```python
import torch

def _softmax(x, axis=-1):
    return torch.softmax(x, dim=axis)
def _gelu(x):
    return torch.nn.functional.gelu(x, approximate="tanh")
def _silu(x):
    return torch.nn.functional.silu(x)
def _sigmoid(x):
    return torch.sigmoid(x)
def _layernorm(x, axis=-1, eps=1e-5):
    m = x.mean(dim=axis, keepdim=True)
    v = x.var(dim=axis, keepdim=True, unbiased=False)
    return (x - m) / torch.sqrt(v + eps)
def _scatter_add(tgt, idx, src, axis=0):
    return tgt.clone().index_add_(axis, idx, src)
def _segment_sum(src, seg, n):
    out = torch.zeros((n,) + src.shape[1:], dtype=src.dtype)
    return out.index_add_(0, seg, src)
def _pad(x, pw):
    flat = tuple(v for pair in reversed(pw) for v in pair)
    return torch.nn.functional.pad(x, flat)

kernel_name = 'sequential_preLN__linear_attn_block__glu_gated_reglu__prompt'

def setup_inputs():

    _w = (lambda a: (lambda t: t.to(torch.bfloat16) if t.is_floating_point() else t)(torch.as_tensor(a)))
    def _A_setup():
        B, S, D = 1, 2048, 640
        return {
            "x": _w((lambda *s: torch.randn(*s, dtype=torch.bfloat16) * 0.05)(B, S, D)),
            "wqkv": _w((lambda *s: torch.randn(*s, dtype=torch.bfloat16) * 0.05)(D, 3 * D)),
            "wo": _w((lambda *s: torch.randn(*s, dtype=torch.bfloat16) * 0.05)(D, D)),
        }
    _A_in = _A_setup()

    def _B_setup():
        B, S, D, F = 1, 2048, 640, 1536
        return {
            "x": _w((lambda *s: torch.randn(*s, dtype=torch.bfloat16) * 0.05)(B, S, D)),
            "W_gate": _w((lambda *s: torch.randn(*s, dtype=torch.bfloat16) * 0.2)(D, F) * (2.0 / D) ** 0.5),
            "W_up": _w((lambda *s: torch.randn(*s, dtype=torch.bfloat16) * 0.2)(D, F) * (2.0 / D) ** 0.5),
            "W_down": _w((lambda *s: torch.randn(*s, dtype=torch.bfloat16) * 0.2)(F, D) * (1.0 / F) ** 0.5),
        }
    _B_in = _B_setup()

    return {
        "A_x": _A_in["x"],
        "A_wqkv": _A_in["wqkv"],
        "A_wo": _A_in["wo"],
        "B_x": _B_in["x"],
        "B_W_gate": _B_in["W_gate"],
        "B_W_up": _B_in["W_up"],
        "B_W_down": _B_in["W_down"],
    }

def reference(A_x, A_wqkv, A_wo, B_x, B_W_gate, B_W_up, B_W_down):
    def _A_ref(x, wqkv, wo):
        B, S, D = x.shape
        H = 32; Dh = D // H
        qkv = (lambda x, *d: x.permute(*d))((x @ wqkv).reshape(B, S, 3, H, Dh), 2, 0, 3, 1, 4)
        q, k, v = qkv[0], qkv[1], qkv[2]
        phi = lambda t: torch.where(t > 0, t + 1, torch.exp(t)) + 1e-6
        pq, pk = phi(q), phi(k)
        kv = torch.einsum("bhsd,bhse->bhde", pk, v)
        z = torch.einsum("bhsd->bhd", pk)
        num = torch.einsum("bhqd,bhde->bhqe", pq, kv)
        den = torch.einsum("bhqd,bhd->bhq", pq, z)[..., None] + 1e-6
        o = num / den
        return (lambda x, *d: x.permute(*d))(o, 0, 2, 1, 3).reshape(B, S, D) @ wo

    def _B_ref(x, W_gate, W_up, W_down):
        gate = torch.einsum("bsd,df->bsf", x, W_gate)
        up = torch.einsum("bsd,df->bsf", x, W_up)
        gate = gate * (lambda x, dt: x.to(dt))(gate > 0, gate.dtype)
        h = gate * up
        return torch.einsum("bsf,fd->bsd", h, W_down)

    x = A_x
    h = x + _A_ref(_layernorm(x, axis=-1), A_wqkv, A_wo)
    h2 = h + _B_ref(_layernorm(h, axis=-1), B_W_gate, B_W_up, B_W_down)
    return h2
```

```asm
; @launch grid=(256,1,1) block=(256,1,1) lds=163840
.amdgcn_target "amdgcn-amd-amdhsa--gfx950"
.text
.globl sequential_preLN__linear_attn_block__glu_gated_reglu__prompt_kernel
.p2align 8
.type sequential_preLN__linear_attn_block__glu_gated_reglu__prompt_kernel,@function
sequential_preLN__linear_attn_block__glu_gated_reglu__prompt_kernel:
KBEG:
    s_cmp_ge_u32 s2, 256
    s_cbranch_scc0 END_1
    s_endpgm
END_1:
    s_load_dwordx2 s[8:9], s[0:1], 0
    s_load_dwordx2 s[12:13], s[0:1], 8
    s_load_dwordx2 s[16:17], s[0:1], 72
    s_load_dwordx2 s[32:33], s[0:1], 64
    s_load_dwordx2 s[20:21], s[0:1], 32
    s_load_dwordx2 s[24:25], s[0:1], 40
    s_load_dwordx2 s[28:29], s[0:1], 48
    s_load_dwordx2 s[96:97], s[0:1], 16
    v_lshrrev_b32 v1, 6, v0
    v_and_b32 v0, 63, v0
    s_nop 0
    v_readfirstlane_b32 s36, v1
    s_and_b32 s3, s2, 7
    s_lshr_b32 s4, s2, 3
    s_lshr_b32 s5, s3, 1
    s_lshl_b32 s5, s5, 2
    s_and_b32 s6, s4, 3
    s_add_u32 s34, s5, s6
    s_and_b32 s5, s3, 1
    s_lshl_b32 s5, s5, 3
    s_lshr_b32 s6, s4, 2
    s_add_u32 s35, s5, s6
    s_waitcnt lgkmcnt(0)
    s_and_b32 s9, s9, 0xffff
    s_mov_b32 s10, 0x280000
    s_mov_b32 s11, 0x20000
    s_and_b32 s13, s13, 0xffff
    s_mov_b32 s14, 0x258000
    s_mov_b32 s15, 0x20000
    s_and_b32 s17, s17, 0xffff
    s_mov_b32 s18, 0x1600000
    s_mov_b32 s19, 0x20000
    s_and_b32 s21, s21, 0xffff
    s_mov_b32 s22, 0x1e0000
    s_mov_b32 s23, 0x20000
    s_and_b32 s25, s25, 0xffff
    s_mov_b32 s26, 0x1e0000
    s_mov_b32 s27, 0x20000
    s_and_b32 s29, s29, 0xffff
    s_mov_b32 s30, 0x1e0000
    s_mov_b32 s31, 0x20000
    s_and_b32 s40, s35, 7
    s_lshl2_add_u32 s40, s40, s36
    s_and_b32 s41, s34, 3
    s_lshl_b32 s41, s41, 5
    s_add_u32 s61, s41, s40
    s_lshl_b32 s41, s34, 5
    s_add_u32 s40, s40, s41
    s_mul_i32 s40, s40, 5120
    s_lshr_b32 s41, s35, 3
    s_mul_i32 s56, s41, 640
    s_mul_i32 s41, s61, 3840
    s_add_u32 s41, s41, s56
    s_mul_i32 s40, s35, 1280
    s_lshl2_add_u32 s6, s34, s40
    s_add_u32 s6, s6, 22020096
    s_mul_i32 s40, s34, 1280
    s_lshl2_add_u32 s7, s35, s40
    s_add_u32 s7, s7, 22040576
    s_xor_b32 s40, s35, s34
    s_or_b32 s40, s40, s36
    s_cbranch_scc1 Z_2
    s_and_b32 s40, s6, 0xffffff80
    s_and_b32 s41, s7, 0xffffff80
    v_lshlrev_b32 v26, 2, v0
    v_mov_b32 v27, 0
    s_mov_b64 exec, 0xffff
    buffer_store_dword v27, v26, s[16:19], s40 offen sc1
    buffer_store_dword v27, v26, s[16:19], s41 offen sc1
    s_mov_b64 exec, -1
Z_2:
    v_lshrrev_b32 v26, 3, v0
    v_mul_u32_u24 v26, 1280, v26
    v_lshrrev_b32 v27, 4, v0
    v_and_b32 v28, 7, v0
    v_xor_b32 v27, v27, v28
    v_lshl_add_u32 v2, v27, 4, v26
    v_xor_b32 v27, 4, v27
    v_lshl_add_u32 v3, v27, 4, v26
    v_add_u32 v3, 10240, v3
    s_add_u32 s40, s34, s35
    s_mul_i32 s41, s40, 13108
    s_lshr_b32 s41, s41, 16
    s_mul_i32 s41, s41, 5
    s_sub_u32 s40, s40, s41
    s_lshl_b32 s41, s34, 2
    s_add_u32 s41, s41, s36
    s_mul_i32 s41, s41, 40960
    s_mul_i32 s42, s35, 80
    s_lshl_b32 s44, s40, 8
    s_add_u32 s44, s44, s41
    s_mul_i32 s49, s40, 491520
    s_add_u32 s49, s49, s42
    s_add_u32 s40, s40, 1
    s_cmp_eq_u32 s40, 5
    s_cselect_b32 s40, 0, s40
    s_lshl_b32 s45, s40, 8
    s_add_u32 s45, s45, s41
    s_mul_i32 s50, s40, 491520
    s_add_u32 s50, s50, s42
    s_add_u32 s40, s40, 1
    s_cmp_eq_u32 s40, 5
    s_cselect_b32 s40, 0, s40
    s_lshl_b32 s46, s40, 8
    s_add_u32 s46, s46, s41
    s_mul_i32 s51, s40, 491520
    s_add_u32 s51, s51, s42
    s_add_u32 s40, s40, 1
    s_cmp_eq_u32 s40, 5
    s_cselect_b32 s40, 0, s40
    s_lshl_b32 s47, s40, 8
    s_add_u32 s47, s47, s41
    s_mul_i32 s52, s40, 491520
    s_add_u32 s52, s52, s42
    s_add_u32 s40, s40, 1
    s_cmp_eq_u32 s40, 5
    s_cselect_b32 s40, 0, s40
    s_lshl_b32 s48, s40, 8
    s_add_u32 s48, s48, s41
    s_mul_i32 s53, s40, 491520
    s_add_u32 s53, s53, s42
    s_add_u32 s40, s40, 1
    s_cmp_eq_u32 s40, 5
    s_cselect_b32 s40, 0, s40
    s_lshl_b32 s54, s36, 13
    s_mul_i32 s55, s36, 5120
    s_add_u32 m0, s54, 0
    s_add_u32 s40, s44, 0
    buffer_load_dwordx4 v2, s[8:11], s40 offen  lds
    s_add_u32 m0, s54, 1024
    s_add_u32 s40, s44, 0
    buffer_load_dwordx4 v3, s[8:11], s40 offen  lds
    s_add_u32 m0, s54, 2048
    s_add_u32 s40, s44, 20480
    buffer_load_dwordx4 v2, s[8:11], s40 offen  lds
    s_add_u32 m0, s54, 3072
    s_add_u32 s40, s44, 20480
    buffer_load_dwordx4 v3, s[8:11], s40 offen  lds
    s_add_u32 m0, s54, 4096
    s_add_u32 s40, s44, 128
    buffer_load_dwordx4 v2, s[8:11], s40 offen  lds
    s_add_u32 m0, s54, 5120
    s_add_u32 s40, s44, 128
    buffer_load_dwordx4 v3, s[8:11], s40 offen  lds
    s_add_u32 m0, s54, 6144
    s_add_u32 s40, s44, 20608
    buffer_load_dwordx4 v2, s[8:11], s40 offen  lds
    s_add_u32 m0, s54, 7168
    s_add_u32 s40, s44, 20608
    buffer_load_dwordx4 v3, s[8:11], s40 offen  lds
    s_cmp_lg_u32 s36, 1
    s_cbranch_scc1 C_3
    s_getpc_b64 s[40:41]
C_4:
    s_lshr_b32 s42, s2, 3
    s_mul_i32 s42, s42, 1280
    v_lshl_add_u32 v26, v0, 7, s42
    v_min_u32 v26, KEND-C_4-4, v26
    v_mov_b32 v27, s41
    v_add_co_u32 v26, vcc, s40, v26
    s_nop 1
    v_addc_co_u32 v27, vcc, 0, v27, vcc
    s_mov_b64 exec, 0x3ff
    global_load_dword v255, v[26:27], off
    s_mov_b64 exec, -1
C_3:
    s_mul_i32 s41, s36, 122880
    s_add_u32 s41, s41, s49
    s_add_u32 s41, s41, 1280
    v_add_u32 v26, 0, v0
    v_mul_u32_u24 v28, 6554, v26
    v_lshrrev_b32 v28, 16, v28
    v_mul_u32_u24 v27, 10, v28
    v_sub_u32 v27, v26, v27
    v_bfe_u32 v29, v28, 2, 2
    v_mul_u32_u24 v29, 8, v29
    v_lshrrev_b32 v30, 4, v28
    v_mad_u32_u24 v29, 4, v30, v29
    v_and_b32 v30, 3, v28
    v_add_u32 v29, v29, v30
    v_mul_u32_u24 v29, 3840, v29
    v_lshl_add_u32 v4, v27, 4, v29
    v_cmp_lt_u32 vcc, 4, v27
    v_mov_b32 v28, 1200
    v_mov_b32 v29, 122800
    v_cndmask_b32 v28, 0, v28, vcc
    v_cndmask_b32 v29, 0, v29, vcc
    v_add_u32 v9, v4, v29
    v_add_u32 v4, v4, v28
    s_add_u32 m0, s55, 32768
    s_nop 0
    buffer_load_dwordx4 v4, s[12:15], s41 offen  lds
    v_add_u32 v26, 64, v0
    v_mul_u32_u24 v28, 6554, v26
    v_lshrrev_b32 v28, 16, v28
    v_mul_u32_u24 v27, 10, v28
    v_sub_u32 v27, v26, v27
    v_bfe_u32 v29, v28, 2, 2
    v_mul_u32_u24 v29, 8, v29
    v_lshrrev_b32 v30, 4, v28
    v_mad_u32_u24 v29, 4, v30, v29
    v_and_b32 v30, 3, v28
    v_add_u32 v29, v29, v30
    v_mul_u32_u24 v29, 3840, v29
    v_lshl_add_u32 v5, v27, 4, v29
    v_cmp_lt_u32 vcc, 4, v27
    v_mov_b32 v28, 1200
    v_mov_b32 v29, 122800
    v_cndmask_b32 v28, 0, v28, vcc
    v_cndmask_b32 v29, 0, v29, vcc
    v_add_u32 v10, v5, v29
    v_add_u32 v5, v5, v28
    s_add_u32 m0, s55, 33792
    s_nop 0
    buffer_load_dwordx4 v5, s[12:15], s41 offen  lds
    v_add_u32 v26, 128, v0
    v_mul_u32_u24 v28, 6554, v26
    v_lshrrev_b32 v28, 16, v28
    v_mul_u32_u24 v27, 10, v28
    v_sub_u32 v27, v26, v27
    v_bfe_u32 v29, v28, 2, 2
    v_mul_u32_u24 v29, 8, v29
    v_lshrrev_b32 v30, 4, v28
    v_mad_u32_u24 v29, 4, v30, v29
    v_and_b32 v30, 3, v28
    v_add_u32 v29, v29, v30
    v_mul_u32_u24 v29, 3840, v29
    v_lshl_add_u32 v6, v27, 4, v29
    v_cmp_lt_u32 vcc, 4, v27
    v_mov_b32 v28, 1200
    v_mov_b32 v29, 122800
    v_cndmask_b32 v28, 0, v28, vcc
    v_cndmask_b32 v29, 0, v29, vcc
    v_add_u32 v11, v6, v29
    v_add_u32 v6, v6, v28
    s_add_u32 m0, s55, 34816
    s_nop 0
    buffer_load_dwordx4 v6, s[12:15], s41 offen  lds
    v_add_u32 v26, 192, v0
    v_mul_u32_u24 v28, 6554, v26
    v_lshrrev_b32 v28, 16, v28
    v_mul_u32_u24 v27, 10, v28
    v_sub_u32 v27, v26, v27
    v_bfe_u32 v29, v28, 2, 2
    v_mul_u32_u24 v29, 8, v29
    v_lshrrev_b32 v30, 4, v28
    v_mad_u32_u24 v29, 4, v30, v29
    v_and_b32 v30, 3, v28
    v_add_u32 v29, v29, v30
    v_mul_u32_u24 v29, 3840, v29
    v_lshl_add_u32 v7, v27, 4, v29
    v_cmp_lt_u32 vcc, 4, v27
    v_mov_b32 v28, 1200
    v_mov_b32 v29, 122800
    v_cndmask_b32 v28, 0, v28, vcc
    v_cndmask_b32 v29, 0, v29, vcc
    v_add_u32 v12, v7, v29
    v_add_u32 v7, v7, v28
    s_add_u32 m0, s55, 35840
    s_nop 0
    buffer_load_dwordx4 v7, s[12:15], s41 offen  lds
    v_add_u32 v26, 256, v0
    v_mul_u32_u24 v28, 6554, v26
    v_lshrrev_b32 v28, 16, v28
    v_mul_u32_u24 v27, 10, v28
    v_sub_u32 v27, v26, v27
    v_bfe_u32 v29, v28, 2, 2
    v_mul_u32_u24 v29, 8, v29
    v_lshrrev_b32 v30, 4, v28
    v_mad_u32_u24 v29, 4, v30, v29
    v_and_b32 v30, 3, v28
    v_add_u32 v29, v29, v30
    v_mul_u32_u24 v29, 3840, v29
    v_lshl_add_u32 v8, v27, 4, v29
    v_cmp_lt_u32 vcc, 4, v27
    v_mov_b32 v28, 1200
    v_mov_b32 v29, 122800
    v_cndmask_b32 v28, 0, v28, vcc
    v_cndmask_b32 v29, 0, v29, vcc
    v_add_u32 v13, v8, v29
    v_add_u32 v8, v8, v28
    s_add_u32 m0, s55, 36864
    s_nop 0
    buffer_load_dwordx4 v8, s[12:15], s41 offen  lds
    s_add_u32 m0, s54, 53248
    s_add_u32 s40, s45, 0
    buffer_load_dwordx4 v2, s[8:11], s40 offen  lds
    v_and_b32 v26, 15, v0
    v_lshrrev_b32 v27, 4, v0
    v_lshrrev_b32 v28, 1, v26
    v_xor_b32 v28, v28, v27
    v_lshlrev_b32 v29, 7, v26
    v_lshl_add_u32 v22, v28, 4, v29
    v_add_u32 v22, s54, v22
    v_xor_b32 v23, 64, v22
    s_mul_i32 s41, s36, 122880
    s_add_u32 s41, s41, s50
    s_add_u32 s41, s41, 1280
    s_add_u32 m0, s55, 86016
    s_nop 0
    buffer_load_dwordx4 v4, s[12:15], s41 offen  lds
    v_lshrrev_b32 v28, 2, v0
    v_mul_u32_u24 v28, 160, v28
    v_and_b32 v29, 3, v0
    v_lshl_add_u32 v25, v29, 3, v28
    v_add_u32 v24, 32768, v25
    v_mov_b32 v40, 0x3f803f80
    v_mov_b32 v41, 0x3f803f80
    v_mov_b32 v42, 0x3f803f80
    v_mov_b32 v43, 0x3f803f80
    s_add_u32 m0, s54, 54272
    s_add_u32 s40, s45, 0
    buffer_load_dwordx4 v3, s[8:11], s40 offen  lds
    v_lshl_add_u32 v28, v27, 2, 0
    v_cmp_le_u32 vcc, 20, v28
    s_nop 1
    v_cndmask_b32 v29, 0, 20, vcc
    v_sub_u32 v30, v28, v29
    v_lshlrev_b32 v30, 1, v30
    v_mad_u32_u24 v30, v29, 42, v30
    v_cmp_gt_u32 s[62:63], 40, v28
    s_add_u32 m0, s54, 55296
    s_add_u32 s40, s45, 20480
    buffer_load_dwordx4 v2, s[8:11], s40 offen  lds
    v_add_u32 v31, 800, v30
    v_mov_b32 v34, 2048
    v_add_u32 v32, -8, v26
    v_sub_u32 v32, v32, v29
    v_cmp_gt_u32 vcc, 20, v32
    s_and_b64 vcc, vcc, s[62:63]
    v_mad_u32_u24 v33, v32, 40, v30
    v_cndmask_b32 v160, v34, v33, vcc
    s_add_u32 m0, s55, 87040
    s_nop 0
    buffer_load_dwordx4 v5, s[12:15], s41 offen  lds
    v_cndmask_b32 v170, v34, v31, vcc
    v_add_u32 v32, 8, v26
    v_sub_u32 v32, v32, v29
    v_cmp_gt_u32 vcc, 20, v32
    s_and_b64 vcc, vcc, s[62:63]
    v_mad_u32_u24 v33, v32, 40, v30
    v_cndmask_b32 v162, v34, v33, vcc
    v_cndmask_b32 v172, v34, v31, vcc
    v_cmp_eq_u32 vcc, 0, v26
    s_add_u32 m0, s54, 56320
    s_add_u32 s40, s45, 20480
    buffer_load_dwordx4 v3, s[8:11], s40 offen  lds
    s_and_b64 vcc, vcc, s[62:63]
    s_nop 0
    v_cndmask_b32 v167, v34, v31, vcc
    v_lshl_add_u32 v28, v27, 2, 16
    v_cmp_le_u32 vcc, 20, v28
    s_nop 1
    v_cndmask_b32 v29, 0, 20, vcc
    v_sub_u32 v30, v28, v29
    s_add_u32 m0, s55, 88064
    s_nop 0
    buffer_load_dwordx4 v6, s[12:15], s41 offen  lds
    v_lshlrev_b32 v30, 1, v30
    v_mad_u32_u24 v30, v29, 42, v30
    v_cmp_gt_u32 s[62:63], 40, v28
    v_add_u32 v31, 800, v30
    v_mov_b32 v34, 2048
    v_add_u32 v32, -8, v26
    v_sub_u32 v32, v32, v29
    v_cmp_gt_u32 vcc, 20, v32
    s_add_u32 m0, s54, 57344
    s_add_u32 s40, s45, 128
    buffer_load_dwordx4 v2, s[8:11], s40 offen  lds
    s_and_b64 vcc, vcc, s[62:63]
    v_mad_u32_u24 v33, v32, 40, v30
    v_cndmask_b32 v161, v34, v33, vcc
    v_cndmask_b32 v171, v34, v31, vcc
    v_add_u32 v32, 8, v26
    v_sub_u32 v32, v32, v29
    v_cmp_gt_u32 vcc, 20, v32
    s_and_b64 vcc, vcc, s[62:63]
    s_add_u32 m0, s54, 58368
    s_add_u32 s40, s45, 128
    buffer_load_dwordx4 v3, s[8:11], s40 offen  lds
    v_mad_u32_u24 v33, v32, 40, v30
    v_cndmask_b32 v163, v34, v33, vcc
    v_cndmask_b32 v173, v34, v31, vcc
    v_add_u32 v32, 24, v26
    v_sub_u32 v32, v32, v29
    v_cmp_gt_u32 vcc, 20, v32
    s_and_b64 vcc, vcc, s[62:63]
    v_mad_u32_u24 v33, v32, 40, v30
    v_cndmask_b32 v165, v34, v33, vcc
    s_add_u32 m0, s55, 89088
    s_nop 0
    buffer_load_dwordx4 v7, s[12:15], s41 offen  lds
    v_cndmask_b32 v175, v34, v31, vcc
    v_cmp_eq_u32 vcc, 0, v26
    s_and_b64 vcc, vcc, s[62:63]
    s_nop 0
    v_cndmask_b32 v168, v34, v31, vcc
    v_lshl_add_u32 v28, v27, 2, 32
    v_cmp_le_u32 vcc, 20, v28
    s_nop 1
    s_add_u32 m0, s54, 59392
    s_add_u32 s40, s45, 20608
    buffer_load_dwordx4 v2, s[8:11], s40 offen  lds
    v_cndmask_b32 v29, 0, 20, vcc
    v_sub_u32 v30, v28, v29
    v_lshlrev_b32 v30, 1, v30
    v_mad_u32_u24 v30, v29, 42, v30
    v_cmp_gt_u32 s[62:63], 40, v28
    v_add_u32 v31, 800, v30
    v_mov_b32 v34, 2048
    v_add_u32 v32, 8, v26
    s_add_u32 m0, s55, 90112
    s_nop 0
    buffer_load_dwordx4 v8, s[12:15], s41 offen  lds
    v_sub_u32 v32, v32, v29
    v_cmp_gt_u32 vcc, 20, v32
    s_and_b64 vcc, vcc, s[62:63]
    v_mad_u32_u24 v33, v32, 40, v30
    v_cndmask_b32 v164, v34, v33, vcc
    v_cndmask_b32 v174, v34, v31, vcc
    v_add_u32 v32, 24, v26
    v_sub_u32 v32, v32, v29
    v_cmp_gt_u32 vcc, 20, v32
    s_add_u32 m0, s54, 60416
    s_add_u32 s40, s45, 20608
    buffer_load_dwordx4 v3, s[8:11], s40 offen  lds
    s_and_b64 vcc, vcc, s[62:63]
    v_mad_u32_u24 v33, v32, 40, v30
    v_cndmask_b32 v166, v34, v33, vcc
    v_cndmask_b32 v176, v34, v31, vcc
    v_cmp_eq_u32 vcc, 0, v26
    s_and_b64 vcc, vcc, s[62:63]
    s_nop 0
    v_cndmask_b32 v169, v34, v31, vcc
    s_and_b32 s40, s35, 1
    s_lshl4_add_u32 s40, s40, s34
    s_and_b32 s41, s36, 1
    s_lshl1_add_u32 s40, s40, s41
    s_lshr_b32 s41, s35, 1
    s_lshl3_add_u32 s60, s40, s41
    s_cmpk_lt_u32 s60, 480
    s_cselect_b64 s[98:99], -1, 0
    s_cmpk_lt_u32 s60, 384
    s_cselect_b64 s[100:101], -1, 0
    s_cmp_lt_u32 s36, 2
    s_cselect_b64 s[98:99], s[98:99], 0
    s_cselect_b64 s[100:101], 0, s[100:101]
    s_lshr_b32 s40, s60, 3
    s_mul_i32 s41, s40, 21846
    s_lshr_b32 s41, s41, 16
    s_and_b32 s42, s60, 7
    s_sub_u32 s42, s42, s41
    s_mul_i32 s42, s42, 3
    s_add_u32 s42, s42, s40
    s_mul_i32 s59, s41, 24
    s_add_u32 s59, s59, s42
    s_lshl_b32 s59, s59, 13
    s_add_u32 s59, s59, 1048576
    s_lshr_b32 s40, s41, 1
    s_lshl_b32 s40, s40, 4
    s_lshl_b32 s43, s41, 5
    s_add_u32 s40, s40, s43
    s_sub_u32 s43, s41, 16
    s_mul_i32 s43, s43, 160
    s_add_u32 s43, s43, 64
    s_cmp_lt_u32 s41, 16
    s_cselect_b32 s40, s40, s43
    s_cselect_b32 s57, 16, 0x50
    s_mul_i32 s40, s40, 3072
    s_lshl_b32 s42, s42, 7
    s_add_u32 s64, s40, s42
    s_mul_i32 s57, s57, 3072
    s_sub_u32 s57, s57, 24576
    v_lshrrev_b32 v26, 3, v0
    v_mul_u32_u24 v26, 3072, v26
    v_lshrrev_b32 v27, 4, v0
    v_and_b32 v28, 7, v0
    v_xor_b32 v27, v27, v28
    v_lshl_add_u32 v14, v27, 4, v26
    v_xor_b32 v15, 64, v14
    s_lshr_b32 s41, s60, 3
    s_and_b32 s40, s60, 7
    s_mul_i32 s58, s40, 48
    s_add_u32 s58, s58, s41
    s_mul_i32 s58, s58, 5120
    s_add_u32 s58, s58, 5242880
    s_mul_i32 s42, s41, 21846
    s_lshr_b32 s42, s42, 16
    s_mul_i32 s42, s42, 72
    s_lshl_b32 s41, s41, 3
    s_add_u32 s41, s41, s42
    s_mul_i32 s41, s41, 1280
    s_mul_i32 s40, s40, 160
    s_add_u32 s65, s41, s40
    s_and_b32 s64, s64, s98
    s_and_b32 s65, s65, s100
    s_and_b32 s59, s59, s98
    s_and_b32 s58, s58, s100
    s_or_b32 s59, s59, s58
    s_add_u32 s58, s59, 4096
    v_add_u32 v26, 0, v0
    v_mul_u32_u24 v28, 6554, v26
    v_lshrrev_b32 v28, 16, v28
    v_mul_u32_u24 v27, 10, v28
    v_sub_u32 v27, v26, v27
    v_bfe_u32 v29, v28, 2, 2
    v_mul_u32_u24 v29, 24, v29
    v_lshrrev_b32 v30, 4, v28
    v_mad_u32_u24 v29, 4, v30, v29
    v_and_b32 v30, 3, v28
    v_add_u32 v29, v29, v30
    v_mul_u32_u24 v29, 1280, v29
    v_lshl_add_u32 v16, v27, 4, v29
    v_add_u32 v26, 64, v0
    v_mul_u32_u24 v28, 6554, v26
    v_lshrrev_b32 v28, 16, v28
    v_mul_u32_u24 v27, 10, v28
    v_sub_u32 v27, v26, v27
    v_bfe_u32 v29, v28, 2, 2
    v_mul_u32_u24 v29, 24, v29
    v_lshrrev_b32 v30, 4, v28
    v_mad_u32_u24 v29, 4, v30, v29
    v_and_b32 v30, 3, v28
    v_add_u32 v29, v29, v30
    v_mul_u32_u24 v29, 1280, v29
    v_lshl_add_u32 v17, v27, 4, v29
    v_add_u32 v26, 128, v0
    v_mul_u32_u24 v28, 6554, v26
    v_lshrrev_b32 v28, 16, v28
    v_mul_u32_u24 v27, 10, v28
    v_sub_u32 v27, v26, v27
    v_bfe_u32 v29, v28, 2, 2
    v_mul_u32_u24 v29, 24, v29
    v_lshrrev_b32 v30, 4, v28
    v_mad_u32_u24 v29, 4, v30, v29
    v_and_b32 v30, 3, v28
    v_add_u32 v29, v29, v30
    v_mul_u32_u24 v29, 1280, v29
    v_lshl_add_u32 v18, v27, 4, v29
    v_add_u32 v26, 192, v0
    v_mul_u32_u24 v28, 6554, v26
    v_lshrrev_b32 v28, 16, v28
    v_mul_u32_u24 v27, 10, v28
    v_sub_u32 v27, v26, v27
    v_bfe_u32 v29, v28, 2, 2
    v_mul_u32_u24 v29, 24, v29
    v_lshrrev_b32 v30, 4, v28
    v_mad_u32_u24 v29, 4, v30, v29
    v_and_b32 v30, 3, v28
    v_add_u32 v29, v29, v30
    v_mul_u32_u24 v29, 1280, v29
    v_lshl_add_u32 v19, v27, 4, v29
    v_add_u32 v26, 256, v0
    v_mul_u32_u24 v28, 6554, v26
    v_lshrrev_b32 v28, 16, v28
    v_mul_u32_u24 v27, 10, v28
    v_sub_u32 v27, v26, v27
    v_bfe_u32 v29, v28, 2, 2
    v_mul_u32_u24 v29, 24, v29
    v_lshrrev_b32 v30, 4, v28
    v_mad_u32_u24 v29, 4, v30, v29
    v_and_b32 v30, 3, v28
    v_add_u32 v29, v29, v30
    v_mul_u32_u24 v29, 1280, v29
    v_lshl_add_u32 v20, v27, 4, v29
    s_xor_b32 s3, s35, 1
    s_sub_u32 s56, s3, s35
    s_mul_i32 s56, s56, 80
    s_waitcnt vmcnt(13)
    s_barrier
    s_xor_b32 s40, s35, s34
    s_or_b32 s40, s40, s36
    s_cbranch_scc1 Z_21
    s_lshl_b32 s40, s34, 2
    v_mov_b32 v26, s40
    v_mov_b32 v27, 1
    s_mov_b64 exec, 1
    global_store_dword v26, v27, s[32:33] sc1
    s_mov_b64 exec, -1
Z_21:
    ds_read_b128 a[0:3], v22 offset:0
    ds_read_b128 a[4:7], v22 offset:2048
    ds_read_b64_tr_b16 v[120:121], v24 offset:0
    ds_read_b64_tr_b16 v[122:123], v24 offset:2560
    ds_read_b64_tr_b16 v[124:125], v24 offset:32
    ds_read_b64_tr_b16 v[126:127], v24 offset:2592
    ds_read_b64_tr_b16 v[128:129], v24 offset:64
    ds_read_b64_tr_b16 v[130:131], v24 offset:2624
    ds_read_b64_tr_b16 v[132:133], v24 offset:96
    ds_read_b64_tr_b16 v[134:135], v24 offset:2656
    ds_read_b64_tr_b16 v[136:137], v24 offset:128
    ds_read_b64_tr_b16 v[138:139], v24 offset:2688
    s_waitcnt lgkmcnt(0)
    v_mfma_f32_16x16x32_bf16 v[104:107], a[0:3], v[40:43], 0
    ds_read_b128 a[8:11], v23 offset:0
    s_add_u32 m0, s54, 106496
    v_mfma_f32_16x16x32_bf16 v[112:115], a[0:3], a[0:3], 0
    ds_read_b128 a[12:15], v23 offset:2048
    s_add_u32 s40, s46, 0
    v_mfma_f32_16x16x32_bf16 v[108:111], a[4:7], v[40:43], 0
    ds_read_b64_tr_b16 v[140:141], v24 offset:5120
    buffer_load_dwordx4 v2, s[8:11], s40 offen  lds
    v_mfma_f32_16x16x32_bf16 v[116:119], a[4:7], a[4:7], 0
    ds_read_b64_tr_b16 v[142:143], v24 offset:7680
    v_mfma_f32_16x16x32_bf16 v[44:47], a[0:3], v[120:123], 0
    ds_read_b64_tr_b16 v[144:145], v24 offset:5152
    s_mul_i32 s41, s36, 122880
    v_mfma_f32_16x16x32_bf16 v[64:67], a[4:7], v[120:123], 0
    ds_read_b64_tr_b16 v[146:147], v24 offset:7712
    s_add_u32 s41, s41, s51
    v_mfma_f32_16x16x32_bf16 v[84:87], v[40:43], v[120:123], 0
    ds_read_b64_tr_b16 v[148:149], v24 offset:5184
    s_add_u32 s41, s41, 1280
    v_mfma_f32_16x16x32_bf16 v[48:51], a[0:3], v[124:127], 0
    ds_read_b64_tr_b16 v[150:151], v24 offset:7744
    v_mfma_f32_16x16x32_bf16 v[68:71], a[4:7], v[124:127], 0
    ds_read_b64_tr_b16 v[152:153], v24 offset:5216
    s_add_u32 m0, s55, 139264
    v_mfma_f32_16x16x32_bf16 v[88:91], v[40:43], v[124:127], 0
    ds_read_b64_tr_b16 v[154:155], v24 offset:7776
    s_nop 0
    v_mfma_f32_16x16x32_bf16 v[52:55], a[0:3], v[128:131], 0
    ds_read_b64_tr_b16 v[156:157], v24 offset:5248
    buffer_load_dwordx4 v4, s[12:15], s41 offen  lds
    v_mfma_f32_16x16x32_bf16 v[72:75], a[4:7], v[128:131], 0
    ds_read_b64_tr_b16 v[158:159], v24 offset:7808
    v_mfma_f32_16x16x32_bf16 v[92:95], v[40:43], v[128:131], 0
    s_add_u32 m0, s54, 107520
    s_add_u32 s40, s46, 0
    v_mfma_f32_16x16x32_bf16 v[56:59], a[0:3], v[132:135], 0
    buffer_load_dwordx4 v3, s[8:11], s40 offen  lds
    s_add_u32 m0, s54, 108544
    v_mfma_f32_16x16x32_bf16 v[76:79], a[4:7], v[132:135], 0
    s_add_u32 s40, s46, 20480
    buffer_load_dwordx4 v2, s[8:11], s40 offen  lds
    v_mfma_f32_16x16x32_bf16 v[96:99], v[40:43], v[132:135], 0
    s_cmp_eq_u32 s98, 0
    s_cbranch_scc1 K_5
    buffer_load_dwordx4 a[160:163], v14, s[20:23], s64 offen
K_5:
    v_mfma_f32_16x16x32_bf16 v[60:63], a[0:3], v[136:139], 0
    s_cmp_eq_u32 s100, 0
    s_cbranch_scc1 K_13
    buffer_load_dwordx4 a[160:163], v16, s[28:31], s65 offen
K_13:
    s_cmp_eq_u32 s98, 0
    s_cbranch_scc1 K_6
    buffer_load_dwordx4 a[176:179], v15, s[24:27], s64 offen
K_6:
    s_add_u32 s64, s64, 24576
    v_mfma_f32_16x16x32_bf16 v[80:83], a[4:7], v[136:139], 0
    s_cmp_eq_u32 s100, 0
    s_cbranch_scc1 K_14
    buffer_load_dwordx4 a[164:167], v17, s[28:31], s65 offen
K_14:
    s_cmp_eq_u32 s98, 0
    s_cbranch_scc1 K_7
    buffer_load_dwordx4 a[164:167], v14, s[20:23], s64 offen
K_7:
    v_mfma_f32_16x16x32_bf16 v[100:103], v[40:43], v[136:139], 0
    s_cmp_eq_u32 s100, 0
    s_cbranch_scc1 K_15
    buffer_load_dwordx4 a[168:171], v18, s[28:31], s65 offen
K_15:
    s_waitcnt lgkmcnt(0)
    v_mfma_f32_16x16x32_bf16 v[104:107], a[8:11], v[40:43], v[104:107]
    ds_read_b128 a[16:19], v22 offset:4096
    s_add_u32 m0, s55, 140288
    v_mfma_f32_16x16x32_bf16 v[112:115], a[8:11], a[8:11], v[112:115]
    ds_read_b128 a[20:23], v22 offset:6144
    s_nop 0
    v_mfma_f32_16x16x32_bf16 v[108:111], a[12:15], v[40:43], v[108:111]
    ds_read_b64_tr_b16 v[120:121], v24 offset:10240
    v_mfma_f32_16x16x32_bf16 v[116:119], a[12:15], a[12:15], v[116:119]
    ds_read_b64_tr_b16 v[122:123], v24 offset:12800
    buffer_load_dwordx4 v5, s[12:15], s41 offen  lds
    v_mfma_f32_16x16x32_bf16 v[44:47], a[8:11], v[140:143], v[44:47]
    ds_read_b64_tr_b16 v[124:125], v24 offset:10272
    s_add_u32 m0, s54, 109568
    v_mfma_f32_16x16x32_bf16 v[64:67], a[12:15], v[140:143], v[64:67]
    ds_read_b64_tr_b16 v[126:127], v24 offset:12832
    v_mfma_f32_16x16x32_bf16 v[84:87], v[40:43], v[140:143], v[84:87]
    ds_read_b64_tr_b16 v[128:129], v24 offset:10304
    s_add_u32 s40, s46, 20480
    v_mfma_f32_16x16x32_bf16 v[48:51], a[8:11], v[144:147], v[48:51]
    ds_read_b64_tr_b16 v[130:131], v24 offset:12864
    buffer_load_dwordx4 v3, s[8:11], s40 offen  lds
    v_mfma_f32_16x16x32_bf16 v[68:71], a[12:15], v[144:147], v[68:71]
    ds_read_b64_tr_b16 v[132:133], v24 offset:10336
    v_mfma_f32_16x16x32_bf16 v[88:91], v[40:43], v[144:147], v[88:91]
    ds_read_b64_tr_b16 v[134:135], v24 offset:12896
    s_add_u32 m0, s55, 141312
    v_mfma_f32_16x16x32_bf16 v[52:55], a[8:11], v[148:151], v[52:55]
    ds_read_b64_tr_b16 v[136:137], v24 offset:10368
    v_mfma_f32_16x16x32_bf16 v[72:75], a[12:15], v[148:151], v[72:75]
    ds_read_b64_tr_b16 v[138:139], v24 offset:12928
    s_nop 0
    v_mfma_f32_16x16x32_bf16 v[92:95], v[40:43], v[148:151], v[92:95]
    buffer_load_dwordx4 v6, s[12:15], s41 offen  lds
    s_add_u32 m0, s54, 110592
    v_mfma_f32_16x16x32_bf16 v[56:59], a[8:11], v[152:155], v[56:59]
    s_add_u32 s40, s46, 128
    v_mfma_f32_16x16x32_bf16 v[76:79], a[12:15], v[152:155], v[76:79]
    buffer_load_dwordx4 v2, s[8:11], s40 offen  lds
    s_cmp_eq_u32 s98, 0
    s_cbranch_scc1 K_8
    buffer_load_dwordx4 a[180:183], v15, s[24:27], s64 offen
K_8:
    s_add_u32 s64, s64, s57
    v_mfma_f32_16x16x32_bf16 v[96:99], v[40:43], v[152:155], v[96:99]
    s_cmp_eq_u32 s100, 0
    s_cbranch_scc1 K_16
    buffer_load_dwordx4 a[172:175], v19, s[28:31], s65 offen
K_16:
    s_cmp_eq_u32 s98, 0
    s_cbranch_scc1 K_9
    buffer_load_dwordx4 a[168:171], v14, s[20:23], s64 offen
K_9:
    v_mfma_f32_16x16x32_bf16 v[60:63], a[8:11], v[156:159], v[60:63]
    s_cmp_eq_u32 s100, 0
    s_cbranch_scc1 K_17
    buffer_load_dwordx4 a[176:179], v20, s[28:31], s65 offen
K_17:
    v_mfma_f32_16x16x32_bf16 v[80:83], a[12:15], v[156:159], v[80:83]
    s_cmp_eq_u32 s98, 0
    s_cbranch_scc1 K_10
    buffer_load_dwordx4 a[184:187], v15, s[24:27], s64 offen
K_10:
    s_add_u32 s64, s64, 24576
    s_cmp_eq_u32 s98, 0
    s_cbranch_scc1 K_11
    buffer_load_dwordx4 a[172:175], v14, s[20:23], s64 offen
K_11:
    v_mfma_f32_16x16x32_bf16 v[100:103], v[40:43], v[156:159], v[100:103]
    s_cmp_eq_u32 s98, 0
    s_cbranch_scc1 K_12
    buffer_load_dwordx4 a[188:191], v15, s[24:27], s64 offen
K_12:
    s_waitcnt lgkmcnt(0)
    v_mfma_f32_16x16x32_bf16 v[104:107], a[16:19], v[40:43], v[104:107]
    ds_read_b128 a[24:27], v23 offset:4096
    s_add_u32 m0, s54, 111616
    v_mfma_f32_16x16x32_bf16 v[112:115], a[16:19], a[16:19], v[112:115]
    ds_read_b128 a[28:31], v23 offset:6144
    v_mfma_f32_16x16x32_bf16 v[108:111], a[20:23], v[40:43], v[108:111]
    ds_read_b64_tr_b16 v[140:141], v24 offset:15360
    s_add_u32 s40, s46, 128
    v_mfma_f32_16x16x32_bf16 v[116:119], a[20:23], a[20:23], v[116:119]
    ds_read_b64_tr_b16 v[142:143], v24 offset:17920
    v_mfma_f32_16x16x32_bf16 v[44:47], a[16:19], v[120:123], v[44:47]
    ds_read_b64_tr_b16 v[144:145], v24 offset:15392
    buffer_load_dwordx4 v3, s[8:11], s40 offen  lds
    v_mfma_f32_16x16x32_bf16 v[64:67], a[20:23], v[120:123], v[64:67]
    ds_read_b64_tr_b16 v[146:147], v24 offset:17952
    v_mfma_f32_16x16x32_bf16 v[84:87], v[40:43], v[120:123], v[84:87]
    ds_read_b64_tr_b16 v[148:149], v24 offset:15424
    v_mfma_f32_16x16x32_bf16 v[48:51], a[16:19], v[124:127], v[48:51]
    ds_read_b64_tr_b16 v[150:151], v24 offset:17984
    s_add_u32 m0, s55, 142336
    v_mfma_f32_16x16x32_bf16 v[68:71], a[20:23], v[124:127], v[68:71]
    ds_read_b64_tr_b16 v[152:153], v24 offset:15456
    v_mfma_f32_16x16x32_bf16 v[88:91], v[40:43], v[124:127], v[88:91]
    ds_read_b64_tr_b16 v[154:155], v24 offset:18016
    s_nop 0
    v_mfma_f32_16x16x32_bf16 v[52:55], a[16:19], v[128:131], v[52:55]
    ds_read_b64_tr_b16 v[156:157], v24 offset:15488
    v_mfma_f32_16x16x32_bf16 v[72:75], a[20:23], v[128:131], v[72:75]
    ds_read_b64_tr_b16 v[158:159], v24 offset:18048
    buffer_load_dwordx4 v7, s[12:15], s41 offen  lds
    v_mfma_f32_16x16x32_bf16 v[92:95], v[40:43], v[128:131], v[92:95]
    s_add_u32 m0, s54, 112640
    v_mfma_f32_16x16x32_bf16 v[56:59], a[16:19], v[132:135], v[56:59]
    s_add_u32 s40, s46, 20608
    v_mfma_f32_16x16x32_bf16 v[76:79], a[20:23], v[132:135], v[76:79]
    buffer_load_dwordx4 v2, s[8:11], s40 offen  lds
    s_add_u32 m0, s55, 143360
    v_mfma_f32_16x16x32_bf16 v[96:99], v[40:43], v[132:135], v[96:99]
    s_nop 0
    v_mfma_f32_16x16x32_bf16 v[60:63], a[16:19], v[136:139], v[60:63]
    buffer_load_dwordx4 v8, s[12:15], s41 offen  lds
    s_add_u32 m0, s54, 113664
    v_mfma_f32_16x16x32_bf16 v[80:83], a[20:23], v[136:139], v[80:83]
    s_add_u32 s40, s46, 20608
    v_mfma_f32_16x16x32_bf16 v[100:103], v[40:43], v[136:139], v[100:103]
    buffer_load_dwordx4 v3, s[8:11], s40 offen  lds
    s_waitcnt lgkmcnt(0)
    s_cmp_lg_u32 s98, 0
    s_cbranch_scc1 K_22
    s_cmp_lg_u32 s100, 0
    s_cbranch_scc1 K_23
    s_waitcnt vmcnt(13)
K_23:
    s_waitcnt vmcnt(18)
K_22:
    s_waitcnt vmcnt(21)
    s_barrier
    v_add_u32 v22, 53248, v22
    v_add_u32 v23, 53248, v23
    v_add_u32 v24, 53248, v24
    v_mfma_f32_16x16x32_bf16 v[104:107], a[24:27], v[40:43], v[104:107]
    ds_read_b128 a[32:35], v22 offset:0
    s_add_u32 m0, s54, 0
    v_mfma_f32_16x16x32_bf16 v[112:115], a[24:27], a[24:27], v[112:115]
    ds_read_b128 a[36:39], v22 offset:2048
    v_mfma_f32_16x16x32_bf16 v[108:111], a[28:31], v[40:43], v[108:111]
    ds_read_b64_tr_b16 v[120:121], v24 offset:0
    v_mfma_f32_16x16x32_bf16 v[116:119], a[28:31], a[28:31], v[116:119]
    ds_read_b64_tr_b16 v[122:123], v24 offset:2560
    s_add_u32 s40, s47, 0
    v_mfma_f32_16x16x32_bf16 v[44:47], a[24:27], v[140:143], v[44:47]
    ds_read_b64_tr_b16 v[124:125], v24 offset:32
    v_mfma_f32_16x16x32_bf16 v[64:67], a[28:31], v[140:143], v[64:67]
    ds_read_b64_tr_b16 v[126:127], v24 offset:2592
    v_mfma_f32_16x16x32_bf16 v[84:87], v[40:43], v[140:143], v[84:87]
    ds_read_b64_tr_b16 v[128:129], v24 offset:64
    v_mfma_f32_16x16x32_bf16 v[48:51], a[24:27], v[144:147], v[48:51]
    ds_read_b64_tr_b16 v[130:131], v24 offset:2624
    buffer_load_dwordx4 v2, s[8:11], s40 offen  lds
    v_mfma_f32_16x16x32_bf16 v[68:71], a[28:31], v[144:147], v[68:71]
    ds_read_b64_tr_b16 v[132:133], v24 offset:96
    v_mfma_f32_16x16x32_bf16 v[88:91], v[40:43], v[144:147], v[88:91]
    ds_read_b64_tr_b16 v[134:135], v24 offset:2656
    v_mfma_f32_16x16x32_bf16 v[52:55], a[24:27], v[148:151], v[52:55]
    ds_read_b64_tr_b16 v[136:137], v24 offset:128
    v_mfma_f32_16x16x32_bf16 v[72:75], a[28:31], v[148:151], v[72:75]
    ds_read_b64_tr_b16 v[138:139], v24 offset:2688
    s_mul_i32 s41, s36, 122880
    v_mfma_f32_16x16x32_bf16 v[92:95], v[40:43], v[148:151], v[92:95]
    s_add_u32 s41, s41, s52
    v_mfma_f32_16x16x32_bf16 v[56:59], a[24:27], v[152:155], v[56:59]
    s_add_u32 s41, s41, 1280
    v_mfma_f32_16x16x32_bf16 v[76:79], a[28:31], v[152:155], v[76:79]
    s_add_u32 m0, s55, 32768
    v_mfma_f32_16x16x32_bf16 v[96:99], v[40:43], v[152:155], v[96:99]
    s_nop 0
    buffer_load_dwordx4 v4, s[12:15], s41 offen  lds
    v_mfma_f32_16x16x32_bf16 v[60:63], a[24:27], v[156:159], v[60:63]
    s_add_u32 m0, s54, 1024
    v_mfma_f32_16x16x32_bf16 v[80:83], a[28:31], v[156:159], v[80:83]
    s_add_u32 s40, s47, 0
    v_mfma_f32_16x16x32_bf16 v[100:103], v[40:43], v[156:159], v[100:103]
    buffer_load_dwordx4 v3, s[8:11], s40 offen  lds
    s_waitcnt lgkmcnt(0)
    v_mfma_f32_16x16x32_bf16 v[104:107], a[32:35], v[40:43], v[104:107]
    ds_read_b128 a[40:43], v23 offset:0
    s_add_u32 m0, s54, 2048
    v_mfma_f32_16x16x32_bf16 v[112:115], a[32:35], a[32:35], v[112:115]
    ds_read_b128 a[44:47], v23 offset:2048
    v_mfma_f32_16x16x32_bf16 v[108:111], a[36:39], v[40:43], v[108:111]
    ds_read_b64_tr_b16 v[140:141], v24 offset:5120
    v_mfma_f32_16x16x32_bf16 v[116:119], a[36:39], a[36:39], v[116:119]
    ds_read_b64_tr_b16 v[142:143], v24 offset:7680
    v_mfma_f32_16x16x32_bf16 v[44:47], a[32:35], v[120:123], v[44:47]
    ds_read_b64_tr_b16 v[144:145], v24 offset:5152
    v_mfma_f32_16x16x32_bf16 v[64:67], a[36:39], v[120:123], v[64:67]
    ds_read_b64_tr_b16 v[146:147], v24 offset:7712
    v_mfma_f32_16x16x32_bf16 v[84:87], v[40:43], v[120:123], v[84:87]
    ds_read_b64_tr_b16 v[148:149], v24 offset:5184
    v_mfma_f32_16x16x32_bf16 v[48:51], a[32:35], v[124:127], v[48:51]
    ds_read_b64_tr_b16 v[150:151], v24 offset:7744
    v_mfma_f32_16x16x32_bf16 v[68:71], a[36:39], v[124:127], v[68:71]
    ds_read_b64_tr_b16 v[152:153], v24 offset:5216
    v_mfma_f32_16x16x32_bf16 v[88:91], v[40:43], v[124:127], v[88:91]
    ds_read_b64_tr_b16 v[154:155], v24 offset:7776
    s_add_u32 s40, s47, 20480
    v_mfma_f32_16x16x32_bf16 v[52:55], a[32:35], v[128:131], v[52:55]
    ds_read_b64_tr_b16 v[156:157], v24 offset:5248
    v_mfma_f32_16x16x32_bf16 v[72:75], a[36:39], v[128:131], v[72:75]
    ds_read_b64_tr_b16 v[158:159], v24 offset:7808
    v_mfma_f32_16x16x32_bf16 v[92:95], v[40:43], v[128:131], v[92:95]
    buffer_load_dwordx4 v2, s[8:11], s40 offen  lds
    v_mfma_f32_16x16x32_bf16 v[56:59], a[32:35], v[132:135], v[56:59]
    s_add_u32 m0, s55, 33792
    v_mfma_f32_16x16x32_bf16 v[76:79], a[36:39], v[132:135], v[76:79]
    s_nop 0
    v_mfma_f32_16x16x32_bf16 v[96:99], v[40:43], v[132:135], v[96:99]
    buffer_load_dwordx4 v5, s[12:15], s41 offen  lds
    v_mfma_f32_16x16x32_bf16 v[60:63], a[32:35], v[136:139], v[60:63]
    s_add_u32 m0, s54, 3072
    v_mfma_f32_16x16x32_bf16 v[80:83], a[36:39], v[136:139], v[80:83]
    s_add_u32 s40, s47, 20480
    v_mfma_f32_16x16x32_bf16 v[100:103], v[40:43], v[136:139], v[100:103]
    buffer_load_dwordx4 v3, s[8:11], s40 offen  lds
    s_waitcnt lgkmcnt(0)
    v_mfma_f32_16x16x32_bf16 v[104:107], a[40:43], v[40:43], v[104:107]
    ds_read_b128 a[48:51], v22 offset:4096
    s_add_u32 m0, s55, 34816
    v_mfma_f32_16x16x32_bf16 v[112:115], a[40:43], a[40:43], v[112:115]
    ds_read_b128 a[52:55], v22 offset:6144
    v_mfma_f32_16x16x32_bf16 v[108:111], a[44:47], v[40:43], v[108:111]
    ds_read_b64_tr_b16 v[120:121], v24 offset:10240
    v_mfma_f32_16x16x32_bf16 v[116:119], a[44:47], a[44:47], v[116:119]
    ds_read_b64_tr_b16 v[122:123], v24 offset:12800
    v_mfma_f32_16x16x32_bf16 v[44:47], a[40:43], v[140:143], v[44:47]
    ds_read_b64_tr_b16 v[124:125], v24 offset:10272
    v_mfma_f32_16x16x32_bf16 v[64:67], a[44:47], v[140:143], v[64:67]
    ds_read_b64_tr_b16 v[126:127], v24 offset:12832
    v_mfma_f32_16x16x32_bf16 v[84:87], v[40:43], v[140:143], v[84:87]
    ds_read_b64_tr_b16 v[128:129], v24 offset:10304
    v_mfma_f32_16x16x32_bf16 v[48:51], a[40:43], v[144:147], v[48:51]
    ds_read_b64_tr_b16 v[130:131], v24 offset:12864
    v_mfma_f32_16x16x32_bf16 v[68:71], a[44:47], v[144:147], v[68:71]
    ds_read_b64_tr_b16 v[132:133], v24 offset:10336
    v_mfma_f32_16x16x32_bf16 v[88:91], v[40:43], v[144:147], v[88:91]
    ds_read_b64_tr_b16 v[134:135], v24 offset:12896
    s_nop 0
    v_mfma_f32_16x16x32_bf16 v[52:55], a[40:43], v[148:151], v[52:55]
    ds_read_b64_tr_b16 v[136:137], v24 offset:10368
    v_mfma_f32_16x16x32_bf16 v[72:75], a[44:47], v[148:151], v[72:75]
    ds_read_b64_tr_b16 v[138:139], v24 offset:12928
    v_mfma_f32_16x16x32_bf16 v[92:95], v[40:43], v[148:151], v[92:95]
    buffer_load_dwordx4 v6, s[12:15], s41 offen  lds
    v_mfma_f32_16x16x32_bf16 v[56:59], a[40:43], v[152:155], v[56:59]
    s_add_u32 m0, s54, 4096
    v_mfma_f32_16x16x32_bf16 v[76:79], a[44:47], v[152:155], v[76:79]
    s_add_u32 s40, s47, 128
    v_mfma_f32_16x16x32_bf16 v[96:99], v[40:43], v[152:155], v[96:99]
    buffer_load_dwordx4 v2, s[8:11], s40 offen  lds
    v_mfma_f32_16x16x32_bf16 v[60:63], a[40:43], v[156:159], v[60:63]
    s_add_u32 m0, s54, 5120
    v_mfma_f32_16x16x32_bf16 v[80:83], a[44:47], v[156:159], v[80:83]
    s_add_u32 s40, s47, 128
    v_mfma_f32_16x16x32_bf16 v[100:103], v[40:43], v[156:159], v[100:103]
    buffer_load_dwordx4 v3, s[8:11], s40 offen  lds
    s_waitcnt lgkmcnt(0)
    v_mfma_f32_16x16x32_bf16 v[104:107], a[48:51], v[40:43], v[104:107]
    ds_read_b128 a[56:59], v23 offset:4096
    s_add_u32 m0, s55, 35840
    v_mfma_f32_16x16x32_bf16 v[112:115], a[48:51], a[48:51], v[112:115]
    ds_read_b128 a[60:63], v23 offset:6144
    v_mfma_f32_16x16x32_bf16 v[108:111], a[52:55], v[40:43], v[108:111]
    ds_read_b64_tr_b16 v[140:141], v24 offset:15360
    v_mfma_f32_16x16x32_bf16 v[116:119], a[52:55], a[52:55], v[116:119]
    ds_read_b64_tr_b16 v[142:143], v24 offset:17920
    s_nop 0
    v_mfma_f32_16x16x32_bf16 v[44:47], a[48:51], v[120:123], v[44:47]
    ds_read_b64_tr_b16 v[144:145], v24 offset:15392
    v_mfma_f32_16x16x32_bf16 v[64:67], a[52:55], v[120:123], v[64:67]
    ds_read_b64_tr_b16 v[146:147], v24 offset:17952
    v_mfma_f32_16x16x32_bf16 v[84:87], v[40:43], v[120:123], v[84:87]
    ds_read_b64_tr_b16 v[148:149], v24 offset:15424
    v_mfma_f32_16x16x32_bf16 v[48:51], a[48:51], v[124:127], v[48:51]
    ds_read_b64_tr_b16 v[150:151], v24 offset:17984
    buffer_load_dwordx4 v7, s[12:15], s41 offen  lds
    v_mfma_f32_16x16x32_bf16 v[68:71], a[52:55], v[124:127], v[68:71]
    ds_read_b64_tr_b16 v[152:153], v24 offset:15456
    v_mfma_f32_16x16x32_bf16 v[88:91], v[40:43], v[124:127], v[88:91]
    ds_read_b64_tr_b16 v[154:155], v24 offset:18016
    v_mfma_f32_16x16x32_bf16 v[52:55], a[48:51], v[128:131], v[52:55]
    ds_read_b64_tr_b16 v[156:157], v24 offset:15488
    v_mfma_f32_16x16x32_bf16 v[72:75], a[52:55], v[128:131], v[72:75]
    ds_read_b64_tr_b16 v[158:159], v24 offset:18048
    s_add_u32 m0, s54, 6144
    v_mfma_f32_16x16x32_bf16 v[92:95], v[40:43], v[128:131], v[92:95]
    s_add_u32 s40, s47, 20608
    v_mfma_f32_16x16x32_bf16 v[56:59], a[48:51], v[132:135], v[56:59]
    buffer_load_dwordx4 v2, s[8:11], s40 offen  lds
    v_mfma_f32_16x16x32_bf16 v[76:79], a[52:55], v[132:135], v[76:79]
    s_add_u32 m0, s55, 36864
    v_mfma_f32_16x16x32_bf16 v[96:99], v[40:43], v[132:135], v[96:99]
    s_nop 0
    buffer_load_dwordx4 v8, s[12:15], s41 offen  lds
    v_mfma_f32_16x16x32_bf16 v[60:63], a[48:51], v[136:139], v[60:63]
    s_add_u32 m0, s54, 7168
    v_mfma_f32_16x16x32_bf16 v[80:83], a[52:55], v[136:139], v[80:83]
    s_add_u32 s40, s47, 20608
    v_mfma_f32_16x16x32_bf16 v[100:103], v[40:43], v[136:139], v[100:103]
    buffer_load_dwordx4 v3, s[8:11], s40 offen  lds
    s_waitcnt lgkmcnt(0)
    s_waitcnt vmcnt(13)
    s_barrier
    v_add_u32 v22, 53248, v22
    v_add_u32 v23, 53248, v23
    v_add_u32 v24, 53248, v24
    s_add_u32 s62, s54, 53248
    v_lshlrev_b32 v21, 4, v0
    v_add_u32 v26, s62, v21
    s_waitcnt vmcnt(18)
    ds_write_b128 v26, a[160:163] offset:0
    ds_write_b128 v26, a[164:167] offset:1024
    ds_write_b128 v26, a[168:171] offset:2048
    ds_write_b128 v26, a[172:175] offset:3072
    ds_write_b128 v26, a[176:179] offset:4096
    s_cmp_lt_u32 s36, 2
    s_cbranch_scc0 J_25
    ds_write_b128 v26, a[180:183] offset:5120
    ds_write_b128 v26, a[184:187] offset:6144
    ds_write_b128 v26, a[188:191] offset:7168
    v_lshrrev_b32 v26, 2, v0
    v_lshlrev_b32 v26, 7, v26
    v_and_b32 v27, 1, v0
    v_lshl_add_u32 v26, v27, 3, v26
    v_bfe_u32 v27, v0, 1, 1
    v_mul_u32_u24 v27, 4160, v27
    v_bfe_u32 v28, v0, 3, 2
    v_lshl_add_u32 v27, v28, 4, v27
    v_add3_u32 v26, v26, v27, s62
    v_xor_b32 v27, 0, v26
    ds_read_b64_tr_b16 a[212:213], v27 offset:0
    ds_read_b64_tr_b16 a[214:215], v27 offset:2048
    v_xor_b32 v28, 16, v26
    ds_read_b64_tr_b16 a[216:217], v28 offset:0
    ds_read_b64_tr_b16 a[218:219], v28 offset:2048
    v_xor_b32 v27, 32, v26
    ds_read_b64_tr_b16 a[220:221], v27 offset:0
    ds_read_b64_tr_b16 a[222:223], v27 offset:2048
    v_xor_b32 v28, 48, v26
    ds_read_b64_tr_b16 a[224:225], v28 offset:0
    ds_read_b64_tr_b16 a[226:227], v28 offset:2048
    v_xor_b32 v27, 64, v26
    ds_read_b64_tr_b16 a[228:229], v27 offset:0
    ds_read_b64_tr_b16 a[230:231], v27 offset:2048
    v_xor_b32 v28, 80, v26
    ds_read_b64_tr_b16 a[232:233], v28 offset:0
    ds_read_b64_tr_b16 a[234:235], v28 offset:2048
    v_xor_b32 v27, 96, v26
    ds_read_b64_tr_b16 a[236:237], v27 offset:0
    ds_read_b64_tr_b16 a[238:239], v27 offset:2048
    v_xor_b32 v28, 112, v26
    ds_read_b64_tr_b16 a[240:241], v28 offset:0
    ds_read_b64_tr_b16 a[242:243], v28 offset:2048
    v_and_b32 v21, 0x31, v0
    v_bfe_u32 v30, v0, 1, 2
    v_lshl_add_u32 v21, v30, 2, v21
    v_bfe_u32 v30, v0, 3, 1
    v_lshl_add_u32 v21, v30, 1, v21
    v_lshlrev_b32 v21, 4, v21
    s_branch J_26
J_25:
    v_add_u32 v26, s62, v25
    ds_read_b64_tr_b16 a[212:213], v26 offset:0
    ds_read_b64_tr_b16 a[214:215], v26 offset:2560
    ds_read_b64_tr_b16 a[216:217], v26 offset:32
    ds_read_b64_tr_b16 a[218:219], v26 offset:2592
    ds_read_b64_tr_b16 a[220:221], v26 offset:64
    ds_read_b64_tr_b16 a[222:223], v26 offset:2624
    ds_read_b64_tr_b16 a[224:225], v26 offset:96
    ds_read_b64_tr_b16 a[226:227], v26 offset:2656
    ds_read_b64_tr_b16 a[228:229], v26 offset:128
    ds_read_b64_tr_b16 a[230:231], v26 offset:2688
J_26:
    v_mfma_f32_16x16x32_bf16 v[104:107], a[56:59], v[40:43], v[104:107]
    ds_read_b128 a[64:67], v22 offset:0
    s_mul_i32 s41, s36, 122880
    v_mfma_f32_16x16x32_bf16 v[112:115], a[56:59], a[56:59], v[112:115]
    ds_read_b128 a[68:71], v22 offset:2048
    v_mfma_f32_16x16x32_bf16 v[108:111], a[60:63], v[40:43], v[108:111]
    ds_read_b64_tr_b16 v[120:121], v24 offset:0
    v_mfma_f32_16x16x32_bf16 v[116:119], a[60:63], a[60:63], v[116:119]
    ds_read_b64_tr_b16 v[122:123], v24 offset:2560
    s_add_u32 s41, s41, s53
    v_mfma_f32_16x16x32_bf16 v[44:47], a[56:59], v[140:143], v[44:47]
    ds_read_b64_tr_b16 v[124:125], v24 offset:32
    v_mfma_f32_16x16x32_bf16 v[64:67], a[60:63], v[140:143], v[64:67]
    ds_read_b64_tr_b16 v[126:127], v24 offset:2592
    v_mfma_f32_16x16x32_bf16 v[84:87], v[40:43], v[140:143], v[84:87]
    ds_read_b64_tr_b16 v[128:129], v24 offset:64
    v_mfma_f32_16x16x32_bf16 v[48:51], a[56:59], v[144:147], v[48:51]
    ds_read_b64_tr_b16 v[130:131], v24 offset:2624
    s_add_u32 s41, s41, 1280
    v_mfma_f32_16x16x32_bf16 v[68:71], a[60:63], v[144:147], v[68:71]
    ds_read_b64_tr_b16 v[132:133], v24 offset:96
    v_mfma_f32_16x16x32_bf16 v[88:91], v[40:43], v[144:147], v[88:91]
    ds_read_b64_tr_b16 v[134:135], v24 offset:2656
    v_mfma_f32_16x16x32_bf16 v[52:55], a[56:59], v[148:151], v[52:55]
    ds_read_b64_tr_b16 v[136:137], v24 offset:128
    v_mfma_f32_16x16x32_bf16 v[72:75], a[60:63], v[148:151], v[72:75]
    ds_read_b64_tr_b16 v[138:139], v24 offset:2688
    s_add_u32 m0, s55, 86016
    v_mfma_f32_16x16x32_bf16 v[92:95], v[40:43], v[148:151], v[92:95]
    s_nop 0
    v_mfma_f32_16x16x32_bf16 v[56:59], a[56:59], v[152:155], v[56:59]
    buffer_load_dwordx4 v4, s[12:15], s41 offen  lds
    v_mfma_f32_16x16x32_bf16 v[76:79], a[60:63], v[152:155], v[76:79]
    s_add_u32 m0, s55, 87040
    v_mfma_f32_16x16x32_bf16 v[96:99], v[40:43], v[152:155], v[96:99]
    s_nop 0
    buffer_load_dwordx4 v5, s[12:15], s41 offen  lds
    v_mfma_f32_16x16x32_bf16 v[60:63], a[56:59], v[156:159], v[60:63]
    s_add_u32 m0, s55, 88064
    v_mfma_f32_16x16x32_bf16 v[80:83], a[60:63], v[156:159], v[80:83]
    s_nop 0
    v_mfma_f32_16x16x32_bf16 v[100:103], v[40:43], v[156:159], v[100:103]
    buffer_load_dwordx4 v6, s[12:15], s41 offen  lds
    s_waitcnt lgkmcnt(0)
    v_mfma_f32_16x16x32_bf16 v[104:107], a[64:67], v[40:43], v[104:107]
    ds_read_b128 a[72:75], v23 offset:0
    s_add_u32 m0, s54, 53248
    v_mfma_f32_16x16x32_bf16 v[112:115], a[64:67], a[64:67], v[112:115]
    ds_read_b128 a[76:79], v23 offset:2048
    v_mfma_f32_16x16x32_bf16 v[108:111], a[68:71], v[40:43], v[108:111]
    ds_read_b64_tr_b16 v[140:141], v24 offset:5120
    v_mfma_f32_16x16x32_bf16 v[116:119], a[68:71], a[68:71], v[116:119]
    ds_read_b64_tr_b16 v[142:143], v24 offset:7680
    v_mfma_f32_16x16x32_bf16 v[44:47], a[64:67], v[120:123], v[44:47]
    ds_read_b64_tr_b16 v[144:145], v24 offset:5152
    v_mfma_f32_16x16x32_bf16 v[64:67], a[68:71], v[120:123], v[64:67]
    ds_read_b64_tr_b16 v[146:147], v24 offset:7712
    v_mfma_f32_16x16x32_bf16 v[84:87], v[40:43], v[120:123], v[84:87]
    ds_read_b64_tr_b16 v[148:149], v24 offset:5184
    v_mfma_f32_16x16x32_bf16 v[48:51], a[64:67], v[124:127], v[48:51]
    ds_read_b64_tr_b16 v[150:151], v24 offset:7744
    v_mfma_f32_16x16x32_bf16 v[68:71], a[68:71], v[124:127], v[68:71]
    ds_read_b64_tr_b16 v[152:153], v24 offset:5216
    v_mfma_f32_16x16x32_bf16 v[88:91], v[40:43], v[124:127], v[88:91]
    ds_read_b64_tr_b16 v[154:155], v24 offset:7776
    s_add_u32 s40, s48, 0
    v_mfma_f32_16x16x32_bf16 v[52:55], a[64:67], v[128:131], v[52:55]
    ds_read_b64_tr_b16 v[156:157], v24 offset:5248
    v_mfma_f32_16x16x32_bf16 v[72:75], a[68:71], v[128:131], v[72:75]
    ds_read_b64_tr_b16 v[158:159], v24 offset:7808
    v_mfma_f32_16x16x32_bf16 v[92:95], v[40:43], v[128:131], v[92:95]
    buffer_load_dwordx4 v2, s[8:11], s40 offen  lds
    v_mfma_f32_16x16x32_bf16 v[56:59], a[64:67], v[132:135], v[56:59]
    s_add_u32 m0, s54, 54272
    v_mfma_f32_16x16x32_bf16 v[76:79], a[68:71], v[132:135], v[76:79]
    s_add_u32 s40, s48, 0
    v_mfma_f32_16x16x32_bf16 v[96:99], v[40:43], v[132:135], v[96:99]
    buffer_load_dwordx4 v3, s[8:11], s40 offen  lds
    v_mfma_f32_16x16x32_bf16 v[60:63], a[64:67], v[136:139], v[60:63]
    s_add_u32 m0, s54, 55296
    v_mfma_f32_16x16x32_bf16 v[80:83], a[68:71], v[136:139], v[80:83]
    s_add_u32 s40, s48, 20480
    v_mfma_f32_16x16x32_bf16 v[100:103], v[40:43], v[136:139], v[100:103]
    buffer_load_dwordx4 v2, s[8:11], s40 offen  lds
    s_waitcnt lgkmcnt(0)
    v_mfma_f32_16x16x32_bf16 v[104:107], a[72:75], v[40:43], v[104:107]
    ds_read_b128 a[80:83], v22 offset:4096
    s_add_u32 m0, s54, 56320
    v_mfma_f32_16x16x32_bf16 v[112:115], a[72:75], a[72:75], v[112:115]
    ds_read_b128 a[84:87], v22 offset:6144
    v_mfma_f32_16x16x32_bf16 v[108:111], a[76:79], v[40:43], v[108:111]
    ds_read_b64_tr_b16 v[120:121], v24 offset:10240
    v_mfma_f32_16x16x32_bf16 v[116:119], a[76:79], a[76:79], v[116:119]
    ds_read_b64_tr_b16 v[122:123], v24 offset:12800
    v_mfma_f32_16x16x32_bf16 v[44:47], a[72:75], v[140:143], v[44:47]
    ds_read_b64_tr_b16 v[124:125], v24 offset:10272
    v_mfma_f32_16x16x32_bf16 v[64:67], a[76:79], v[140:143], v[64:67]
    ds_read_b64_tr_b16 v[126:127], v24 offset:12832
    v_mfma_f32_16x16x32_bf16 v[84:87], v[40:43], v[140:143], v[84:87]
    ds_read_b64_tr_b16 v[128:129], v24 offset:10304
    s_add_u32 s40, s48, 20480
    v_mfma_f32_16x16x32_bf16 v[48:51], a[72:75], v[144:147], v[48:51]
    ds_read_b64_tr_b16 v[130:131], v24 offset:12864
    v_mfma_f32_16x16x32_bf16 v[68:71], a[76:79], v[144:147], v[68:71]
    ds_read_b64_tr_b16 v[132:133], v24 offset:10336
    v_mfma_f32_16x16x32_bf16 v[88:91], v[40:43], v[144:147], v[88:91]
    ds_read_b64_tr_b16 v[134:135], v24 offset:12896
    v_mfma_f32_16x16x32_bf16 v[52:55], a[72:75], v[148:151], v[52:55]
    ds_read_b64_tr_b16 v[136:137], v24 offset:10368
    v_mfma_f32_16x16x32_bf16 v[72:75], a[76:79], v[148:151], v[72:75]
    ds_read_b64_tr_b16 v[138:139], v24 offset:12928
    v_mfma_f32_16x16x32_bf16 v[92:95], v[40:43], v[148:151], v[92:95]
    buffer_load_dwordx4 v3, s[8:11], s40 offen  lds
    s_add_u32 m0, s54, 57344
    v_mfma_f32_16x16x32_bf16 v[56:59], a[72:75], v[152:155], v[56:59]
    s_add_u32 s40, s48, 128
    v_mfma_f32_16x16x32_bf16 v[76:79], a[76:79], v[152:155], v[76:79]
    buffer_load_dwordx4 v2, s[8:11], s40 offen  lds
    v_mfma_f32_16x16x32_bf16 v[96:99], v[40:43], v[152:155], v[96:99]
    s_add_u32 m0, s55, 89088
    v_mfma_f32_16x16x32_bf16 v[60:63], a[72:75], v[156:159], v[60:63]
    s_nop 0
    v_mfma_f32_16x16x32_bf16 v[80:83], a[76:79], v[156:159], v[80:83]
    buffer_load_dwordx4 v7, s[12:15], s41 offen  lds
    v_mfma_f32_16x16x32_bf16 v[100:103], v[40:43], v[156:159], v[100:103]
    s_or_b32 s63, s98, s100
    s_cbranch_scc0 K_27
    buffer_store_dwordx4 a[212:215], v21, s[16:19], s59 offen offset:0 sc0 sc1
K_27:
    s_waitcnt lgkmcnt(0)
    v_mfma_f32_16x16x32_bf16 v[104:107], a[80:83], v[40:43], v[104:107]
    ds_read_b128 a[88:91], v23 offset:4096
    s_add_u32 m0, s54, 58368
    v_mfma_f32_16x16x32_bf16 v[112:115], a[80:83], a[80:83], v[112:115]
    ds_read_b128 a[92:95], v23 offset:6144
    v_mfma_f32_16x16x32_bf16 v[108:111], a[84:87], v[40:43], v[108:111]
    ds_read_b64_tr_b16 v[140:141], v24 offset:15360
    v_mfma_f32_16x16x32_bf16 v[116:119], a[84:87], a[84:87], v[116:119]
    ds_read_b64_tr_b16 v[142:143], v24 offset:17920
    s_add_u32 s40, s48, 128
    v_mfma_f32_16x16x32_bf16 v[44:47], a[80:83], v[120:123], v[44:47]
    ds_read_b64_tr_b16 v[144:145], v24 offset:15392
    v_mfma_f32_16x16x32_bf16 v[64:67], a[84:87], v[120:123], v[64:67]
    ds_read_b64_tr_b16 v[146:147], v24 offset:17952
    v_mfma_f32_16x16x32_bf16 v[84:87], v[40:43], v[120:123], v[84:87]
    ds_read_b64_tr_b16 v[148:149], v24 offset:15424
    buffer_load_dwordx4 v3, s[8:11], s40 offen  lds
    v_mfma_f32_16x16x32_bf16 v[48:51], a[80:83], v[124:127], v[48:51]
    ds_read_b64_tr_b16 v[150:151], v24 offset:17984
    v_mfma_f32_16x16x32_bf16 v[68:71], a[84:87], v[124:127], v[68:71]
    ds_read_b64_tr_b16 v[152:153], v24 offset:15456
    v_mfma_f32_16x16x32_bf16 v[88:91], v[40:43], v[124:127], v[88:91]
    ds_read_b64_tr_b16 v[154:155], v24 offset:18016
    s_add_u32 m0, s54, 59392
    v_mfma_f32_16x16x32_bf16 v[52:55], a[80:83], v[128:131], v[52:55]
    ds_read_b64_tr_b16 v[156:157], v24 offset:15488
    v_mfma_f32_16x16x32_bf16 v[72:75], a[84:87], v[128:131], v[72:75]
    ds_read_b64_tr_b16 v[158:159], v24 offset:18048
    v_mfma_f32_16x16x32_bf16 v[92:95], v[40:43], v[128:131], v[92:95]
    s_add_u32 s40, s48, 20608
    buffer_load_dwordx4 v2, s[8:11], s40 offen  lds
    v_mfma_f32_16x16x32_bf16 v[56:59], a[80:83], v[132:135], v[56:59]
    s_add_u32 m0, s55, 90112
    v_mfma_f32_16x16x32_bf16 v[76:79], a[84:87], v[132:135], v[76:79]
    s_nop 0
    v_mfma_f32_16x16x32_bf16 v[96:99], v[40:43], v[132:135], v[96:99]
    buffer_load_dwordx4 v8, s[12:15], s41 offen  lds
    s_add_u32 m0, s54, 60416
    v_mfma_f32_16x16x32_bf16 v[60:63], a[80:83], v[136:139], v[60:63]
    s_add_u32 s40, s48, 20608
    v_mfma_f32_16x16x32_bf16 v[80:83], a[84:87], v[136:139], v[80:83]
    buffer_load_dwordx4 v3, s[8:11], s40 offen  lds
    v_mfma_f32_16x16x32_bf16 v[100:103], v[40:43], v[136:139], v[100:103]
    s_or_b32 s63, s98, s100
    s_cbranch_scc0 K_28
    buffer_store_dwordx4 a[216:219], v21, s[16:19], s59 offen offset:1024 sc0 sc1
K_28:
    s_waitcnt lgkmcnt(0)
    s_cmp_lg_u32 s98, 0
    s_cbranch_scc1 K_35
    s_cmp_lg_u32 s100, 0
    s_cbranch_scc1 K_36
    s_waitcnt vmcnt(13)
K_36:
    s_waitcnt vmcnt(15)
K_35:
    s_waitcnt vmcnt(15)
    s_barrier
    v_add_u32 v22, 4294860800, v22
    v_add_u32 v23, 4294860800, v23
    v_add_u32 v24, 4294860800, v24
    v_mfma_f32_16x16x32_bf16 v[104:107], a[88:91], v[40:43], v[104:107]
    ds_read_b128 a[96:99], v22 offset:0
    s_cmp_ge_u32 s36, 2
    v_mfma_f32_16x16x32_bf16 v[112:115], a[88:91], a[88:91], v[112:115]
    ds_read_b128 a[100:103], v22 offset:2048
    s_cselect_b32 s41, s50, s49
    v_mfma_f32_16x16x32_bf16 v[108:111], a[92:95], v[40:43], v[108:111]
    ds_read_b64_tr_b16 v[120:121], v24 offset:0
    s_and_b32 s42, s36, 1
    v_mfma_f32_16x16x32_bf16 v[116:119], a[92:95], a[92:95], v[116:119]
    ds_read_b64_tr_b16 v[122:123], v24 offset:2560
    s_mul_i32 s42, s42, 245760
    v_mfma_f32_16x16x32_bf16 v[44:47], a[88:91], v[140:143], v[44:47]
    ds_read_b64_tr_b16 v[124:125], v24 offset:32
    s_add_u32 s41, s41, s42
    v_mfma_f32_16x16x32_bf16 v[64:67], a[92:95], v[140:143], v[64:67]
    ds_read_b64_tr_b16 v[126:127], v24 offset:2592
    s_add_u32 s41, s41, s56
    v_mfma_f32_16x16x32_bf16 v[84:87], v[40:43], v[140:143], v[84:87]
    ds_read_b64_tr_b16 v[128:129], v24 offset:64
    v_mfma_f32_16x16x32_bf16 v[48:51], a[88:91], v[144:147], v[48:51]
    ds_read_b64_tr_b16 v[130:131], v24 offset:2624
    s_add_u32 m0, s55, 106496
    v_mfma_f32_16x16x32_bf16 v[68:71], a[92:95], v[144:147], v[68:71]
    ds_read_b64_tr_b16 v[132:133], v24 offset:96
    s_nop 0
    v_mfma_f32_16x16x32_bf16 v[88:91], v[40:43], v[144:147], v[88:91]
    ds_read_b64_tr_b16 v[134:135], v24 offset:2656
    buffer_load_dwordx4 v9, s[12:15], s41 offen  lds
    v_mfma_f32_16x16x32_bf16 v[52:55], a[88:91], v[148:151], v[52:55]
    ds_read_b64_tr_b16 v[136:137], v24 offset:128
    s_lshr_b32 s37, s35, 1
    v_mfma_f32_16x16x32_bf16 v[72:75], a[92:95], v[148:151], v[72:75]
    ds_read_b64_tr_b16 v[138:139], v24 offset:2688
    s_and_b32 s62, s35, 1
    v_mfma_f32_16x16x32_bf16 v[92:95], v[40:43], v[148:151], v[92:95]
    s_lshl1_add_u32 s62, s34, s62
    v_mfma_f32_16x16x32_bf16 v[56:59], a[88:91], v[152:155], v[56:59]
    s_lshl_b32 s62, s62, 2
    s_add_u32 s38, s62, s36
    v_mfma_f32_16x16x32_bf16 v[76:79], a[92:95], v[152:155], v[76:79]
    s_mul_i32 s62, s38, 20480
    s_mul_i32 s5, s37, 160
    v_mfma_f32_16x16x32_bf16 v[96:99], v[40:43], v[152:155], v[96:99]
    s_add_u32 s39, s62, s5
    s_mul_i32 s4, s36, 5120
    v_mfma_f32_16x16x32_bf16 v[60:63], a[88:91], v[156:159], v[60:63]
    v_lshlrev_b32 v2, 4, v0
    v_and_b32 v3, 15, v0
    v_mfma_f32_16x16x32_bf16 v[80:83], a[92:95], v[156:159], v[80:83]
    v_mul_u32_u24 v3, 1280, v3
    v_lshrrev_b32 v26, 4, v0
    v_mfma_f32_16x16x32_bf16 v[100:103], v[40:43], v[156:159], v[100:103]
    v_lshl_add_u32 v3, v26, 3, v3
    s_waitcnt lgkmcnt(0)
    v_mfma_f32_16x16x32_bf16 v[104:107], a[96:99], v[40:43], v[104:107]
    ds_read_b128 a[104:107], v23 offset:0
    s_add_u32 m0, s55, 107520
    v_mfma_f32_16x16x32_bf16 v[112:115], a[96:99], a[96:99], v[112:115]
    ds_read_b128 a[108:111], v23 offset:2048
    s_nop 0
    v_mfma_f32_16x16x32_bf16 v[108:111], a[100:103], v[40:43], v[108:111]
    ds_read_b64_tr_b16 v[140:141], v24 offset:5120
    buffer_load_dwordx4 v10, s[12:15], s41 offen  lds
    v_mfma_f32_16x16x32_bf16 v[116:119], a[100:103], a[100:103], v[116:119]
    ds_read_b64_tr_b16 v[142:143], v24 offset:7680
    v_mfma_f32_16x16x32_bf16 v[44:47], a[96:99], v[120:123], v[44:47]
    ds_read_b64_tr_b16 v[144:145], v24 offset:5152
    v_add_u32 v26, 0, v0
    v_mfma_f32_16x16x32_bf16 v[64:67], a[100:103], v[120:123], v[64:67]
    ds_read_b64_tr_b16 v[146:147], v24 offset:7712
    s_add_u32 m0, s55, 108544
    v_mfma_f32_16x16x32_bf16 v[84:87], v[40:43], v[120:123], v[84:87]
    ds_read_b64_tr_b16 v[148:149], v24 offset:5184
    v_mfma_f32_16x16x32_bf16 v[48:51], a[96:99], v[124:127], v[48:51]
    ds_read_b64_tr_b16 v[150:151], v24 offset:7744
    s_nop 0
    v_mfma_f32_16x16x32_bf16 v[68:71], a[100:103], v[124:127], v[68:71]
    ds_read_b64_tr_b16 v[152:153], v24 offset:5216
    buffer_load_dwordx4 v11, s[12:15], s41 offen  lds
    v_mfma_f32_16x16x32_bf16 v[88:91], v[40:43], v[124:127], v[88:91]
    ds_read_b64_tr_b16 v[154:155], v24 offset:7776
    v_mfma_f32_16x16x32_bf16 v[52:55], a[96:99], v[128:131], v[52:55]
    ds_read_b64_tr_b16 v[156:157], v24 offset:5248
    v_mul_u32_u24 v28, 6554, v26
    v_mfma_f32_16x16x32_bf16 v[72:75], a[100:103], v[128:131], v[72:75]
    ds_read_b64_tr_b16 v[158:159], v24 offset:7808
    s_or_b32 s63, s98, s100
    s_cbranch_scc0 K_29
    buffer_store_dwordx4 a[220:223], v21, s[16:19], s59 offen offset:2048 sc0 sc1
K_29:
    v_mfma_f32_16x16x32_bf16 v[92:95], v[40:43], v[128:131], v[92:95]
    v_lshrrev_b32 v28, 16, v28
    v_mfma_f32_16x16x32_bf16 v[56:59], a[96:99], v[132:135], v[56:59]
    v_mul_u32_u24 v27, 10, v28
    v_sub_u32 v27, v26, v27
    v_mfma_f32_16x16x32_bf16 v[76:79], a[100:103], v[132:135], v[76:79]
    v_bfe_u32 v29, v28, 2, 2
    v_mul_u32_u24 v29, 4, v29
    v_mfma_f32_16x16x32_bf16 v[96:99], v[40:43], v[132:135], v[96:99]
    v_lshrrev_b32 v30, 4, v28
    v_mfma_f32_16x16x32_bf16 v[60:63], a[96:99], v[136:139], v[60:63]
    v_mad_u32_u24 v29, 16, v30, v29
    v_and_b32 v30, 3, v28
    v_mfma_f32_16x16x32_bf16 v[80:83], a[100:103], v[136:139], v[80:83]
    v_add_u32 v29, v29, v30
    v_mul_u32_u24 v29, 1280, v29
    v_mfma_f32_16x16x32_bf16 v[100:103], v[40:43], v[136:139], v[100:103]
    v_lshl_add_u32 v4, v27, 4, v29
    s_waitcnt lgkmcnt(0)
    v_mfma_f32_16x16x32_bf16 v[104:107], a[104:107], v[40:43], v[104:107]
    ds_read_b128 a[112:115], v22 offset:4096
    s_add_u32 m0, s55, 109568
    v_mfma_f32_16x16x32_bf16 v[112:115], a[104:107], a[104:107], v[112:115]
    ds_read_b128 a[116:119], v22 offset:6144
    s_nop 0
    v_mfma_f32_16x16x32_bf16 v[108:111], a[108:111], v[40:43], v[108:111]
    ds_read_b64_tr_b16 v[120:121], v24 offset:10240
    buffer_load_dwordx4 v12, s[12:15], s41 offen  lds
    v_mfma_f32_16x16x32_bf16 v[116:119], a[108:111], a[108:111], v[116:119]
    ds_read_b64_tr_b16 v[122:123], v24 offset:12800
    v_mfma_f32_16x16x32_bf16 v[44:47], a[104:107], v[140:143], v[44:47]
    ds_read_b64_tr_b16 v[124:125], v24 offset:10272
    v_add_u32 v26, 64, v0
    v_mfma_f32_16x16x32_bf16 v[64:67], a[108:111], v[140:143], v[64:67]
    ds_read_b64_tr_b16 v[126:127], v24 offset:12832
    s_add_u32 m0, s55, 110592
    v_mfma_f32_16x16x32_bf16 v[84:87], v[40:43], v[140:143], v[84:87]
    ds_read_b64_tr_b16 v[128:129], v24 offset:10304
    v_mfma_f32_16x16x32_bf16 v[48:51], a[104:107], v[144:147], v[48:51]
    ds_read_b64_tr_b16 v[130:131], v24 offset:12864
    s_nop 0
    v_mfma_f32_16x16x32_bf16 v[68:71], a[108:111], v[144:147], v[68:71]
    ds_read_b64_tr_b16 v[132:133], v24 offset:10336
    buffer_load_dwordx4 v13, s[12:15], s41 offen  lds
    v_mfma_f32_16x16x32_bf16 v[88:91], v[40:43], v[144:147], v[88:91]
    ds_read_b64_tr_b16 v[134:135], v24 offset:12896
    v_mfma_f32_16x16x32_bf16 v[52:55], a[104:107], v[148:151], v[52:55]
    ds_read_b64_tr_b16 v[136:137], v24 offset:10368
    v_mul_u32_u24 v28, 6554, v26
    v_mfma_f32_16x16x32_bf16 v[72:75], a[108:111], v[148:151], v[72:75]
    ds_read_b64_tr_b16 v[138:139], v24 offset:12928
    s_or_b32 s63, s98, s100
    s_cbranch_scc0 K_30
    buffer_store_dwordx4 a[224:227], v21, s[16:19], s59 offen offset:3072 sc0 sc1
K_30:
    v_mfma_f32_16x16x32_bf16 v[92:95], v[40:43], v[148:151], v[92:95]
    v_lshrrev_b32 v28, 16, v28
    v_mfma_f32_16x16x32_bf16 v[56:59], a[104:107], v[152:155], v[56:59]
    v_mul_u32_u24 v27, 10, v28
    v_sub_u32 v27, v26, v27
    v_mfma_f32_16x16x32_bf16 v[76:79], a[108:111], v[152:155], v[76:79]
    v_bfe_u32 v29, v28, 2, 2
    v_mul_u32_u24 v29, 4, v29
    v_mfma_f32_16x16x32_bf16 v[96:99], v[40:43], v[152:155], v[96:99]
    v_lshrrev_b32 v30, 4, v28
    v_mfma_f32_16x16x32_bf16 v[60:63], a[104:107], v[156:159], v[60:63]
    v_mad_u32_u24 v29, 16, v30, v29
    v_and_b32 v30, 3, v28
    v_mfma_f32_16x16x32_bf16 v[80:83], a[108:111], v[156:159], v[80:83]
    v_add_u32 v29, v29, v30
    v_mul_u32_u24 v29, 1280, v29
    v_mfma_f32_16x16x32_bf16 v[100:103], v[40:43], v[156:159], v[100:103]
    v_lshl_add_u32 v5, v27, 4, v29
    s_waitcnt lgkmcnt(0)
    v_mfma_f32_16x16x32_bf16 v[104:107], a[112:115], v[40:43], v[104:107]
    ds_read_b128 a[120:123], v23 offset:4096
    s_cmp_ge_u32 s36, 2
    v_mfma_f32_16x16x32_bf16 v[112:115], a[112:115], a[112:115], v[112:115]
    ds_read_b128 a[124:127], v23 offset:6144
    s_cselect_b32 s41, s52, s51
    v_mfma_f32_16x16x32_bf16 v[108:111], a[116:119], v[40:43], v[108:111]
    ds_read_b64_tr_b16 v[140:141], v24 offset:15360
    s_and_b32 s42, s36, 1
    v_mfma_f32_16x16x32_bf16 v[116:119], a[116:119], a[116:119], v[116:119]
    ds_read_b64_tr_b16 v[142:143], v24 offset:17920
    s_mul_i32 s42, s42, 245760
    v_mfma_f32_16x16x32_bf16 v[44:47], a[112:115], v[120:123], v[44:47]
    ds_read_b64_tr_b16 v[144:145], v24 offset:15392
    s_add_u32 s41, s41, s42
    v_mfma_f32_16x16x32_bf16 v[64:67], a[116:119], v[120:123], v[64:67]
    ds_read_b64_tr_b16 v[146:147], v24 offset:17952
    s_add_u32 s41, s41, s56
    v_mfma_f32_16x16x32_bf16 v[84:87], v[40:43], v[120:123], v[84:87]
    ds_read_b64_tr_b16 v[148:149], v24 offset:15424
    s_add_u32 m0, s55, 126976
    v_mfma_f32_16x16x32_bf16 v[48:51], a[112:115], v[124:127], v[48:51]
    ds_read_b64_tr_b16 v[150:151], v24 offset:17984
    s_nop 0
    v_mfma_f32_16x16x32_bf16 v[68:71], a[116:119], v[124:127], v[68:71]
    ds_read_b64_tr_b16 v[152:153], v24 offset:15456
    buffer_load_dwordx4 v9, s[12:15], s41 offen  lds
    v_mfma_f32_16x16x32_bf16 v[88:91], v[40:43], v[124:127], v[88:91]
    ds_read_b64_tr_b16 v[154:155], v24 offset:18016
    v_add_u32 v26, 128, v0
    v_mfma_f32_16x16x32_bf16 v[52:55], a[112:115], v[128:131], v[52:55]
    ds_read_b64_tr_b16 v[156:157], v24 offset:15488
    s_add_u32 m0, s55, 128000
    v_mfma_f32_16x16x32_bf16 v[72:75], a[116:119], v[128:131], v[72:75]
    ds_read_b64_tr_b16 v[158:159], v24 offset:18048
    s_nop 0
    v_mfma_f32_16x16x32_bf16 v[92:95], v[40:43], v[128:131], v[92:95]
    buffer_load_dwordx4 v10, s[12:15], s41 offen  lds
    v_mul_u32_u24 v28, 6554, v26
    v_mfma_f32_16x16x32_bf16 v[56:59], a[112:115], v[132:135], v[56:59]
    s_or_b32 s63, s98, s100
    s_cbranch_scc0 K_31
    buffer_store_dwordx4 a[228:231], v21, s[16:19], s58 offen offset:0 sc0 sc1
K_31:
    v_lshrrev_b32 v28, 16, v28
    v_mfma_f32_16x16x32_bf16 v[76:79], a[116:119], v[132:135], v[76:79]
    v_mul_u32_u24 v27, 10, v28
    v_sub_u32 v27, v26, v27
    v_mfma_f32_16x16x32_bf16 v[96:99], v[40:43], v[132:135], v[96:99]
    v_bfe_u32 v29, v28, 2, 2
    v_mul_u32_u24 v29, 4, v29
    v_mfma_f32_16x16x32_bf16 v[60:63], a[112:115], v[136:139], v[60:63]
    v_lshrrev_b32 v30, 4, v28
    v_mad_u32_u24 v29, 16, v30, v29
    v_mfma_f32_16x16x32_bf16 v[80:83], a[116:119], v[136:139], v[80:83]
    v_and_b32 v30, 3, v28
    v_add_u32 v29, v29, v30
    v_mfma_f32_16x16x32_bf16 v[100:103], v[40:43], v[136:139], v[100:103]
    v_mul_u32_u24 v29, 1280, v29
    v_lshl_add_u32 v6, v27, 4, v29
    s_waitcnt lgkmcnt(0)
    s_cmp_lg_u32 s98, 0
    s_cbranch_scc1 K_38
    s_cmp_lg_u32 s100, 0
    s_cbranch_scc1 K_39
    s_waitcnt vmcnt(7)
K_39:
    s_waitcnt vmcnt(11)
K_38:
    s_waitcnt vmcnt(11)
    s_barrier
    v_add_u32 v22, 53248, v22
    v_add_u32 v23, 53248, v23
    v_add_u32 v24, 53248, v24
    v_mfma_f32_16x16x32_bf16 v[104:107], a[120:123], v[40:43], v[104:107]
    ds_read_b128 a[128:131], v22 offset:0
    s_add_u32 m0, s55, 129024
    v_mfma_f32_16x16x32_bf16 v[112:115], a[120:123], a[120:123], v[112:115]
    ds_read_b128 a[132:135], v22 offset:2048
    v_mfma_f32_16x16x32_bf16 v[108:111], a[124:127], v[40:43], v[108:111]
    ds_read_b64_tr_b16 v[120:121], v24 offset:0
    s_nop 0
    v_mfma_f32_16x16x32_bf16 v[116:119], a[124:127], a[124:127], v[116:119]
    ds_read_b64_tr_b16 v[122:123], v24 offset:2560
    v_mfma_f32_16x16x32_bf16 v[44:47], a[120:123], v[140:143], v[44:47]
    ds_read_b64_tr_b16 v[124:125], v24 offset:32
    buffer_load_dwordx4 v11, s[12:15], s41 offen  lds
    v_mfma_f32_16x16x32_bf16 v[64:67], a[124:127], v[140:143], v[64:67]
    ds_read_b64_tr_b16 v[126:127], v24 offset:2592
    v_mfma_f32_16x16x32_bf16 v[84:87], v[40:43], v[140:143], v[84:87]
    ds_read_b64_tr_b16 v[128:129], v24 offset:64
    v_add_u32 v26, 192, v0
    v_mfma_f32_16x16x32_bf16 v[48:51], a[120:123], v[144:147], v[48:51]
    ds_read_b64_tr_b16 v[130:131], v24 offset:2624
    v_mfma_f32_16x16x32_bf16 v[68:71], a[124:127], v[144:147], v[68:71]
    ds_read_b64_tr_b16 v[132:133], v24 offset:96
    v_mul_u32_u24 v28, 6554, v26
    v_mfma_f32_16x16x32_bf16 v[88:91], v[40:43], v[144:147], v[88:91]
    ds_read_b64_tr_b16 v[134:135], v24 offset:2656
    v_mfma_f32_16x16x32_bf16 v[52:55], a[120:123], v[148:151], v[52:55]
    ds_read_b64_tr_b16 v[136:137], v24 offset:128
    v_lshrrev_b32 v28, 16, v28
    v_mfma_f32_16x16x32_bf16 v[72:75], a[124:127], v[148:151], v[72:75]
    ds_read_b64_tr_b16 v[138:139], v24 offset:2688
    v_mfma_f32_16x16x32_bf16 v[92:95], v[40:43], v[148:151], v[92:95]
    v_mul_u32_u24 v27, 10, v28
    v_sub_u32 v27, v26, v27
    v_mfma_f32_16x16x32_bf16 v[56:59], a[120:123], v[152:155], v[56:59]
    v_bfe_u32 v29, v28, 2, 2
    v_mfma_f32_16x16x32_bf16 v[76:79], a[124:127], v[152:155], v[76:79]
    v_mul_u32_u24 v29, 4, v29
    v_lshrrev_b32 v30, 4, v28
    v_mfma_f32_16x16x32_bf16 v[96:99], v[40:43], v[152:155], v[96:99]
    v_mad_u32_u24 v29, 16, v30, v29
    v_mfma_f32_16x16x32_bf16 v[60:63], a[120:123], v[156:159], v[60:63]
    v_and_b32 v30, 3, v28
    v_add_u32 v29, v29, v30
    v_mfma_f32_16x16x32_bf16 v[80:83], a[124:127], v[156:159], v[80:83]
    v_mul_u32_u24 v29, 1280, v29
    v_mfma_f32_16x16x32_bf16 v[100:103], v[40:43], v[156:159], v[100:103]
    v_lshl_add_u32 v7, v27, 4, v29
    s_waitcnt lgkmcnt(0)
    v_mfma_f32_16x16x32_bf16 v[104:107], a[128:131], v[40:43], v[104:107]
    ds_read_b128 a[136:139], v23 offset:0
    s_add_u32 m0, s55, 130048
    v_mfma_f32_16x16x32_bf16 v[112:115], a[128:131], a[128:131], v[112:115]
    ds_read_b128 a[140:143], v23 offset:2048
    s_nop 0
    v_mfma_f32_16x16x32_bf16 v[108:111], a[132:135], v[40:43], v[108:111]
    ds_read_b64_tr_b16 v[140:141], v24 offset:5120
    v_mfma_f32_16x16x32_bf16 v[116:119], a[132:135], a[132:135], v[116:119]
    ds_read_b64_tr_b16 v[142:143], v24 offset:7680
    buffer_load_dwordx4 v12, s[12:15], s41 offen  lds
    v_mfma_f32_16x16x32_bf16 v[44:47], a[128:131], v[120:123], v[44:47]
    ds_read_b64_tr_b16 v[144:145], v24 offset:5152
    v_mfma_f32_16x16x32_bf16 v[64:67], a[132:135], v[120:123], v[64:67]
    ds_read_b64_tr_b16 v[146:147], v24 offset:7712
    v_add_u32 v26, 256, v0
    v_mfma_f32_16x16x32_bf16 v[84:87], v[40:43], v[120:123], v[84:87]
    ds_read_b64_tr_b16 v[148:149], v24 offset:5184
    v_mfma_f32_16x16x32_bf16 v[48:51], a[128:131], v[124:127], v[48:51]
    ds_read_b64_tr_b16 v[150:151], v24 offset:7744
    s_or_b32 s63, s98, 0
    s_cbranch_scc0 K_32
    buffer_store_dwordx4 a[232:235], v21, s[16:19], s58 offen offset:1024 sc0 sc1
K_32:
    v_mfma_f32_16x16x32_bf16 v[68:71], a[132:135], v[124:127], v[68:71]
    ds_read_b64_tr_b16 v[152:153], v24 offset:5216
    v_mfma_f32_16x16x32_bf16 v[88:91], v[40:43], v[124:127], v[88:91]
    ds_read_b64_tr_b16 v[154:155], v24 offset:7776
    v_mul_u32_u24 v28, 6554, v26
    v_mfma_f32_16x16x32_bf16 v[52:55], a[128:131], v[128:131], v[52:55]
    ds_read_b64_tr_b16 v[156:157], v24 offset:5248
    v_mfma_f32_16x16x32_bf16 v[72:75], a[132:135], v[128:131], v[72:75]
    ds_read_b64_tr_b16 v[158:159], v24 offset:7808
    v_lshrrev_b32 v28, 16, v28
    v_mfma_f32_16x16x32_bf16 v[92:95], v[40:43], v[128:131], v[92:95]
    v_mul_u32_u24 v27, 10, v28
    v_mfma_f32_16x16x32_bf16 v[56:59], a[128:131], v[132:135], v[56:59]
    v_sub_u32 v27, v26, v27
    v_bfe_u32 v29, v28, 2, 2
    v_mfma_f32_16x16x32_bf16 v[76:79], a[132:135], v[132:135], v[76:79]
    v_mul_u32_u24 v29, 4, v29
    v_mfma_f32_16x16x32_bf16 v[96:99], v[40:43], v[132:135], v[96:99]
    v_lshrrev_b32 v30, 4, v28
    v_mad_u32_u24 v29, 16, v30, v29
    v_mfma_f32_16x16x32_bf16 v[60:63], a[128:131], v[136:139], v[60:63]
    v_and_b32 v30, 3, v28
    v_mfma_f32_16x16x32_bf16 v[80:83], a[132:135], v[136:139], v[80:83]
    v_add_u32 v29, v29, v30
    v_mul_u32_u24 v29, 1280, v29
    v_mfma_f32_16x16x32_bf16 v[100:103], v[40:43], v[136:139], v[100:103]
    v_lshl_add_u32 v8, v27, 4, v29
    s_waitcnt lgkmcnt(0)
    v_mfma_f32_16x16x32_bf16 v[104:107], a[136:139], v[40:43], v[104:107]
    ds_read_b128 a[144:147], v22 offset:4096
    s_add_u32 m0, s55, 131072
    v_mfma_f32_16x16x32_bf16 v[112:115], a[136:139], a[136:139], v[112:115]
    ds_read_b128 a[148:151], v22 offset:6144
    s_nop 0
    v_mfma_f32_16x16x32_bf16 v[108:111], a[140:143], v[40:43], v[108:111]
    ds_read_b64_tr_b16 v[120:121], v24 offset:10240
    v_mfma_f32_16x16x32_bf16 v[116:119], a[140:143], a[140:143], v[116:119]
    ds_read_b64_tr_b16 v[122:123], v24 offset:12800
    buffer_load_dwordx4 v13, s[12:15], s41 offen  lds
    v_mfma_f32_16x16x32_bf16 v[44:47], a[136:139], v[140:143], v[44:47]
    ds_read_b64_tr_b16 v[124:125], v24 offset:10272
    s_mov_b32 s20, s96
    v_mfma_f32_16x16x32_bf16 v[64:67], a[140:143], v[140:143], v[64:67]
    ds_read_b64_tr_b16 v[126:127], v24 offset:12832
    v_mfma_f32_16x16x32_bf16 v[84:87], v[40:43], v[140:143], v[84:87]
    ds_read_b64_tr_b16 v[128:129], v24 offset:10304
    s_or_b32 s63, s98, 0
    s_cbranch_scc0 K_33
    buffer_store_dwordx4 a[236:239], v21, s[16:19], s58 offen offset:2048 sc0 sc1
K_33:
    v_mfma_f32_16x16x32_bf16 v[48:51], a[136:139], v[144:147], v[48:51]
    ds_read_b64_tr_b16 v[130:131], v24 offset:12864
    s_and_b32 s21, s97, 0xffff
    v_mfma_f32_16x16x32_bf16 v[68:71], a[140:143], v[144:147], v[68:71]
    ds_read_b64_tr_b16 v[132:133], v24 offset:10336
    v_mfma_f32_16x16x32_bf16 v[88:91], v[40:43], v[144:147], v[88:91]
    ds_read_b64_tr_b16 v[134:135], v24 offset:12896
    s_mov_b32 s22, 819200
    v_mfma_f32_16x16x32_bf16 v[52:55], a[136:139], v[148:151], v[52:55]
    ds_read_b64_tr_b16 v[136:137], v24 offset:10368
    v_mfma_f32_16x16x32_bf16 v[72:75], a[140:143], v[148:151], v[72:75]
    ds_read_b64_tr_b16 v[138:139], v24 offset:12928
    s_mul_i32 s64, s34, 0
    v_mfma_f32_16x16x32_bf16 v[92:95], v[40:43], v[148:151], v[92:95]
    s_lshr_b32 s64, s64, 1
    s_add_u32 s64, s64, s35
    v_mfma_f32_16x16x32_bf16 v[56:59], a[136:139], v[152:155], v[56:59]
    s_mul_i32 s62, s64, 6554
    v_mfma_f32_16x16x32_bf16 v[76:79], a[140:143], v[152:155], v[76:79]
    s_lshr_b32 s62, s62, 16
    s_mul_i32 s62, s62, 10
    v_mfma_f32_16x16x32_bf16 v[96:99], v[40:43], v[152:155], v[96:99]
    s_sub_u32 s64, s64, s62
    s_lshl_b32 s64, s64, 1
    v_mfma_f32_16x16x32_bf16 v[60:63], a[136:139], v[156:159], v[60:63]
    s_lshl_b32 s65, s35, 2
    v_mfma_f32_16x16x32_bf16 v[80:83], a[140:143], v[156:159], v[80:83]
    s_add_u32 s65, s65, s36
    s_mul_i32 s65, s65, 3072
    v_mfma_f32_16x16x32_bf16 v[100:103], v[40:43], v[156:159], v[100:103]
    s_add_u32 s65, s65, 1048576
    s_waitcnt lgkmcnt(0)
    v_mfma_f32_16x16x32_bf16 v[104:107], a[144:147], v[40:43], v[104:107]
    ds_read_b128 a[152:155], v23 offset:4096
    v_mfma_f32_16x16x32_bf16 v[112:115], a[144:147], a[144:147], v[112:115]
    ds_read_b128 a[156:159], v23 offset:6144
    v_mfma_f32_16x16x32_bf16 v[108:111], a[148:151], v[40:43], v[108:111]
    ds_read_b64_tr_b16 v[140:141], v24 offset:15360
    v_mfma_f32_16x16x32_bf16 v[116:119], a[148:151], a[148:151], v[116:119]
    ds_read_b64_tr_b16 v[142:143], v24 offset:17920
    v_mfma_f32_16x16x32_bf16 v[44:47], a[144:147], v[120:123], v[44:47]
    ds_read_b64_tr_b16 v[144:145], v24 offset:15392
    v_mfma_f32_16x16x32_bf16 v[64:67], a[148:151], v[120:123], v[64:67]
    ds_read_b64_tr_b16 v[146:147], v24 offset:17952
    v_mfma_f32_16x16x32_bf16 v[84:87], v[40:43], v[120:123], v[84:87]
    ds_read_b64_tr_b16 v[148:149], v24 offset:15424
    v_mfma_f32_16x16x32_bf16 v[48:51], a[144:147], v[124:127], v[48:51]
    ds_read_b64_tr_b16 v[150:151], v24 offset:17984
    v_mfma_f32_16x16x32_bf16 v[68:71], a[148:151], v[124:127], v[68:71]
    ds_read_b64_tr_b16 v[152:153], v24 offset:15456
    v_mfma_f32_16x16x32_bf16 v[88:91], v[40:43], v[124:127], v[88:91]
    ds_read_b64_tr_b16 v[154:155], v24 offset:18016
    v_mfma_f32_16x16x32_bf16 v[52:55], a[144:147], v[128:131], v[52:55]
    ds_read_b64_tr_b16 v[156:157], v24 offset:15488
    v_mfma_f32_16x16x32_bf16 v[72:75], a[148:151], v[128:131], v[72:75]
    ds_read_b64_tr_b16 v[158:159], v24 offset:18048
    v_mfma_f32_16x16x32_bf16 v[92:95], v[40:43], v[128:131], v[92:95]
    v_mfma_f32_16x16x32_bf16 v[56:59], a[144:147], v[132:135], v[56:59]
    v_mfma_f32_16x16x32_bf16 v[76:79], a[148:151], v[132:135], v[76:79]
    v_mfma_f32_16x16x32_bf16 v[96:99], v[40:43], v[132:135], v[96:99]
    v_mfma_f32_16x16x32_bf16 v[60:63], a[144:147], v[136:139], v[60:63]
    s_cmp_ge_u32 s36, 2
    s_cbranch_scc1 Q_20
    s_cmp_ge_u32 s36, 2
    s_cselect_b32 s41, s53, s53
    s_and_b32 s42, s36, 1
    s_mul_i32 s42, s42, 245760
    s_add_u32 s41, s41, s42
    s_add_u32 s41, s41, s56
    s_add_u32 m0, s55, 147456
    s_nop 0
    buffer_load_dwordx4 v9, s[12:15], s41 offen  lds
    s_add_u32 m0, s55, 148480
    s_nop 0
    buffer_load_dwordx4 v10, s[12:15], s41 offen  lds
    s_add_u32 m0, s55, 149504
    s_nop 0
    buffer_load_dwordx4 v11, s[12:15], s41 offen  lds
    s_add_u32 m0, s55, 150528
    s_nop 0
    buffer_load_dwordx4 v12, s[12:15], s41 offen  lds
    s_add_u32 m0, s55, 151552
    s_nop 0
    buffer_load_dwordx4 v13, s[12:15], s41 offen  lds
Q_20:
    v_mfma_f32_16x16x32_bf16 v[80:83], a[148:151], v[136:139], v[80:83]
    s_or_b32 s63, s98, 0
    s_cbranch_scc0 K_34
    buffer_store_dwordx4 a[240:243], v21, s[16:19], s58 offen offset:3072 sc0 sc1
K_34:
    v_mfma_f32_16x16x32_bf16 v[100:103], v[40:43], v[136:139], v[100:103]
    s_waitcnt lgkmcnt(0)
    v_mfma_f32_16x16x32_bf16 v[104:107], a[152:155], v[40:43], v[104:107]
    s_load_dwordx2 s[12:13], s[0:1], 56
    v_add_u32 v26, 0, v0
    v_mul_u32_u24 v28, 6554, v26
    v_lshrrev_b32 v28, 16, v28
    v_mfma_f32_16x16x32_bf16 v[112:115], a[152:155], a[152:155], v[112:115]
    v_mul_u32_u24 v27, 10, v28
    v_sub_u32 v27, v26, v27
    v_bfe_u32 v29, v28, 2, 2
    v_mfma_f32_16x16x32_bf16 v[108:111], a[156:159], v[40:43], v[108:111]
    v_mul_u32_u24 v29, 40, v29
    v_lshrrev_b32 v30, 4, v28
    v_mad_u32_u24 v29, 4, v30, v29
    v_and_b32 v30, 3, v28
    v_mfma_f32_16x16x32_bf16 v[116:119], a[156:159], a[156:159], v[116:119]
    v_add_u32 v29, v29, v30
    v_mul_u32_u24 v29, 1280, v29
    v_lshl_add_u32 v9, v27, 4, v29
    v_mfma_f32_16x16x32_bf16 v[44:47], a[152:155], v[140:143], v[44:47]
    v_add_u32 v26, 64, v0
    v_mul_u32_u24 v28, 6554, v26
    v_lshrrev_b32 v28, 16, v28
    v_mul_u32_u24 v27, 10, v28
    v_mfma_f32_16x16x32_bf16 v[64:67], a[156:159], v[140:143], v[64:67]
    v_sub_u32 v27, v26, v27
    v_bfe_u32 v29, v28, 2, 2
    v_mul_u32_u24 v29, 40, v29
    v_mfma_f32_16x16x32_bf16 v[84:87], v[40:43], v[140:143], v[84:87]
    v_lshrrev_b32 v30, 4, v28
    v_mad_u32_u24 v29, 4, v30, v29
    v_and_b32 v30, 3, v28
    v_add_u32 v29, v29, v30
    v_mfma_f32_16x16x32_bf16 v[48:51], a[152:155], v[144:147], v[48:51]
    v_mul_u32_u24 v29, 1280, v29
    v_lshl_add_u32 v10, v27, 4, v29
    v_add_u32 v26, 128, v0
    v_mfma_f32_16x16x32_bf16 v[68:71], a[156:159], v[144:147], v[68:71]
    v_mul_u32_u24 v28, 6554, v26
    v_lshrrev_b32 v28, 16, v28
    v_mul_u32_u24 v27, 10, v28
    v_sub_u32 v27, v26, v27
    v_mfma_f32_16x16x32_bf16 v[88:91], v[40:43], v[144:147], v[88:91]
    v_bfe_u32 v29, v28, 2, 2
    v_mul_u32_u24 v29, 40, v29
    v_lshrrev_b32 v30, 4, v28
    v_mfma_f32_16x16x32_bf16 v[52:55], a[152:155], v[148:151], v[52:55]
    v_mad_u32_u24 v29, 4, v30, v29
    v_and_b32 v30, 3, v28
    v_add_u32 v29, v29, v30
    v_mul_u32_u24 v29, 1280, v29
    v_mfma_f32_16x16x32_bf16 v[72:75], a[156:159], v[148:151], v[72:75]
    v_lshl_add_u32 v11, v27, 4, v29
    v_add_u32 v26, 192, v0
    v_mul_u32_u24 v28, 6554, v26
    v_mfma_f32_16x16x32_bf16 v[92:95], v[40:43], v[148:151], v[92:95]
    v_lshrrev_b32 v28, 16, v28
    v_mul_u32_u24 v27, 10, v28
    v_sub_u32 v27, v26, v27
    v_bfe_u32 v29, v28, 2, 2
    v_mfma_f32_16x16x32_bf16 v[56:59], a[152:155], v[152:155], v[56:59]
    v_mul_u32_u24 v29, 40, v29
    v_lshrrev_b32 v30, 4, v28
    v_mad_u32_u24 v29, 4, v30, v29
    v_mfma_f32_16x16x32_bf16 v[76:79], a[156:159], v[152:155], v[76:79]
    v_and_b32 v30, 3, v28
    v_add_u32 v29, v29, v30
    v_mul_u32_u24 v29, 1280, v29
    v_lshl_add_u32 v12, v27, 4, v29
    v_mfma_f32_16x16x32_bf16 v[96:99], v[40:43], v[152:155], v[96:99]
    v_add_u32 v26, 256, v0
    v_mul_u32_u24 v28, 6554, v26
    v_lshrrev_b32 v28, 16, v28
    v_mfma_f32_16x16x32_bf16 v[60:63], a[152:155], v[156:159], v[60:63]
    v_mul_u32_u24 v27, 10, v28
    v_sub_u32 v27, v26, v27
    v_bfe_u32 v29, v28, 2, 2
    v_mul_u32_u24 v29, 40, v29
    v_mfma_f32_16x16x32_bf16 v[80:83], a[156:159], v[156:159], v[80:83]
    v_lshrrev_b32 v30, 4, v28
    v_mad_u32_u24 v29, 4, v30, v29
    v_and_b32 v30, 3, v28
    v_mfma_f32_16x16x32_bf16 v[100:103], v[40:43], v[156:159], v[100:103]
    v_add_u32 v29, v29, v30
    v_mul_u32_u24 v29, 1280, v29
    v_lshl_add_u32 v13, v27, 4, v29
    v_lshrrev_b32 v26, 4, v0
    v_mul_u32_u24 v26, 80, v26
    s_mov_b32 s40, 0x3acccccd
    s_nop 4
    ds_bpermute_b32 v188, v26, v112 offset:0
    ds_bpermute_b32 v189, v26, v113 offset:4
    ds_bpermute_b32 v190, v26, v114 offset:8
    ds_bpermute_b32 v191, v26, v115 offset:12
    ds_bpermute_b32 v192, v26, v116 offset:0
    ds_bpermute_b32 v193, v26, v117 offset:4
    ds_bpermute_b32 v194, v26, v118 offset:8
    ds_bpermute_b32 v195, v26, v119 offset:12
    s_mov_b32 s42, 0x3727c5ac
    s_mov_b32 s44, 0x3fb8aa3b
    s_mov_b32 s46, 0x358637bd
    v_pk_mul_f32 v[180:181], v[104:105], s[40:41] op_sel_hi:[1,0]
    v_pk_mul_f32 v[182:183], v[106:107], s[40:41] op_sel_hi:[1,0]
    v_pk_mul_f32 v[184:185], v[108:109], s[40:41] op_sel_hi:[1,0]
    v_pk_mul_f32 v[186:187], v[110:111], s[40:41] op_sel_hi:[1,0]
    v_pk_fma_f32 v[196:197], v[180:181], v[180:181], s[42:43] op_sel_hi:[1,1,0] neg_lo:[1,0,0] neg_hi:[1,0,0]
    v_pk_fma_f32 v[198:199], v[182:183], v[182:183], s[42:43] op_sel_hi:[1,1,0] neg_lo:[1,0,0] neg_hi:[1,0,0]
    v_pk_fma_f32 v[200:201], v[184:185], v[184:185], s[42:43] op_sel_hi:[1,1,0] neg_lo:[1,0,0] neg_hi:[1,0,0]
    v_pk_fma_f32 v[202:203], v[186:187], v[186:187], s[42:43] op_sel_hi:[1,1,0] neg_lo:[1,0,0] neg_hi:[1,0,0]
    v_and_b32 v26, 15, v0
    v_cmp_gt_u32 vcc, 8, v26
    s_waitcnt lgkmcnt(0)
    v_pk_fma_f32 v[188:189], v[188:189], s[40:41], v[196:197] op_sel_hi:[1,0,1]
    v_pk_fma_f32 v[190:191], v[190:191], s[40:41], v[198:199] op_sel_hi:[1,0,1]
    v_pk_fma_f32 v[192:193], v[192:193], s[40:41], v[200:201] op_sel_hi:[1,0,1]
    v_pk_fma_f32 v[194:195], v[194:195], s[40:41], v[202:203] op_sel_hi:[1,0,1]
    v_max_f32 v188, s42, v188
    v_max_f32 v189, s42, v189
    v_max_f32 v190, s42, v190
    v_max_f32 v191, s42, v191
    v_max_f32 v192, s42, v192
    s_add_u32 m0, s4, 0
    s_add_u32 s62, s36, 0
    s_mul_i32 s62, s62, 51200
    s_add_u32 s62, s62, 10240
    s_add_u32 s62, s62, s5
    buffer_load_dwordx4 v4, s[20:23], s62 offen  lds
    v_max_f32 v193, s42, v193
    v_max_f32 v194, s42, v194
    v_max_f32 v195, s42, v195
    v_rsq_f32 v188, v188
    v_rsq_f32 v189, v189
    v_rsq_f32 v190, v190
    v_rsq_f32 v191, v191
    v_rsq_f32 v192, v192
    v_rsq_f32 v193, v193
    v_rsq_f32 v194, v194
    v_rsq_f32 v195, v195
    v_pk_fma_f32 v[44:45], v[180:181], v[84:85], v[44:45] op_sel_hi:[1,0,1] neg_lo:[1,0,0] neg_hi:[1,0,0]
    v_pk_fma_f32 v[46:47], v[182:183], v[84:85], v[46:47] op_sel_hi:[1,0,1] neg_lo:[1,0,0] neg_hi:[1,0,0]
    v_pk_mul_f32 v[196:197], v[188:189], s[44:45] op_sel_hi:[1,0]
    v_pk_mul_f32 v[198:199], v[190:191], s[44:45] op_sel_hi:[1,0]
    v_pk_mul_f32 v[200:201], v[192:193], s[44:45] op_sel_hi:[1,0]
    v_pk_mul_f32 v[202:203], v[194:195], s[44:45] op_sel_hi:[1,0]
    s_add_u32 m0, s4, 1024
    s_nop 0
    buffer_load_dwordx4 v5, s[20:23], s62 offen  lds
    v_pk_mul_f32 v[26:27], v[44:45], v[196:197]
    v_pk_mul_f32 v[28:29], v[46:47], v[198:199]
    v_exp_f32_e64 v26, v26 clamp
    v_exp_f32_e64 v27, v27 clamp
    v_exp_f32_e64 v28, v28 clamp
    v_exp_f32_e64 v29, v29 clamp
    v_max_f32 v44, 0, v44
    v_max_f32 v45, 0, v45
    v_max_f32 v46, 0, v46
    v_max_f32 v47, 0, v47
    v_pk_add_f32 v[26:27], v[26:27], s[46:47] op_sel_hi:[1,0]
    v_pk_add_f32 v[28:29], v[28:29], s[46:47] op_sel_hi:[1,0]
    v_pk_fma_f32 v[44:45], v[44:45], v[188:189], v[26:27]
    v_pk_fma_f32 v[46:47], v[46:47], v[190:191], v[28:29]
    v_cvt_pk_bf16_f32 v212, v44, v45
    v_cvt_pk_bf16_f32 v213, v46, v47
    s_add_u32 m0, s4, 2048
    s_nop 0
    buffer_load_dwordx4 v6, s[20:23], s62 offen  lds
    v_pk_fma_f32 v[64:65], v[184:185], v[84:85], v[64:65] op_sel_hi:[1,0,1] neg_lo:[1,0,0] neg_hi:[1,0,0]
    v_pk_fma_f32 v[66:67], v[186:187], v[84:85], v[66:67] op_sel_hi:[1,0,1] neg_lo:[1,0,0] neg_hi:[1,0,0]
    v_pk_mul_f32 v[26:27], v[64:65], v[200:201]
    v_pk_mul_f32 v[28:29], v[66:67], v[202:203]
    v_exp_f32_e64 v26, v26 clamp
    v_exp_f32_e64 v27, v27 clamp
    v_exp_f32_e64 v28, v28 clamp
    v_exp_f32_e64 v29, v29 clamp
    v_max_f32 v64, 0, v64
    v_max_f32 v65, 0, v65
    v_max_f32 v66, 0, v66
    v_max_f32 v67, 0, v67
    v_pk_add_f32 v[26:27], v[26:27], s[46:47] op_sel_hi:[1,0]
    v_pk_add_f32 v[28:29], v[28:29], s[46:47] op_sel_hi:[1,0]
    v_pk_fma_f32 v[64:65], v[64:65], v[192:193], v[26:27]
    v_pk_fma_f32 v[66:67], v[66:67], v[194:195], v[28:29]
    v_cvt_pk_bf16_f32 v214, v64, v65
    s_add_u32 m0, s4, 3072
    s_nop 0
    buffer_load_dwordx4 v7, s[20:23], s62 offen  lds
    v_cvt_pk_bf16_f32 v215, v66, v67
    v_pk_fma_f32 v[48:49], v[180:181], v[88:89], v[48:49] op_sel_hi:[1,0,1] neg_lo:[1,0,0] neg_hi:[1,0,0]
    v_pk_fma_f32 v[50:51], v[182:183], v[88:89], v[50:51] op_sel_hi:[1,0,1] neg_lo:[1,0,0] neg_hi:[1,0,0]
    v_pk_mul_f32 v[26:27], v[48:49], v[196:197]
    v_pk_mul_f32 v[28:29], v[50:51], v[198:199]
    v_exp_f32_e64 v26, v26 clamp
    v_exp_f32_e64 v27, v27 clamp
    v_exp_f32_e64 v28, v28 clamp
    v_exp_f32_e64 v29, v29 clamp
    v_max_f32 v48, 0, v48
    v_max_f32 v49, 0, v49
    v_max_f32 v50, 0, v50
    v_max_f32 v51, 0, v51
    v_pk_add_f32 v[26:27], v[26:27], s[46:47] op_sel_hi:[1,0]
    v_pk_add_f32 v[28:29], v[28:29], s[46:47] op_sel_hi:[1,0]
    v_pk_fma_f32 v[48:49], v[48:49], v[188:189], v[26:27]
    v_pk_fma_f32 v[50:51], v[50:51], v[190:191], v[28:29]
    s_add_u32 m0, s4, 4096
    s_nop 0
    buffer_load_dwordx4 v8, s[20:23], s62 offen  lds
    v_cvt_pk_bf16_f32 v216, v48, v49
    v_cvt_pk_bf16_f32 v217, v50, v51
    v_pk_fma_f32 v[68:69], v[184:185], v[88:89], v[68:69] op_sel_hi:[1,0,1] neg_lo:[1,0,0] neg_hi:[1,0,0]
    v_pk_fma_f32 v[70:71], v[186:187], v[88:89], v[70:71] op_sel_hi:[1,0,1] neg_lo:[1,0,0] neg_hi:[1,0,0]
    v_pk_mul_f32 v[26:27], v[68:69], v[200:201]
    v_pk_mul_f32 v[28:29], v[70:71], v[202:203]
    v_exp_f32_e64 v26, v26 clamp
    v_exp_f32_e64 v27, v27 clamp
    v_exp_f32_e64 v28, v28 clamp
    v_exp_f32_e64 v29, v29 clamp
    v_max_f32 v68, 0, v68
    v_max_f32 v69, 0, v69
    v_max_f32 v70, 0, v70
    v_max_f32 v71, 0, v71
    v_pk_add_f32 v[26:27], v[26:27], s[46:47] op_sel_hi:[1,0]
    v_pk_add_f32 v[28:29], v[28:29], s[46:47] op_sel_hi:[1,0]
    v_pk_fma_f32 v[68:69], v[68:69], v[192:193], v[26:27]
    s_add_u32 m0, s4, 20480
    s_add_u32 s62, s36, 4
    s_mul_i32 s62, s62, 51200
    s_add_u32 s62, s62, 10240
    s_add_u32 s62, s62, s5
    buffer_load_dwordx4 v4, s[20:23], s62 offen  lds
    v_pk_fma_f32 v[70:71], v[70:71], v[194:195], v[28:29]
    v_cvt_pk_bf16_f32 v218, v68, v69
    v_cvt_pk_bf16_f32 v219, v70, v71
    v_pk_fma_f32 v[52:53], v[180:181], v[92:93], v[52:53] op_sel_hi:[1,0,1] neg_lo:[1,0,0] neg_hi:[1,0,0]
    v_pk_fma_f32 v[54:55], v[182:183], v[92:93], v[54:55] op_sel_hi:[1,0,1] neg_lo:[1,0,0] neg_hi:[1,0,0]
    v_pk_mul_f32 v[26:27], v[52:53], v[196:197]
    v_pk_mul_f32 v[28:29], v[54:55], v[198:199]
    v_exp_f32_e64 v26, v26 clamp
    v_exp_f32_e64 v27, v27 clamp
    v_exp_f32_e64 v28, v28 clamp
    v_exp_f32_e64 v29, v29 clamp
    v_max_f32 v30, 0, v52
    v_max_f32 v31, 0, v53
    v_max_f32 v32, 0, v54
    v_max_f32 v33, 0, v55
    v_pk_add_f32 v[26:27], v[26:27], s[46:47] op_sel_hi:[1,0]
    v_pk_add_f32 v[28:29], v[28:29], s[46:47] op_sel_hi:[1,0]
    s_add_u32 m0, s4, 21504
    s_nop 0
    buffer_load_dwordx4 v5, s[20:23], s62 offen  lds
    v_pk_fma_f32 v[30:31], v[30:31], v[188:189], v[26:27]
    v_pk_fma_f32 v[32:33], v[32:33], v[190:191], v[28:29]
    v_pk_mul_f32 v[52:53], v[52:53], v[188:189]
    v_pk_mul_f32 v[54:55], v[54:55], v[190:191]
    v_cndmask_b32 v52, v52, v30, vcc
    v_cndmask_b32 v53, v53, v31, vcc
    v_cndmask_b32 v54, v54, v32, vcc
    v_cndmask_b32 v55, v55, v33, vcc
    v_cvt_pk_bf16_f32 v220, v52, v53
    v_cvt_pk_bf16_f32 v221, v54, v55
    v_pk_fma_f32 v[72:73], v[184:185], v[92:93], v[72:73] op_sel_hi:[1,0,1] neg_lo:[1,0,0] neg_hi:[1,0,0]
    v_pk_fma_f32 v[74:75], v[186:187], v[92:93], v[74:75] op_sel_hi:[1,0,1] neg_lo:[1,0,0] neg_hi:[1,0,0]
    v_pk_mul_f32 v[26:27], v[72:73], v[200:201]
    v_pk_mul_f32 v[28:29], v[74:75], v[202:203]
    v_exp_f32_e64 v26, v26 clamp
    v_exp_f32_e64 v27, v27 clamp
    s_add_u32 m0, s4, 22528
    s_nop 0
    buffer_load_dwordx4 v6, s[20:23], s62 offen  lds
    v_exp_f32_e64 v28, v28 clamp
    v_exp_f32_e64 v29, v29 clamp
    v_max_f32 v30, 0, v72
    v_max_f32 v31, 0, v73
    v_max_f32 v32, 0, v74
    v_max_f32 v33, 0, v75
    v_pk_add_f32 v[26:27], v[26:27], s[46:47] op_sel_hi:[1,0]
    v_pk_add_f32 v[28:29], v[28:29], s[46:47] op_sel_hi:[1,0]
    v_pk_fma_f32 v[30:31], v[30:31], v[192:193], v[26:27]
    v_pk_fma_f32 v[32:33], v[32:33], v[194:195], v[28:29]
    v_pk_mul_f32 v[72:73], v[72:73], v[192:193]
    v_pk_mul_f32 v[74:75], v[74:75], v[194:195]
    v_cndmask_b32 v72, v72, v30, vcc
    v_cndmask_b32 v73, v73, v31, vcc
    v_cndmask_b32 v74, v74, v32, vcc
    v_cndmask_b32 v75, v75, v33, vcc
    v_cvt_pk_bf16_f32 v222, v72, v73
    s_add_u32 m0, s4, 23552
    s_nop 0
    buffer_load_dwordx4 v7, s[20:23], s62 offen  lds
    v_cvt_pk_bf16_f32 v223, v74, v75
    v_pk_fma_f32 v[56:57], v[180:181], v[96:97], v[56:57] op_sel_hi:[1,0,1] neg_lo:[1,0,0] neg_hi:[1,0,0]
    v_pk_fma_f32 v[58:59], v[182:183], v[96:97], v[58:59] op_sel_hi:[1,0,1] neg_lo:[1,0,0] neg_hi:[1,0,0]
    v_pk_mul_f32 v[56:57], v[56:57], v[188:189]
    v_pk_mul_f32 v[58:59], v[58:59], v[190:191]
    v_cvt_pk_bf16_f32 v224, v56, v57
    v_cvt_pk_bf16_f32 v225, v58, v59
    v_pk_fma_f32 v[76:77], v[184:185], v[96:97], v[76:77] op_sel_hi:[1,0,1] neg_lo:[1,0,0] neg_hi:[1,0,0]
    v_pk_fma_f32 v[78:79], v[186:187], v[96:97], v[78:79] op_sel_hi:[1,0,1] neg_lo:[1,0,0] neg_hi:[1,0,0]
    v_pk_mul_f32 v[76:77], v[76:77], v[192:193]
    v_pk_mul_f32 v[78:79], v[78:79], v[194:195]
    v_cvt_pk_bf16_f32 v226, v76, v77
    v_cvt_pk_bf16_f32 v227, v78, v79
    v_pk_fma_f32 v[60:61], v[180:181], v[100:101], v[60:61] op_sel_hi:[1,0,1] neg_lo:[1,0,0] neg_hi:[1,0,0]
    v_pk_fma_f32 v[62:63], v[182:183], v[100:101], v[62:63] op_sel_hi:[1,0,1] neg_lo:[1,0,0] neg_hi:[1,0,0]
    v_pk_mul_f32 v[60:61], v[60:61], v[188:189]
    v_pk_mul_f32 v[62:63], v[62:63], v[190:191]
    s_add_u32 m0, s4, 24576
    s_nop 0
    buffer_load_dwordx4 v8, s[20:23], s62 offen  lds
    v_cvt_pk_bf16_f32 v228, v60, v61
    v_cvt_pk_bf16_f32 v229, v62, v63
    v_pk_fma_f32 v[80:81], v[184:185], v[100:101], v[80:81] op_sel_hi:[1,0,1] neg_lo:[1,0,0] neg_hi:[1,0,0]
    v_pk_fma_f32 v[82:83], v[186:187], v[100:101], v[82:83] op_sel_hi:[1,0,1] neg_lo:[1,0,0] neg_hi:[1,0,0]
    v_pk_mul_f32 v[80:81], v[80:81], v[192:193]
    v_pk_mul_f32 v[82:83], v[82:83], v[194:195]
    v_cvt_pk_bf16_f32 v230, v80, v81
    v_cvt_pk_bf16_f32 v231, v82, v83
    s_nop 1
    v_mfma_f32_16x16x32_bf16 v[44:47], v[212:215], v[220:223], 0
    v_mfma_f32_16x16x32_bf16 v[48:51], v[216:219], v[220:223], 0
    v_mfma_f32_16x16x32_bf16 v[52:55], v[212:215], v[224:227], 0
    v_mfma_f32_16x16x32_bf16 v[56:59], v[216:219], v[224:227], 0
    v_mfma_f32_16x16x32_bf16 v[60:63], v[220:223], v[224:227], 0
    v_mfma_f32_16x16x32_bf16 v[64:67], v[216:219], v[228:231], 0
    v_mfma_f32_16x16x32_bf16 v[68:71], v[220:223], v[228:231], 0
    v_mfma_f32_16x16x32_bf16 v[72:75], v[212:215], v[40:43], 0
    v_mfma_f32_16x16x32_bf16 v[76:79], v[216:219], v[40:43], 0
    v_mfma_f32_16x16x32_bf16 v[80:83], v[220:223], v[40:43], 0
    s_add_u32 s40, s54, 53248
    v_lshl_add_u32 v26, v160, 1, s40
    v_lshl_add_u32 v27, v161, 1, s40
    v_lshl_add_u32 v28, v162, 1, s40
    v_lshl_add_u32 v29, v163, 1, s40
    v_lshl_add_u32 v30, v164, 1, s40
    v_lshl_add_u32 v31, v165, 1, s40
    v_lshl_add_u32 v32, v166, 1, s40
    v_lshl_add_u32 v33, v167, 1, s40
    v_lshl_add_u32 v34, v168, 1, s40
    v_lshl_add_u32 v35, v169, 1, s40
    ds_write_b128 v26, v[44:47]
    ds_write_b128 v27, v[48:51]
    ds_write_b128 v28, v[52:55]
    ds_write_b128 v29, v[56:59]
    ds_write_b128 v30, v[60:63]
    ds_write_b128 v31, v[64:67]
    ds_write_b128 v32, v[68:71]
    ds_write_b128 v33, v[72:75]
    ds_write_b128 v34, v[76:79]
    ds_write_b128 v35, v[80:83]
    v_lshl_add_u32 v36, s36, 6, v0
    v_lshlrev_b32 v37, 4, v36
    v_add_u32 v38, 53248, v37
    s_lshl_b32 s40, s35, 4
    s_add_u32 s40, s40, s34
    s_lshl_b32 s40, s40, 12
    s_add_u32 s40, s40, 19922944
    s_waitcnt lgkmcnt(0) vmcnt(10)
    s_barrier
    ds_read_b128 v[44:47], v38 offset:0
    ds_read_b128 v[48:51], v38 offset:8192
    ds_read_b128 v[52:55], v38 offset:16384
    ds_read_b128 v[56:59], v38 offset:24576
    v_mov_b32 v26, 0
    v_mov_b32 v27, 0
    v_mov_b32 v28, 161792
    ds_write_b64 v28, v[26:27]
    v_and_b32 v18, 15, v0
    v_lshlrev_b32 v18, 2, v18
    v_add_u32 v24, 106496, v25
    s_waitcnt lgkmcnt(1)
    v_add_f32 v44, v44, v48
    v_add_f32 v52, v52, v56
    v_add_f32 v45, v45, v49
    v_add_f32 v53, v53, v57
    v_add_f32 v46, v46, v50
    v_add_f32 v54, v54, v58
    v_add_f32 v47, v47, v51
    v_add_f32 v55, v55, v59
    v_add_f32 v44, v44, v52
    v_add_f32 v45, v45, v53
    v_add_f32 v46, v46, v54
    v_add_f32 v47, v47, v55
    buffer_store_dwordx4 v[44:47], v37, s[16:19], s40 offen sc0 sc1
    global_load_dword v19, v18, s[32:33] sc1
    v_and_b32 v26, 3, v0
    v_cmp_eq_u32 s[40:41], 1, v26
    v_cmp_eq_u32 s[42:43], 2, v26
    v_cmp_eq_u32 vcc, 3, v26
    v_and_b32 v26, 15, v0
    v_lshrrev_b32 v27, 2, v26
    v_lshl_add_u32 v26, v27, 4, v26
    v_lshlrev_b32 v26, 2, v26
    v_cndmask_b32 v27, v180, v181, s[40:41]
    v_cndmask_b32 v27, v27, v182, s[42:43]
    v_cndmask_b32 v27, v27, v183, vcc
    ds_bpermute_b32 v204, v26, v27
    v_cndmask_b32 v28, v188, v189, s[40:41]
    v_cndmask_b32 v28, v28, v190, s[42:43]
    v_cndmask_b32 v28, v28, v191, vcc
    ds_bpermute_b32 v205, v26, v28
    v_cndmask_b32 v29, v184, v185, s[40:41]
    v_cndmask_b32 v29, v29, v186, s[42:43]
    v_cndmask_b32 v29, v29, v187, vcc
    ds_bpermute_b32 v208, v26, v29
    v_cndmask_b32 v30, v192, v193, s[40:41]
    v_cndmask_b32 v30, v30, v194, s[42:43]
    v_cndmask_b32 v30, v30, v195, vcc
    ds_bpermute_b32 v209, v26, v30
    ds_read_b64_tr_b16 v[120:121], v24 offset:0
    ds_read_b64_tr_b16 v[122:123], v24 offset:2560
    ds_read_b64_tr_b16 v[124:125], v24 offset:32
    ds_read_b64_tr_b16 v[126:127], v24 offset:2592
    ds_read_b64_tr_b16 v[128:129], v24 offset:64
    ds_read_b64_tr_b16 v[130:131], v24 offset:2624
    s_waitcnt lgkmcnt(0)
    v_mfma_f32_16x16x32_bf16 v[104:107], v[120:123], a[0:3], 0
    ds_read_b64_tr_b16 v[132:133], v24 offset:80
    v_mfma_f32_16x16x32_bf16 v[116:119], v[120:123], a[4:7], 0
    ds_read_b64_tr_b16 v[134:135], v24 offset:2640
    v_mfma_f32_16x16x32_bf16 v[152:155], v[120:123], v[40:43], 0
    ds_read_b64_tr_b16 v[136:137], v24 offset:112
    v_mfma_f32_16x16x32_bf16 v[108:111], v[124:127], a[0:3], 0
    ds_read_b64_tr_b16 v[138:139], v24 offset:2672
    v_mfma_f32_16x16x32_bf16 v[144:147], v[124:127], a[4:7], 0
    ds_read_b64_tr_b16 v[140:141], v24 offset:144
    v_mfma_f32_16x16x32_bf16 v[156:159], v[124:127], v[40:43], 0
    ds_read_b64_tr_b16 v[142:143], v24 offset:2704
    v_mfma_f32_16x16x32_bf16 v[112:115], v[128:131], a[0:3], 0
    v_mfma_f32_16x16x32_bf16 v[148:151], v[128:131], a[4:7], 0
    v_mfma_f32_16x16x32_bf16 v[248:251], v[128:131], v[40:43], 0
    s_waitcnt lgkmcnt(0)
    v_mfma_f32_16x16x32_bf16 v[104:107], v[132:135], a[8:11], v[104:107]
    ds_read_b64_tr_b16 v[120:121], v24 offset:5120
    s_add_u32 m0, s4, 81920
    v_mfma_f32_16x16x32_bf16 v[116:119], v[132:135], a[12:15], v[116:119]
    ds_read_b64_tr_b16 v[122:123], v24 offset:7680
    v_mfma_f32_16x16x32_bf16 v[152:155], v[132:135], v[40:43], v[152:155]
    ds_read_b64_tr_b16 v[124:125], v24 offset:5152
    v_mfma_f32_16x16x32_bf16 v[108:111], v[136:139], a[8:11], v[108:111]
    ds_read_b64_tr_b16 v[126:127], v24 offset:7712
    v_mfma_f32_16x16x32_bf16 v[144:147], v[136:139], a[12:15], v[144:147]
    ds_read_b64_tr_b16 v[128:129], v24 offset:5184
    v_mfma_f32_16x16x32_bf16 v[156:159], v[136:139], v[40:43], v[156:159]
    ds_read_b64_tr_b16 v[130:131], v24 offset:7744
    v_mfma_f32_16x16x32_bf16 v[112:115], v[140:143], a[8:11], v[112:115]
    s_mul_i32 s62, s36, 204800
    v_mfma_f32_16x16x32_bf16 v[148:151], v[140:143], a[12:15], v[148:151]
    s_add_u32 s62, s62, s5
    v_mfma_f32_16x16x32_bf16 v[248:251], v[140:143], v[40:43], v[248:251]
    buffer_load_dwordx4 v9, s[20:23], s62 offen  lds
    s_waitcnt lgkmcnt(0)
    v_mfma_f32_16x16x32_bf16 v[104:107], v[120:123], a[16:19], v[104:107]
    ds_read_b64_tr_b16 v[132:133], v24 offset:5200
    v_mfma_f32_16x16x32_bf16 v[116:119], v[120:123], a[20:23], v[116:119]
    ds_read_b64_tr_b16 v[134:135], v24 offset:7760
    v_mfma_f32_16x16x32_bf16 v[152:155], v[120:123], v[40:43], v[152:155]
    ds_read_b64_tr_b16 v[136:137], v24 offset:5232
    v_mfma_f32_16x16x32_bf16 v[108:111], v[124:127], a[16:19], v[108:111]
    ds_read_b64_tr_b16 v[138:139], v24 offset:7792
    v_mfma_f32_16x16x32_bf16 v[144:147], v[124:127], a[20:23], v[144:147]
    ds_read_b64_tr_b16 v[140:141], v24 offset:5264
    v_mfma_f32_16x16x32_bf16 v[156:159], v[124:127], v[40:43], v[156:159]
    ds_read_b64_tr_b16 v[142:143], v24 offset:7824
    v_mfma_f32_16x16x32_bf16 v[112:115], v[128:131], a[16:19], v[112:115]
    s_add_u32 m0, s4, 82944
    v_mfma_f32_16x16x32_bf16 v[148:151], v[128:131], a[20:23], v[148:151]
    s_nop 0
    v_mfma_f32_16x16x32_bf16 v[248:251], v[128:131], v[40:43], v[248:251]
    buffer_load_dwordx4 v10, s[20:23], s62 offen  lds
    s_waitcnt lgkmcnt(0)
    v_mfma_f32_16x16x32_bf16 v[104:107], v[132:135], a[24:27], v[104:107]
    ds_read_b64_tr_b16 v[120:121], v24 offset:10240
    v_mfma_f32_16x16x32_bf16 v[116:119], v[132:135], a[28:31], v[116:119]
    ds_read_b64_tr_b16 v[122:123], v24 offset:12800
    v_mfma_f32_16x16x32_bf16 v[152:155], v[132:135], v[40:43], v[152:155]
    ds_read_b64_tr_b16 v[124:125], v24 offset:10272
    v_mfma_f32_16x16x32_bf16 v[108:111], v[136:139], a[24:27], v[108:111]
    ds_read_b64_tr_b16 v[126:127], v24 offset:12832
    v_mfma_f32_16x16x32_bf16 v[144:147], v[136:139], a[28:31], v[144:147]
    ds_read_b64_tr_b16 v[128:129], v24 offset:10304
    v_mfma_f32_16x16x32_bf16 v[156:159], v[136:139], v[40:43], v[156:159]
    ds_read_b64_tr_b16 v[130:131], v24 offset:12864
    v_mfma_f32_16x16x32_bf16 v[112:115], v[140:143], a[24:27], v[112:115]
    s_add_u32 m0, s4, 83968
    v_mfma_f32_16x16x32_bf16 v[148:151], v[140:143], a[28:31], v[148:151]
    s_nop 0
    v_mfma_f32_16x16x32_bf16 v[248:251], v[140:143], v[40:43], v[248:251]
    buffer_load_dwordx4 v11, s[20:23], s62 offen  lds
    s_waitcnt lgkmcnt(0)
    v_mfma_f32_16x16x32_bf16 v[104:107], v[120:123], a[32:35], v[104:107]
    ds_read_b64_tr_b16 v[132:133], v24 offset:10320
    v_mfma_f32_16x16x32_bf16 v[116:119], v[120:123], a[36:39], v[116:119]
    ds_read_b64_tr_b16 v[134:135], v24 offset:12880
    v_mfma_f32_16x16x32_bf16 v[152:155], v[120:123], v[40:43], v[152:155]
    ds_read_b64_tr_b16 v[136:137], v24 offset:10352
    v_mfma_f32_16x16x32_bf16 v[108:111], v[124:127], a[32:35], v[108:111]
    ds_read_b64_tr_b16 v[138:139], v24 offset:12912
    v_mfma_f32_16x16x32_bf16 v[144:147], v[124:127], a[36:39], v[144:147]
    ds_read_b64_tr_b16 v[140:141], v24 offset:10384
    v_mfma_f32_16x16x32_bf16 v[156:159], v[124:127], v[40:43], v[156:159]
    ds_read_b64_tr_b16 v[142:143], v24 offset:12944
    v_mfma_f32_16x16x32_bf16 v[112:115], v[128:131], a[32:35], v[112:115]
    s_add_u32 m0, s4, 84992
    v_mfma_f32_16x16x32_bf16 v[148:151], v[128:131], a[36:39], v[148:151]
    s_nop 0
    v_mfma_f32_16x16x32_bf16 v[248:251], v[128:131], v[40:43], v[248:251]
    buffer_load_dwordx4 v12, s[20:23], s62 offen  lds
    s_waitcnt lgkmcnt(0)
    v_mfma_f32_16x16x32_bf16 v[104:107], v[132:135], a[40:43], v[104:107]
    ds_read_b64_tr_b16 v[120:121], v24 offset:15360
    v_mfma_f32_16x16x32_bf16 v[116:119], v[132:135], a[44:47], v[116:119]
    ds_read_b64_tr_b16 v[122:123], v24 offset:17920
    v_mfma_f32_16x16x32_bf16 v[152:155], v[132:135], v[40:43], v[152:155]
    ds_read_b64_tr_b16 v[124:125], v24 offset:15392
    v_mfma_f32_16x16x32_bf16 v[108:111], v[136:139], a[40:43], v[108:111]
    ds_read_b64_tr_b16 v[126:127], v24 offset:17952
    v_mfma_f32_16x16x32_bf16 v[144:147], v[136:139], a[44:47], v[144:147]
    ds_read_b64_tr_b16 v[128:129], v24 offset:15424
    v_mfma_f32_16x16x32_bf16 v[156:159], v[136:139], v[40:43], v[156:159]
    ds_read_b64_tr_b16 v[130:131], v24 offset:17984
    v_mfma_f32_16x16x32_bf16 v[112:115], v[140:143], a[40:43], v[112:115]
    s_add_u32 m0, s4, 86016
    v_mfma_f32_16x16x32_bf16 v[148:151], v[140:143], a[44:47], v[148:151]
    s_nop 0
    v_mfma_f32_16x16x32_bf16 v[248:251], v[140:143], v[40:43], v[248:251]
    buffer_load_dwordx4 v13, s[20:23], s62 offen  lds
    s_waitcnt lgkmcnt(0)
    s_waitcnt vmcnt(5)
    s_barrier
    v_cmp_gt_u32 vcc, 1, v19
    s_nop 0
    s_cbranch_vccz I_41
    v_and_b32 v18, 15, v0
    v_lshlrev_b32 v18, 2, v18
    s_mov_b32 s41, 100000
P_42:
    global_load_dword v19, v18, s[32:33] offset:0 sc1
    s_waitcnt vmcnt(0)
    v_cmp_gt_u32 vcc, 1, v19
    s_sub_u32 s41, s41, 1
    s_cbranch_vccz P_43
    s_cmp_lg_u32 s41, 0
    s_cbranch_scc1 P_42
P_43:
I_41:
    s_cmp_lg_u32 s36, 0
    s_cbranch_scc1 W_44
    s_mov_b64 exec, 1
    v_mov_b32 v32, 0
    v_mov_b32 v33, 1
    buffer_store_dword v33, v32, s[16:19], s6 offen sc1
    s_mov_b64 exec, -1
W_44:
    v_mfma_f32_16x16x32_bf16 v[104:107], v[120:123], a[48:51], v[104:107]
    ds_read_b64_tr_b16 v[132:133], v24 offset:15440
    s_add_u32 m0, s4, 40960
    v_mfma_f32_16x16x32_bf16 v[116:119], v[120:123], a[52:55], v[116:119]
    ds_read_b64_tr_b16 v[134:135], v24 offset:18000
    v_mfma_f32_16x16x32_bf16 v[152:155], v[120:123], v[40:43], v[152:155]
    ds_read_b64_tr_b16 v[136:137], v24 offset:15472
    v_mfma_f32_16x16x32_bf16 v[108:111], v[124:127], a[48:51], v[108:111]
    ds_read_b64_tr_b16 v[138:139], v24 offset:18032
    s_add_u32 s62, s36, 8
    v_mfma_f32_16x16x32_bf16 v[144:147], v[124:127], a[52:55], v[144:147]
    ds_read_b64_tr_b16 v[140:141], v24 offset:15504
    v_mfma_f32_16x16x32_bf16 v[156:159], v[124:127], v[40:43], v[156:159]
    ds_read_b64_tr_b16 v[142:143], v24 offset:18064
    v_mfma_f32_16x16x32_bf16 v[112:115], v[128:131], a[48:51], v[112:115]
    s_mul_i32 s62, s62, 51200
    s_add_u32 s62, s62, 10240
    v_mfma_f32_16x16x32_bf16 v[148:151], v[128:131], a[52:55], v[148:151]
    s_add_u32 s62, s62, s5
    v_mfma_f32_16x16x32_bf16 v[248:251], v[128:131], v[40:43], v[248:251]
    buffer_load_dwordx4 v4, s[20:23], s62 offen  lds
    s_waitcnt lgkmcnt(0)
    v_mfma_f32_16x16x32_bf16 v[104:107], v[132:135], a[56:59], v[104:107]
    ds_read_b64_tr_b16 v[120:121], v24 offset:20480
    v_mfma_f32_16x16x32_bf16 v[116:119], v[132:135], a[60:63], v[116:119]
    ds_read_b64_tr_b16 v[122:123], v24 offset:23040
    v_mfma_f32_16x16x32_bf16 v[152:155], v[132:135], v[40:43], v[152:155]
    ds_read_b64_tr_b16 v[124:125], v24 offset:20512
    v_mfma_f32_16x16x32_bf16 v[108:111], v[136:139], a[56:59], v[108:111]
    ds_read_b64_tr_b16 v[126:127], v24 offset:23072
    v_mfma_f32_16x16x32_bf16 v[144:147], v[136:139], a[60:63], v[144:147]
    ds_read_b64_tr_b16 v[128:129], v24 offset:20544
    v_mfma_f32_16x16x32_bf16 v[156:159], v[136:139], v[40:43], v[156:159]
    ds_read_b64_tr_b16 v[130:131], v24 offset:23104
    v_mfma_f32_16x16x32_bf16 v[112:115], v[140:143], a[56:59], v[112:115]
    s_add_u32 m0, s4, 41984
    v_mfma_f32_16x16x32_bf16 v[148:151], v[140:143], a[60:63], v[148:151]
    s_nop 0
    v_mfma_f32_16x16x32_bf16 v[248:251], v[140:143], v[40:43], v[248:251]
    buffer_load_dwordx4 v5, s[20:23], s62 offen  lds
    s_waitcnt lgkmcnt(0)
    v_mfma_f32_16x16x32_bf16 v[104:107], v[120:123], a[64:67], v[104:107]
    ds_read_b64_tr_b16 v[132:133], v24 offset:20560
    v_mfma_f32_16x16x32_bf16 v[116:119], v[120:123], a[68:71], v[116:119]
    ds_read_b64_tr_b16 v[134:135], v24 offset:23120
    v_mfma_f32_16x16x32_bf16 v[152:155], v[120:123], v[40:43], v[152:155]
    ds_read_b64_tr_b16 v[136:137], v24 offset:20592
    v_mfma_f32_16x16x32_bf16 v[108:111], v[124:127], a[64:67], v[108:111]
    ds_read_b64_tr_b16 v[138:139], v24 offset:23152
    v_mfma_f32_16x16x32_bf16 v[144:147], v[124:127], a[68:71], v[144:147]
    ds_read_b64_tr_b16 v[140:141], v24 offset:20624
    v_mfma_f32_16x16x32_bf16 v[156:159], v[124:127], v[40:43], v[156:159]
    ds_read_b64_tr_b16 v[142:143], v24 offset:23184
    v_mfma_f32_16x16x32_bf16 v[112:115], v[128:131], a[64:67], v[112:115]
    s_add_u32 m0, s4, 43008
    v_mfma_f32_16x16x32_bf16 v[148:151], v[128:131], a[68:71], v[148:151]
    s_nop 0
    v_mfma_f32_16x16x32_bf16 v[248:251], v[128:131], v[40:43], v[248:251]
    buffer_load_dwordx4 v6, s[20:23], s62 offen  lds
    s_waitcnt lgkmcnt(0)
    v_mfma_f32_16x16x32_bf16 v[104:107], v[132:135], a[72:75], v[104:107]
    ds_read_b64_tr_b16 v[120:121], v24 offset:25600
    s_add_u32 m0, s4, 44032
    v_mfma_f32_16x16x32_bf16 v[116:119], v[132:135], a[76:79], v[116:119]
    ds_read_b64_tr_b16 v[122:123], v24 offset:28160
    v_mfma_f32_16x16x32_bf16 v[152:155], v[132:135], v[40:43], v[152:155]
    ds_read_b64_tr_b16 v[124:125], v24 offset:25632
    v_mfma_f32_16x16x32_bf16 v[108:111], v[136:139], a[72:75], v[108:111]
    ds_read_b64_tr_b16 v[126:127], v24 offset:28192
    s_nop 0
    v_mfma_f32_16x16x32_bf16 v[144:147], v[136:139], a[76:79], v[144:147]
    ds_read_b64_tr_b16 v[128:129], v24 offset:25664
    v_mfma_f32_16x16x32_bf16 v[156:159], v[136:139], v[40:43], v[156:159]
    ds_read_b64_tr_b16 v[130:131], v24 offset:28224
    v_mfma_f32_16x16x32_bf16 v[112:115], v[140:143], a[72:75], v[112:115]
    buffer_load_dwordx4 v7, s[20:23], s62 offen  lds
    s_add_u32 m0, s4, 45056
    v_mfma_f32_16x16x32_bf16 v[148:151], v[140:143], a[76:79], v[148:151]
    s_nop 0
    v_mfma_f32_16x16x32_bf16 v[248:251], v[140:143], v[40:43], v[248:251]
    buffer_load_dwordx4 v8, s[20:23], s62 offen  lds
    s_waitcnt lgkmcnt(0)
    v_mfma_f32_16x16x32_bf16 v[104:107], v[120:123], a[80:83], v[104:107]
    ds_read_b64_tr_b16 v[132:133], v24 offset:25680
    v_mfma_f32_16x16x32_bf16 v[116:119], v[120:123], a[84:87], v[116:119]
    ds_read_b64_tr_b16 v[134:135], v24 offset:28240
    v_mfma_f32_16x16x32_bf16 v[152:155], v[120:123], v[40:43], v[152:155]
    ds_read_b64_tr_b16 v[136:137], v24 offset:25712
    v_mfma_f32_16x16x32_bf16 v[108:111], v[124:127], a[80:83], v[108:111]
    ds_read_b64_tr_b16 v[138:139], v24 offset:28272
    v_mfma_f32_16x16x32_bf16 v[144:147], v[124:127], a[84:87], v[144:147]
    ds_read_b64_tr_b16 v[140:141], v24 offset:25744
    v_mfma_f32_16x16x32_bf16 v[156:159], v[124:127], v[40:43], v[156:159]
    ds_read_b64_tr_b16 v[142:143], v24 offset:28304
    v_mfma_f32_16x16x32_bf16 v[112:115], v[128:131], a[80:83], v[112:115]
    v_mfma_f32_16x16x32_bf16 v[148:151], v[128:131], a[84:87], v[148:151]
    buffer_load_dwordx2 v[220:221], v3, s[8:11], s39 offen offset:0
    v_mfma_f32_16x16x32_bf16 v[248:251], v[128:131], v[40:43], v[248:251]
    s_waitcnt lgkmcnt(0)
    v_mfma_f32_16x16x32_bf16 v[104:107], v[132:135], a[88:91], v[104:107]
    ds_read_b64_tr_b16 v[120:121], v24 offset:30720
    v_mfma_f32_16x16x32_bf16 v[116:119], v[132:135], a[92:95], v[116:119]
    ds_read_b64_tr_b16 v[122:123], v24 offset:33280
    v_mfma_f32_16x16x32_bf16 v[152:155], v[132:135], v[40:43], v[152:155]
    ds_read_b64_tr_b16 v[124:125], v24 offset:30752
    v_mfma_f32_16x16x32_bf16 v[108:111], v[136:139], a[88:91], v[108:111]
    ds_read_b64_tr_b16 v[126:127], v24 offset:33312
    v_mfma_f32_16x16x32_bf16 v[144:147], v[136:139], a[92:95], v[144:147]
    ds_read_b64_tr_b16 v[128:129], v24 offset:30784
    v_mfma_f32_16x16x32_bf16 v[156:159], v[136:139], v[40:43], v[156:159]
    ds_read_b64_tr_b16 v[130:131], v24 offset:33344
    v_mfma_f32_16x16x32_bf16 v[112:115], v[140:143], a[88:91], v[112:115]
    v_mfma_f32_16x16x32_bf16 v[148:151], v[140:143], a[92:95], v[148:151]
    buffer_load_dwordx2 v[222:223], v3, s[8:11], s39 offen offset:32
    v_mfma_f32_16x16x32_bf16 v[248:251], v[140:143], v[40:43], v[248:251]
    s_waitcnt lgkmcnt(0)
    v_mfma_f32_16x16x32_bf16 v[104:107], v[120:123], a[96:99], v[104:107]
    ds_read_b64_tr_b16 v[132:133], v24 offset:30800
    v_mfma_f32_16x16x32_bf16 v[116:119], v[120:123], a[100:103], v[116:119]
    ds_read_b64_tr_b16 v[134:135], v24 offset:33360
    v_mfma_f32_16x16x32_bf16 v[152:155], v[120:123], v[40:43], v[152:155]
    ds_read_b64_tr_b16 v[136:137], v24 offset:30832
    v_mfma_f32_16x16x32_bf16 v[108:111], v[124:127], a[96:99], v[108:111]
    ds_read_b64_tr_b16 v[138:139], v24 offset:33392
    v_mfma_f32_16x16x32_bf16 v[144:147], v[124:127], a[100:103], v[144:147]
    ds_read_b64_tr_b16 v[140:141], v24 offset:30864
    v_mfma_f32_16x16x32_bf16 v[156:159], v[124:127], v[40:43], v[156:159]
    ds_read_b64_tr_b16 v[142:143], v24 offset:33424
    v_mfma_f32_16x16x32_bf16 v[112:115], v[128:131], a[96:99], v[112:115]
    v_mfma_f32_16x16x32_bf16 v[148:151], v[128:131], a[100:103], v[148:151]
    buffer_load_dwordx2 v[224:225], v3, s[8:11], s39 offen offset:64
    v_mfma_f32_16x16x32_bf16 v[248:251], v[128:131], v[40:43], v[248:251]
    s_waitcnt lgkmcnt(0)
    v_mfma_f32_16x16x32_bf16 v[104:107], v[132:135], a[104:107], v[104:107]
    ds_read_b64_tr_b16 v[120:121], v24 offset:35840
    v_mfma_f32_16x16x32_bf16 v[116:119], v[132:135], a[108:111], v[116:119]
    ds_read_b64_tr_b16 v[122:123], v24 offset:38400
    v_mfma_f32_16x16x32_bf16 v[152:155], v[132:135], v[40:43], v[152:155]
    ds_read_b64_tr_b16 v[124:125], v24 offset:35872
    v_mfma_f32_16x16x32_bf16 v[108:111], v[136:139], a[104:107], v[108:111]
    ds_read_b64_tr_b16 v[126:127], v24 offset:38432
    v_mfma_f32_16x16x32_bf16 v[144:147], v[136:139], a[108:111], v[144:147]
    ds_read_b64_tr_b16 v[128:129], v24 offset:35904
    v_mfma_f32_16x16x32_bf16 v[156:159], v[136:139], v[40:43], v[156:159]
    ds_read_b64_tr_b16 v[130:131], v24 offset:38464
    v_mfma_f32_16x16x32_bf16 v[112:115], v[140:143], a[104:107], v[112:115]
    buffer_load_dwordx2 v[226:227], v3, s[8:11], s39 offen offset:96
    v_mfma_f32_16x16x32_bf16 v[148:151], v[140:143], a[108:111], v[148:151]
    buffer_load_dwordx2 v[228:229], v3, s[8:11], s39 offen offset:128
    v_mfma_f32_16x16x32_bf16 v[248:251], v[140:143], v[40:43], v[248:251]
    s_waitcnt lgkmcnt(0)
    v_mfma_f32_16x16x32_bf16 v[104:107], v[120:123], a[112:115], v[104:107]
    ds_read_b64_tr_b16 v[132:133], v24 offset:35920
    s_add_u32 m0, s4, 61440
    v_mfma_f32_16x16x32_bf16 v[116:119], v[120:123], a[116:119], v[116:119]
    ds_read_b64_tr_b16 v[134:135], v24 offset:38480
    v_mfma_f32_16x16x32_bf16 v[152:155], v[120:123], v[40:43], v[152:155]
    ds_read_b64_tr_b16 v[136:137], v24 offset:35952
    v_mfma_f32_16x16x32_bf16 v[108:111], v[124:127], a[112:115], v[108:111]
    ds_read_b64_tr_b16 v[138:139], v24 offset:38512
    s_add_u32 s62, s36, 12
    v_mfma_f32_16x16x32_bf16 v[144:147], v[124:127], a[116:119], v[144:147]
    ds_read_b64_tr_b16 v[140:141], v24 offset:35984
    v_mfma_f32_16x16x32_bf16 v[156:159], v[124:127], v[40:43], v[156:159]
    ds_read_b64_tr_b16 v[142:143], v24 offset:38544
    v_mfma_f32_16x16x32_bf16 v[112:115], v[128:131], a[112:115], v[112:115]
    s_mul_i32 s62, s62, 51200
    s_add_u32 s62, s62, 10240
    v_mfma_f32_16x16x32_bf16 v[148:151], v[128:131], a[116:119], v[148:151]
    s_add_u32 s62, s62, s5
    v_mfma_f32_16x16x32_bf16 v[248:251], v[128:131], v[40:43], v[248:251]
    buffer_load_dwordx4 v4, s[20:23], s62 offen  lds
    s_waitcnt lgkmcnt(0)
    v_mfma_f32_16x16x32_bf16 v[104:107], v[132:135], a[120:123], v[104:107]
    ds_read_b64_tr_b16 v[120:121], v24 offset:40960
    v_mfma_f32_16x16x32_bf16 v[116:119], v[132:135], a[124:127], v[116:119]
    ds_read_b64_tr_b16 v[122:123], v24 offset:43520
    v_mfma_f32_16x16x32_bf16 v[152:155], v[132:135], v[40:43], v[152:155]
    ds_read_b64_tr_b16 v[124:125], v24 offset:40992
    v_mfma_f32_16x16x32_bf16 v[108:111], v[136:139], a[120:123], v[108:111]
    ds_read_b64_tr_b16 v[126:127], v24 offset:43552
    v_mfma_f32_16x16x32_bf16 v[144:147], v[136:139], a[124:127], v[144:147]
    ds_read_b64_tr_b16 v[128:129], v24 offset:41024
    v_mfma_f32_16x16x32_bf16 v[156:159], v[136:139], v[40:43], v[156:159]
    ds_read_b64_tr_b16 v[130:131], v24 offset:43584
    v_mfma_f32_16x16x32_bf16 v[112:115], v[140:143], a[120:123], v[112:115]
    s_add_u32 m0, s4, 62464
    v_mfma_f32_16x16x32_bf16 v[148:151], v[140:143], a[124:127], v[148:151]
    s_nop 0
    v_mfma_f32_16x16x32_bf16 v[248:251], v[140:143], v[40:43], v[248:251]
    buffer_load_dwordx4 v5, s[20:23], s62 offen  lds
    s_waitcnt lgkmcnt(0)
    v_mfma_f32_16x16x32_bf16 v[104:107], v[120:123], a[128:131], v[104:107]
    ds_read_b64_tr_b16 v[132:133], v24 offset:41040
    v_mfma_f32_16x16x32_bf16 v[116:119], v[120:123], a[132:135], v[116:119]
    ds_read_b64_tr_b16 v[134:135], v24 offset:43600
    v_mfma_f32_16x16x32_bf16 v[152:155], v[120:123], v[40:43], v[152:155]
    ds_read_b64_tr_b16 v[136:137], v24 offset:41072
    v_mfma_f32_16x16x32_bf16 v[108:111], v[124:127], a[128:131], v[108:111]
    ds_read_b64_tr_b16 v[138:139], v24 offset:43632
    v_mfma_f32_16x16x32_bf16 v[144:147], v[124:127], a[132:135], v[144:147]
    ds_read_b64_tr_b16 v[140:141], v24 offset:41104
    v_mfma_f32_16x16x32_bf16 v[156:159], v[124:127], v[40:43], v[156:159]
    ds_read_b64_tr_b16 v[142:143], v24 offset:43664
    v_mfma_f32_16x16x32_bf16 v[112:115], v[128:131], a[128:131], v[112:115]
    s_add_u32 m0, s4, 63488
    v_mfma_f32_16x16x32_bf16 v[148:151], v[128:131], a[132:135], v[148:151]
    s_nop 0
    v_mfma_f32_16x16x32_bf16 v[248:251], v[128:131], v[40:43], v[248:251]
    buffer_load_dwordx4 v6, s[20:23], s62 offen  lds
    s_waitcnt lgkmcnt(0)
    v_mfma_f32_16x16x32_bf16 v[104:107], v[132:135], a[136:139], v[104:107]
    ds_read_b64_tr_b16 v[120:121], v24 offset:46080
    s_add_u32 m0, s4, 64512
    v_mfma_f32_16x16x32_bf16 v[116:119], v[132:135], a[140:143], v[116:119]
    ds_read_b64_tr_b16 v[122:123], v24 offset:48640
    v_mfma_f32_16x16x32_bf16 v[152:155], v[132:135], v[40:43], v[152:155]
    ds_read_b64_tr_b16 v[124:125], v24 offset:46112
    v_mfma_f32_16x16x32_bf16 v[108:111], v[136:139], a[136:139], v[108:111]
    ds_read_b64_tr_b16 v[126:127], v24 offset:48672
    s_nop 0
    v_mfma_f32_16x16x32_bf16 v[144:147], v[136:139], a[140:143], v[144:147]
    ds_read_b64_tr_b16 v[128:129], v24 offset:46144
    v_mfma_f32_16x16x32_bf16 v[156:159], v[136:139], v[40:43], v[156:159]
    ds_read_b64_tr_b16 v[130:131], v24 offset:48704
    v_mfma_f32_16x16x32_bf16 v[112:115], v[140:143], a[136:139], v[112:115]
    buffer_load_dwordx4 v7, s[20:23], s62 offen  lds
    s_add_u32 m0, s4, 65536
    v_mfma_f32_16x16x32_bf16 v[148:151], v[140:143], a[140:143], v[148:151]
    s_nop 0
    v_mfma_f32_16x16x32_bf16 v[248:251], v[140:143], v[40:43], v[248:251]
    buffer_load_dwordx4 v8, s[20:23], s62 offen  lds
    s_waitcnt lgkmcnt(0)
    v_mfma_f32_16x16x32_bf16 v[104:107], v[120:123], a[144:147], v[104:107]
    ds_read_b64_tr_b16 v[132:133], v24 offset:46160
    v_mfma_f32_16x16x32_bf16 v[116:119], v[120:123], a[148:151], v[116:119]
    ds_read_b64_tr_b16 v[134:135], v24 offset:48720
    v_mfma_f32_16x16x32_bf16 v[152:155], v[120:123], v[40:43], v[152:155]
    ds_read_b64_tr_b16 v[136:137], v24 offset:46192
    v_mfma_f32_16x16x32_bf16 v[108:111], v[124:127], a[144:147], v[108:111]
    ds_read_b64_tr_b16 v[138:139], v24 offset:48752
    v_mfma_f32_16x16x32_bf16 v[144:147], v[124:127], a[148:151], v[144:147]
    ds_read_b64_tr_b16 v[140:141], v24 offset:46224
    v_mfma_f32_16x16x32_bf16 v[156:159], v[124:127], v[40:43], v[156:159]
    ds_read_b64_tr_b16 v[142:143], v24 offset:48784
    v_mfma_f32_16x16x32_bf16 v[112:115], v[128:131], a[144:147], v[112:115]
    v_mfma_f32_16x16x32_bf16 v[148:151], v[128:131], a[148:151], v[148:151]
    v_mfma_f32_16x16x32_bf16 v[248:251], v[128:131], v[40:43], v[248:251]
    s_waitcnt lgkmcnt(0)
    v_mfma_f32_16x16x32_bf16 v[104:107], v[132:135], a[152:155], v[104:107]
    v_mfma_f32_16x16x32_bf16 v[116:119], v[132:135], a[156:159], v[116:119]
    v_mfma_f32_16x16x32_bf16 v[152:155], v[132:135], v[40:43], v[152:155]
    v_mfma_f32_16x16x32_bf16 v[108:111], v[136:139], a[152:155], v[108:111]
    v_mfma_f32_16x16x32_bf16 v[144:147], v[136:139], a[156:159], v[144:147]
    v_mfma_f32_16x16x32_bf16 v[156:159], v[136:139], v[40:43], v[156:159]
    v_mfma_f32_16x16x32_bf16 v[112:115], v[140:143], a[152:155], v[112:115]
    v_mfma_f32_16x16x32_bf16 v[148:151], v[140:143], a[156:159], v[148:151]
    v_mfma_f32_16x16x32_bf16 v[248:251], v[140:143], v[40:43], v[248:251]
    s_lshr_b32 s40, s35, 1
    s_mul_i32 s40, s40, 2560
    s_add_u32 s40, s40, 22020096
    v_and_b32 v18, 15, v0
    v_lshlrev_b32 v18, 2, v18
    s_mov_b32 s41, 100000
    v_bfe_u32 v19, v0, 4, 1
    v_mul_u32_u24 v19, 1280, v19
    v_add_u32 v18, v19, v18
P_45:
    buffer_load_dword v19, v18, s[16:19], s40 offen sc1
    s_waitcnt vmcnt(0)
    v_cmp_gt_u32 vcc, 1, v19
    s_sub_u32 s41, s41, 1
    s_cbranch_vccz P_46
    s_cmp_lg_u32 s41, 0
    s_cbranch_scc1 P_45
P_46:
    s_lshl_b32 s40, s3, 16
    s_add_u32 s40, s40, 19922944
    buffer_load_dwordx4 v[40:43], v37, s[16:19], s40 offen sc1
    s_add_u32 s40, s40, 4096
    buffer_load_dwordx4 v[44:47], v37, s[16:19], s40 offen sc1
    s_add_u32 s40, s40, 4096
    buffer_load_dwordx4 v[48:51], v37, s[16:19], s40 offen sc1
    s_add_u32 s40, s40, 4096
    buffer_load_dwordx4 v[52:55], v37, s[16:19], s40 offen sc1
    s_add_u32 s40, s40, 4096
    buffer_load_dwordx4 v[56:59], v37, s[16:19], s40 offen sc1
    s_add_u32 s40, s40, 4096
    buffer_load_dwordx4 v[60:63], v37, s[16:19], s40 offen sc1
    s_add_u32 s40, s40, 4096
    buffer_load_dwordx4 v[64:67], v37, s[16:19], s40 offen sc1
    s_add_u32 s40, s40, 4096
    buffer_load_dwordx4 v[68:71], v37, s[16:19], s40 offen sc1
    s_add_u32 s40, s40, 4096
    buffer_load_dwordx4 v[72:75], v37, s[16:19], s40 offen sc1
    s_add_u32 s40, s40, 4096
    buffer_load_dwordx4 v[76:79], v37, s[16:19], s40 offen sc1
    s_add_u32 s40, s40, 4096
    buffer_load_dwordx4 v[80:83], v37, s[16:19], s40 offen sc1
    s_add_u32 s40, s40, 4096
    buffer_load_dwordx4 v[84:87], v37, s[16:19], s40 offen sc1
    s_add_u32 s40, s40, 4096
    buffer_load_dwordx4 v[88:91], v37, s[16:19], s40 offen sc1
    s_add_u32 s40, s40, 4096
    buffer_load_dwordx4 v[92:95], v37, s[16:19], s40 offen sc1
    s_add_u32 s40, s40, 4096
    buffer_load_dwordx4 v[96:99], v37, s[16:19], s40 offen sc1
    s_add_u32 s40, s40, 4096
    buffer_load_dwordx4 v[100:103], v37, s[16:19], s40 offen sc1
    s_add_u32 s40, s40, 4096
    v_mul_f32 v206, 0x3fb8aa3b, v205
    v_mul_f32 v210, 0x3fb8aa3b, v209
    v_cmp_gt_u32 vcc, 32, v0
    v_pk_fma_f32 v[104:105], v[204:205], v[152:153], v[104:105] op_sel_hi:[0,1,1] neg_lo:[1,0,0] neg_hi:[1,0,0]
    v_pk_fma_f32 v[106:107], v[204:205], v[154:155], v[106:107] op_sel_hi:[0,1,1] neg_lo:[1,0,0] neg_hi:[1,0,0]
    s_mul_i32 s63, s64, 196608
    s_add_u32 s63, s63, s65
    buffer_load_dwordx4 a[0:3], v2, s[16:19], s63 offen offset:0 sc1
    v_pk_mul_f32 v[26:27], v[104:105], v[206:207] op_sel_hi:[1,0]
    v_pk_mul_f32 v[28:29], v[106:107], v[206:207] op_sel_hi:[1,0]
    v_exp_f32_e64 v26, v26 clamp
    v_exp_f32_e64 v27, v27 clamp
    v_exp_f32_e64 v28, v28 clamp
    v_exp_f32_e64 v29, v29 clamp
    v_max_f32 v104, 0, v104
    v_max_f32 v105, 0, v105
    buffer_load_dwordx4 a[4:7], v2, s[16:19], s63 offen offset:1024 sc1
    v_max_f32 v106, 0, v106
    v_max_f32 v107, 0, v107
    v_pk_add_f32 v[26:27], v[26:27], s[46:47] op_sel_hi:[1,0]
    v_pk_add_f32 v[28:29], v[28:29], s[46:47] op_sel_hi:[1,0]
    v_pk_fma_f32 v[104:105], v[104:105], v[204:205], v[26:27] op_sel:[0,1,0] op_sel_hi:[1,1,1]
    v_pk_fma_f32 v[106:107], v[106:107], v[204:205], v[28:29] op_sel:[0,1,0] op_sel_hi:[1,1,1]
    v_cvt_pk_bf16_f32 v232, v104, v105
    v_cvt_pk_bf16_f32 v233, v106, v107
    v_pk_fma_f32 v[108:109], v[204:205], v[156:157], v[108:109] op_sel_hi:[0,1,1] neg_lo:[1,0,0] neg_hi:[1,0,0]
    buffer_load_dwordx4 a[8:11], v2, s[16:19], s63 offen offset:2048 sc1
    s_add_u32 s64, s64, 1
    s_cmp_eq_u32 s64, 20
    s_cselect_b32 s64, 0, s64
    v_pk_fma_f32 v[110:111], v[204:205], v[158:159], v[110:111] op_sel_hi:[0,1,1] neg_lo:[1,0,0] neg_hi:[1,0,0]
    v_pk_mul_f32 v[26:27], v[108:109], v[206:207] op_sel_hi:[1,0]
    v_pk_mul_f32 v[28:29], v[110:111], v[206:207] op_sel_hi:[1,0]
    v_exp_f32_e64 v26, v26 clamp
    v_exp_f32_e64 v27, v27 clamp
    v_exp_f32_e64 v28, v28 clamp
    v_exp_f32_e64 v29, v29 clamp
    v_max_f32 v108, 0, v108
    s_mul_i32 s63, s64, 196608
    s_add_u32 s63, s63, s65
    buffer_load_dwordx4 a[12:15], v2, s[16:19], s63 offen offset:0 sc1
    v_max_f32 v109, 0, v109
    v_max_f32 v110, 0, v110
    v_max_f32 v111, 0, v111
    v_pk_add_f32 v[26:27], v[26:27], s[46:47] op_sel_hi:[1,0]
    v_pk_add_f32 v[28:29], v[28:29], s[46:47] op_sel_hi:[1,0]
    v_pk_fma_f32 v[108:109], v[108:109], v[204:205], v[26:27] op_sel:[0,1,0] op_sel_hi:[1,1,1]
    v_pk_fma_f32 v[110:111], v[110:111], v[204:205], v[28:29] op_sel:[0,1,0] op_sel_hi:[1,1,1]
    v_cvt_pk_bf16_f32 v234, v108, v109
    buffer_load_dwordx4 a[16:19], v2, s[16:19], s63 offen offset:1024 sc1
    v_cvt_pk_bf16_f32 v235, v110, v111
    v_pk_fma_f32 v[112:113], v[204:205], v[248:249], v[112:113] op_sel_hi:[0,1,1] neg_lo:[1,0,0] neg_hi:[1,0,0]
    v_pk_fma_f32 v[114:115], v[204:205], v[250:251], v[114:115] op_sel_hi:[0,1,1] neg_lo:[1,0,0] neg_hi:[1,0,0]
    v_pk_mul_f32 v[26:27], v[112:113], v[206:207] op_sel_hi:[1,0]
    v_pk_mul_f32 v[28:29], v[114:115], v[206:207] op_sel_hi:[1,0]
    v_exp_f32_e64 v26, v26 clamp
    v_exp_f32_e64 v27, v27 clamp
    v_exp_f32_e64 v28, v28 clamp
    v_exp_f32_e64 v29, v29 clamp
    buffer_load_dwordx4 a[20:23], v2, s[16:19], s63 offen offset:2048 sc1
    s_add_u32 s64, s64, 1
    s_cmp_eq_u32 s64, 20
    s_cselect_b32 s64, 0, s64
    v_max_f32 v112, 0, v112
    v_max_f32 v113, 0, v113
    v_max_f32 v114, 0, v114
    v_max_f32 v115, 0, v115
    v_pk_add_f32 v[26:27], v[26:27], s[46:47] op_sel_hi:[1,0]
    v_pk_add_f32 v[28:29], v[28:29], s[46:47] op_sel_hi:[1,0]
    v_pk_fma_f32 v[112:113], v[112:113], v[204:205], v[26:27] op_sel:[0,1,0] op_sel_hi:[1,1,1]
    v_pk_fma_f32 v[114:115], v[114:115], v[204:205], v[28:29] op_sel:[0,1,0] op_sel_hi:[1,1,1]
    s_mul_i32 s63, s64, 196608
    s_add_u32 s63, s63, s65
    buffer_load_dwordx4 a[24:27], v2, s[16:19], s63 offen offset:0 sc1
    v_cvt_pk_bf16_f32 v236, v112, v113
    v_cvt_pk_bf16_f32 v237, v114, v115
    v_cndmask_b32 v236, 0, v236, vcc
    v_cndmask_b32 v237, 0, v237, vcc
    v_mov_b32 v238, 0
    v_mov_b32 v239, 0
    v_pk_fma_f32 v[116:117], v[208:209], v[152:153], v[116:117] op_sel_hi:[0,1,1] neg_lo:[1,0,0] neg_hi:[1,0,0]
    v_pk_fma_f32 v[118:119], v[208:209], v[154:155], v[118:119] op_sel_hi:[0,1,1] neg_lo:[1,0,0] neg_hi:[1,0,0]
    v_pk_mul_f32 v[26:27], v[116:117], v[210:211] op_sel_hi:[1,0]
    buffer_load_dwordx4 a[28:31], v2, s[16:19], s63 offen offset:1024 sc1
    v_pk_mul_f32 v[28:29], v[118:119], v[210:211] op_sel_hi:[1,0]
    v_exp_f32_e64 v26, v26 clamp
    v_exp_f32_e64 v27, v27 clamp
    v_exp_f32_e64 v28, v28 clamp
    v_exp_f32_e64 v29, v29 clamp
    v_max_f32 v116, 0, v116
    v_max_f32 v117, 0, v117
    v_max_f32 v118, 0, v118
    buffer_load_dwordx4 a[32:35], v2, s[16:19], s63 offen offset:2048 sc1
    s_add_u32 s64, s64, 1
    s_cmp_eq_u32 s64, 20
    s_cselect_b32 s64, 0, s64
    v_max_f32 v119, 0, v119
    v_pk_add_f32 v[26:27], v[26:27], s[46:47] op_sel_hi:[1,0]
    v_pk_add_f32 v[28:29], v[28:29], s[46:47] op_sel_hi:[1,0]
    v_pk_fma_f32 v[116:117], v[116:117], v[208:209], v[26:27] op_sel:[0,1,0] op_sel_hi:[1,1,1]
    v_pk_fma_f32 v[118:119], v[118:119], v[208:209], v[28:29] op_sel:[0,1,0] op_sel_hi:[1,1,1]
    v_cvt_pk_bf16_f32 v240, v116, v117
    v_cvt_pk_bf16_f32 v241, v118, v119
    v_pk_fma_f32 v[144:145], v[208:209], v[156:157], v[144:145] op_sel_hi:[0,1,1] neg_lo:[1,0,0] neg_hi:[1,0,0]
    v_pk_fma_f32 v[146:147], v[208:209], v[158:159], v[146:147] op_sel_hi:[0,1,1] neg_lo:[1,0,0] neg_hi:[1,0,0]
    s_mul_i32 s63, s64, 196608
    s_add_u32 s63, s63, s65
    buffer_load_dwordx4 a[36:39], v2, s[16:19], s63 offen offset:0 sc1
    v_pk_mul_f32 v[26:27], v[144:145], v[210:211] op_sel_hi:[1,0]
    v_pk_mul_f32 v[28:29], v[146:147], v[210:211] op_sel_hi:[1,0]
    v_exp_f32_e64 v26, v26 clamp
    v_exp_f32_e64 v27, v27 clamp
    v_exp_f32_e64 v28, v28 clamp
    v_exp_f32_e64 v29, v29 clamp
    v_max_f32 v144, 0, v144
    v_max_f32 v145, 0, v145
    buffer_load_dwordx4 a[40:43], v2, s[16:19], s63 offen offset:1024 sc1
    v_max_f32 v146, 0, v146
    v_max_f32 v147, 0, v147
    v_pk_add_f32 v[26:27], v[26:27], s[46:47] op_sel_hi:[1,0]
    v_pk_add_f32 v[28:29], v[28:29], s[46:47] op_sel_hi:[1,0]
    v_pk_fma_f32 v[144:145], v[144:145], v[208:209], v[26:27] op_sel:[0,1,0] op_sel_hi:[1,1,1]
    v_pk_fma_f32 v[146:147], v[146:147], v[208:209], v[28:29] op_sel:[0,1,0] op_sel_hi:[1,1,1]
    v_cvt_pk_bf16_f32 v242, v144, v145
    v_cvt_pk_bf16_f32 v243, v146, v147
    v_pk_fma_f32 v[148:149], v[208:209], v[248:249], v[148:149] op_sel_hi:[0,1,1] neg_lo:[1,0,0] neg_hi:[1,0,0]
    buffer_load_dwordx4 a[44:47], v2, s[16:19], s63 offen offset:2048 sc1
    s_add_u32 s64, s64, 1
    s_cmp_eq_u32 s64, 20
    s_cselect_b32 s64, 0, s64
    v_pk_fma_f32 v[150:151], v[208:209], v[250:251], v[150:151] op_sel_hi:[0,1,1] neg_lo:[1,0,0] neg_hi:[1,0,0]
    v_pk_mul_f32 v[26:27], v[148:149], v[210:211] op_sel_hi:[1,0]
    v_pk_mul_f32 v[28:29], v[150:151], v[210:211] op_sel_hi:[1,0]
    v_exp_f32_e64 v26, v26 clamp
    v_exp_f32_e64 v27, v27 clamp
    v_exp_f32_e64 v28, v28 clamp
    v_exp_f32_e64 v29, v29 clamp
    v_max_f32 v148, 0, v148
    s_mul_i32 s63, s64, 196608
    s_add_u32 s63, s63, s65
    buffer_load_dwordx4 a[48:51], v2, s[16:19], s63 offen offset:0 sc1
    v_max_f32 v149, 0, v149
    v_max_f32 v150, 0, v150
    v_max_f32 v151, 0, v151
    v_pk_add_f32 v[26:27], v[26:27], s[46:47] op_sel_hi:[1,0]
    v_pk_add_f32 v[28:29], v[28:29], s[46:47] op_sel_hi:[1,0]
    v_pk_fma_f32 v[148:149], v[148:149], v[208:209], v[26:27] op_sel:[0,1,0] op_sel_hi:[1,1,1]
    v_pk_fma_f32 v[150:151], v[150:151], v[208:209], v[28:29] op_sel:[0,1,0] op_sel_hi:[1,1,1]
    v_cvt_pk_bf16_f32 v244, v148, v149
    buffer_load_dwordx4 a[52:55], v2, s[16:19], s63 offen offset:1024 sc1
    v_cvt_pk_bf16_f32 v245, v150, v151
    v_cndmask_b32 v244, 0, v244, vcc
    v_cndmask_b32 v245, 0, v245, vcc
    v_mov_b32 v246, 0
    v_mov_b32 v247, 0
    v_lshlrev_b32 v26, 3, v36
    v_add_u32 v26, 159744, v26
    v_add_u32 v160, 159744, v160
    v_add_u32 v170, 159744, v170
    buffer_load_dwordx4 a[56:59], v2, s[16:19], s63 offen offset:2048 sc1
    s_add_u32 s64, s64, 1
    s_cmp_eq_u32 s64, 20
    s_cselect_b32 s64, 0, s64
    v_add_u32 v161, 159744, v161
    v_add_u32 v171, 159744, v171
    v_add_u32 v162, 159744, v162
    v_add_u32 v172, 159744, v172
    v_add_u32 v163, 159744, v163
    v_add_u32 v173, 159744, v173
    v_add_u32 v164, 159744, v164
    v_add_u32 v174, 159744, v174
    s_mul_i32 s63, s64, 196608
    s_add_u32 s63, s63, s65
    buffer_load_dwordx4 a[60:63], v2, s[16:19], s63 offen offset:0 sc1
    v_add_u32 v165, 159744, v165
    v_add_u32 v175, 159744, v175
    v_add_u32 v166, 159744, v166
    v_add_u32 v176, 159744, v176
    s_waitcnt vmcnt(30)
    v_pk_add_f32 v[40:41], v[40:41], v[44:45]
    v_pk_add_f32 v[42:43], v[42:43], v[46:47]
    s_waitcnt vmcnt(29)
    v_pk_add_f32 v[40:41], v[40:41], v[48:49]
    v_pk_add_f32 v[42:43], v[42:43], v[50:51]
    s_waitcnt vmcnt(28)
    v_pk_add_f32 v[40:41], v[40:41], v[52:53]
    v_pk_add_f32 v[42:43], v[42:43], v[54:55]
    s_waitcnt vmcnt(27)
    v_pk_add_f32 v[40:41], v[40:41], v[56:57]
    v_pk_add_f32 v[42:43], v[42:43], v[58:59]
    s_waitcnt vmcnt(26)
    v_pk_add_f32 v[40:41], v[40:41], v[60:61]
    v_pk_add_f32 v[42:43], v[42:43], v[62:63]
    s_waitcnt vmcnt(25)
    v_pk_add_f32 v[40:41], v[40:41], v[64:65]
    v_pk_add_f32 v[42:43], v[42:43], v[66:67]
    s_waitcnt vmcnt(24)
    v_pk_add_f32 v[40:41], v[40:41], v[68:69]
    v_pk_add_f32 v[42:43], v[42:43], v[70:71]
    s_waitcnt vmcnt(23)
    v_pk_add_f32 v[40:41], v[40:41], v[72:73]
    v_pk_add_f32 v[42:43], v[42:43], v[74:75]
    s_waitcnt vmcnt(22)
    v_pk_add_f32 v[40:41], v[40:41], v[76:77]
    v_pk_add_f32 v[42:43], v[42:43], v[78:79]
    s_waitcnt vmcnt(21)
    v_pk_add_f32 v[40:41], v[40:41], v[80:81]
    v_pk_add_f32 v[42:43], v[42:43], v[82:83]
    s_waitcnt vmcnt(20)
    v_pk_add_f32 v[40:41], v[40:41], v[84:85]
    v_pk_add_f32 v[42:43], v[42:43], v[86:87]
    s_waitcnt vmcnt(19)
    v_pk_add_f32 v[40:41], v[40:41], v[88:89]
    v_pk_add_f32 v[42:43], v[42:43], v[90:91]
    s_waitcnt vmcnt(18)
    v_pk_add_f32 v[40:41], v[40:41], v[92:93]
    v_pk_add_f32 v[42:43], v[42:43], v[94:95]
    s_waitcnt vmcnt(17)
    v_pk_add_f32 v[40:41], v[40:41], v[96:97]
    v_pk_add_f32 v[42:43], v[42:43], v[98:99]
    s_waitcnt vmcnt(16)
    v_pk_add_f32 v[40:41], v[40:41], v[100:101]
    v_pk_add_f32 v[42:43], v[42:43], v[102:103]
    v_cvt_pk_bf16_f32 v40, v40, v41
    v_cvt_pk_bf16_f32 v41, v42, v43
    ds_write_b64 v26, v[40:41]
    buffer_load_dwordx4 a[64:67], v2, s[16:19], s63 offen offset:1024 sc1
    buffer_load_dwordx4 a[68:71], v2, s[16:19], s63 offen offset:2048 sc1
    s_add_u32 s64, s64, 1
    s_cmp_eq_u32 s64, 20
    s_cselect_b32 s64, 0, s64
    s_waitcnt lgkmcnt(0)
    s_barrier
    ds_read_b64 v[120:121], v160
    ds_read_b64 v[136:137], v170
    ds_read_b64 v[122:123], v161
    ds_read_b64 v[138:139], v171
    ds_read_b64 v[124:125], v162
    ds_read_b64 v[140:141], v172
    ds_read_b64 v[126:127], v163
    ds_read_b64 v[142:143], v173
    ds_read_b64 v[128:129], v164
    ds_read_b64 v[144:145], v174
    ds_read_b64 v[132:133], v165
    ds_read_b64 v[148:149], v175
    ds_read_b64 v[134:135], v166
    ds_read_b64 v[150:151], v176
    v_mov_b32 v130, 0
    v_mov_b32 v131, 0
    v_mov_b32 v146, 0
    v_mov_b32 v147, 0
    s_mul_i32 s63, s64, 196608
    s_add_u32 s63, s63, s65
    buffer_load_dwordx4 a[72:75], v2, s[16:19], s63 offen offset:0 sc1
    buffer_load_dwordx4 a[76:79], v2, s[16:19], s63 offen offset:1024 sc1
    s_lshl_b32 s40, s34, 2
    s_add_u32 s40, s40, s36
    s_mul_i32 s40, s40, 40960
    s_add_u32 s40, s40, 7340032
    s_lshl_b32 s41, s3, 10
    s_add_u32 s41, s41, s40
    s_lshl_b32 s42, s3, 8
    s_add_u32 s42, s42, s40
    s_add_u32 s42, s42, 16384
    v_lshlrev_b32 v26, 4, v0
    v_and_b32 v27, 0xf0, v26
    v_bfe_u32 v28, v0, 4, 1
    v_lshl_add_u32 v27, v28, 3, v27
    s_waitcnt lgkmcnt(0)
    v_mfma_f32_16x16x32_bf16 v[44:47], v[124:127], v[232:235], 0
    v_mfma_f32_16x16x32_bf16 v[40:43], v[120:123], v[232:235], 0
    v_mfma_f32_16x16x32_bf16 v[48:51], v[132:135], v[234:237], 0
    v_mfma_f32_16x16x32_bf16 v[44:47], v[128:131], v[236:239], v[44:47]
    v_mfma_f32_16x16x32_bf16 v[56:59], v[140:143], v[232:235], 0
    v_mfma_f32_16x16x32_bf16 v[52:55], v[136:139], v[232:235], 0
    v_mfma_f32_16x16x32_bf16 v[60:63], v[148:151], v[234:237], 0
    v_mfma_f32_16x16x32_bf16 v[56:59], v[144:147], v[236:239], v[56:59]
    v_mfma_f32_16x16x32_bf16 v[68:71], v[124:127], v[240:243], 0
    v_mfma_f32_16x16x32_bf16 v[64:67], v[120:123], v[240:243], 0
    v_mfma_f32_16x16x32_bf16 v[72:75], v[132:135], v[242:245], 0
    v_mfma_f32_16x16x32_bf16 v[68:71], v[128:131], v[244:247], v[68:71]
    v_mfma_f32_16x16x32_bf16 v[80:83], v[140:143], v[240:243], 0
    v_mfma_f32_16x16x32_bf16 v[76:79], v[136:139], v[240:243], 0
    v_mfma_f32_16x16x32_bf16 v[84:87], v[148:151], v[242:245], 0
    v_mfma_f32_16x16x32_bf16 v[80:83], v[144:147], v[244:247], v[80:83]
    buffer_load_dwordx4 a[80:83], v2, s[16:19], s63 offen offset:2048 sc1
    s_add_u32 s64, s64, 1
    s_cmp_eq_u32 s64, 20
    s_cselect_b32 s64, 0, s64
    s_mul_i32 s63, s64, 196608
    s_add_u32 s63, s63, s65
    buffer_load_dwordx4 a[84:87], v2, s[16:19], s63 offen offset:0 sc1
    s_nop 7
    v_add_f32 v52, 0x358637bd, v52
    v_add_f32 v56, 0x358637bd, v56
    v_add_f32 v60, 0x358637bd, v60
    v_rcp_f32 v52, v52
    v_rcp_f32 v56, v56
    v_rcp_f32 v60, v60
    s_nop 0
    v_mul_f32 v40, v40, v52
    v_mul_f32 v41, v41, v52
    v_mul_f32 v42, v42, v52
    v_mul_f32 v43, v43, v52
    v_mul_f32 v44, v44, v56
    v_mul_f32 v45, v45, v56
    v_mul_f32 v46, v46, v56
    v_mul_f32 v47, v47, v56
    v_mul_f32 v48, v48, v60
    v_mul_f32 v49, v49, v60
    v_mul_f32 v50, v50, v60
    v_mul_f32 v51, v51, v60
    v_cvt_pk_bf16_f32 v56, v40, v41
    v_cvt_pk_bf16_f32 v57, v42, v43
    v_cvt_pk_bf16_f32 v52, v44, v45
    v_cvt_pk_bf16_f32 v53, v46, v47
    v_cvt_pk_bf16_f32 v54, v48, v49
    v_cvt_pk_bf16_f32 v55, v50, v51
    buffer_store_dwordx4 v[52:55], v26, s[16:19], s41 offen sc0 sc1
    s_mov_b32 exec_lo, 0
    buffer_store_dwordx2 v[56:57], v27, s[16:19], s42 offen sc0 sc1
    s_mov_b32 exec_lo, -1
    s_add_u32 s41, s41, 20480
    s_add_u32 s42, s42, 20480
    v_add_f32 v76, 0x358637bd, v76
    v_add_f32 v80, 0x358637bd, v80
    v_add_f32 v84, 0x358637bd, v84
    v_rcp_f32 v76, v76
    v_rcp_f32 v80, v80
    v_rcp_f32 v84, v84
    s_nop 0
    v_mul_f32 v64, v64, v76
    v_mul_f32 v65, v65, v76
    v_mul_f32 v66, v66, v76
    v_mul_f32 v67, v67, v76
    v_mul_f32 v68, v68, v80
    v_mul_f32 v69, v69, v80
    v_mul_f32 v70, v70, v80
    v_mul_f32 v71, v71, v80
    v_mul_f32 v72, v72, v84
    v_mul_f32 v73, v73, v84
    v_mul_f32 v74, v74, v84
    v_mul_f32 v75, v75, v84
    v_cvt_pk_bf16_f32 v80, v64, v65
    v_cvt_pk_bf16_f32 v81, v66, v67
    v_cvt_pk_bf16_f32 v76, v68, v69
    v_cvt_pk_bf16_f32 v77, v70, v71
    v_cvt_pk_bf16_f32 v78, v72, v73
    v_cvt_pk_bf16_f32 v79, v74, v75
    buffer_store_dwordx4 v[76:79], v26, s[16:19], s41 offen sc0 sc1
    s_mov_b32 exec_lo, 0
    buffer_store_dwordx2 v[80:81], v27, s[16:19], s42 offen sc0 sc1
    s_mov_b32 exec_lo, -1
    v_add_u32 v23, 61440, v25
    s_and_b32 s13, s13, 0xffff
    s_mov_b32 s14, 2621440
    s_mul_i32 s42, s38, 20480
    s_add_u32 s42, s42, 7340032
    v_mov_b32 v204, 0x3f803f80
    v_mov_b32 v205, 0x3f803f80
    v_mov_b32 v206, 0x3f803f80
    v_mov_b32 v207, 0x3f803f80
    ds_read_b64_tr_b16 v[184:185], v25 offset:0
    buffer_load_dwordx4 a[88:91], v2, s[16:19], s63 offen offset:1024 sc1
    ds_read_b64_tr_b16 v[186:187], v25 offset:2560
    buffer_load_dwordx4 a[92:95], v2, s[16:19], s63 offen offset:2048 sc1
    s_add_u32 s64, s64, 1
    s_cmp_eq_u32 s64, 20
    s_cselect_b32 s64, 0, s64
    ds_read_b64_tr_b16 v[188:189], v25 offset:32
    s_mul_i32 s63, s64, 196608
    s_add_u32 s63, s63, s65
    buffer_load_dwordx4 a[96:99], v2, s[16:19], s63 offen offset:0 sc1
    ds_read_b64_tr_b16 v[190:191], v25 offset:2592
    buffer_load_dwordx4 a[100:103], v2, s[16:19], s63 offen offset:1024 sc1
    ds_read_b64_tr_b16 v[192:193], v25 offset:64
    buffer_load_dwordx4 a[104:107], v2, s[16:19], s63 offen offset:2048 sc1
    s_add_u32 s64, s64, 1
    s_cmp_eq_u32 s64, 20
    s_cselect_b32 s64, 0, s64
    ds_read_b64_tr_b16 v[194:195], v25 offset:2624
    s_mul_i32 s63, s64, 196608
    s_add_u32 s63, s63, s65
    buffer_load_dwordx4 a[108:111], v2, s[16:19], s63 offen offset:0 sc1
    ds_read_b64_tr_b16 v[196:197], v25 offset:96
    buffer_load_dwordx4 a[112:115], v2, s[16:19], s63 offen offset:1024 sc1
    ds_read_b64_tr_b16 v[198:199], v25 offset:2656
    buffer_load_dwordx4 a[116:119], v2, s[16:19], s63 offen offset:2048 sc1
    s_add_u32 s64, s64, 1
    s_cmp_eq_u32 s64, 20
    s_cselect_b32 s64, 0, s64
    ds_read_b64_tr_b16 v[200:201], v25 offset:128
    s_mul_i32 s63, s64, 196608
    s_add_u32 s63, s63, s65
    buffer_load_dwordx4 a[120:123], v2, s[16:19], s63 offen offset:0 sc1
    ds_read_b64_tr_b16 v[202:203], v25 offset:2688
    buffer_load_dwordx4 a[124:127], v2, s[16:19], s63 offen offset:1024 sc1
    s_waitcnt vmcnt(10)
    s_barrier
    s_cmp_lg_u32 s36, 0
    s_cbranch_scc1 W_47
    s_mov_b64 exec, 1
    v_mov_b32 v16, 0
    v_mov_b32 v17, 1
    buffer_store_dword v17, v16, s[16:19], s7 offen sc1
    s_mov_b64 exec, -1
W_47:
    ds_read_b64_tr_b16 v[44:45], v25 offset:5120
    buffer_load_dwordx4 a[128:131], v2, s[16:19], s63 offen offset:2048 sc1
    s_add_u32 s64, s64, 1
    s_cmp_eq_u32 s64, 20
    s_cselect_b32 s64, 0, s64
    s_mul_i32 s63, s64, 196608
    s_add_u32 s63, s63, s65
    buffer_load_dwordx4 a[132:135], v2, s[16:19], s63 offen offset:0 sc1
    ds_read_b64_tr_b16 v[46:47], v25 offset:7680
    buffer_load_dwordx4 a[136:139], v2, s[16:19], s63 offen offset:1024 sc1
    ds_read_b64_tr_b16 v[48:49], v25 offset:5152
    buffer_load_dwordx4 a[140:143], v2, s[16:19], s63 offen offset:2048 sc1
    s_add_u32 s64, s64, 1
    s_cmp_eq_u32 s64, 20
    s_cselect_b32 s64, 0, s64
    s_mul_i32 s63, s64, 196608
    s_add_u32 s63, s63, s65
    buffer_load_dwordx4 a[144:147], v2, s[16:19], s63 offen offset:0 sc1
    ds_read_b64_tr_b16 v[50:51], v25 offset:7712
    buffer_load_dwordx4 a[148:151], v2, s[16:19], s63 offen offset:1024 sc1
    ds_read_b64_tr_b16 v[52:53], v25 offset:5184
    buffer_load_dwordx4 a[152:155], v2, s[16:19], s63 offen offset:2048 sc1
    s_add_u32 s64, s64, 1
    s_cmp_eq_u32 s64, 20
    s_cselect_b32 s64, 0, s64
    s_mul_i32 s63, s64, 196608
    s_add_u32 s63, s63, s65
    buffer_load_dwordx4 a[156:159], v2, s[16:19], s63 offen offset:0 sc1
    ds_read_b64_tr_b16 v[54:55], v25 offset:7744
    buffer_load_dwordx4 a[160:163], v2, s[16:19], s63 offen offset:1024 sc1
    buffer_load_dwordx4 a[164:167], v2, s[16:19], s63 offen offset:2048 sc1
    s_add_u32 s64, s64, 1
    s_cmp_eq_u32 s64, 20
    s_cselect_b32 s64, 0, s64
    ds_read_b64_tr_b16 v[56:57], v25 offset:5216
    s_mul_i32 s63, s64, 196608
    s_add_u32 s63, s63, s65
    buffer_load_dwordx4 a[168:171], v2, s[16:19], s63 offen offset:0 sc1
    ds_read_b64_tr_b16 v[58:59], v25 offset:7776
    buffer_load_dwordx4 a[172:175], v2, s[16:19], s63 offen offset:1024 sc1
    buffer_load_dwordx4 a[176:179], v2, s[16:19], s63 offen offset:2048 sc1
    s_add_u32 s64, s64, 1
    s_cmp_eq_u32 s64, 20
    s_cselect_b32 s64, 0, s64
    ds_read_b64_tr_b16 v[60:61], v25 offset:5248
    s_mul_i32 s63, s64, 196608
    s_add_u32 s63, s63, s65
    buffer_load_dwordx4 a[180:183], v2, s[16:19], s63 offen offset:0 sc1
    ds_read_b64_tr_b16 v[62:63], v25 offset:7808
    buffer_load_dwordx4 a[184:187], v2, s[16:19], s63 offen offset:1024 sc1
    buffer_load_dwordx4 a[188:191], v2, s[16:19], s63 offen offset:2048 sc1
    s_add_u32 s64, s64, 1
    s_cmp_eq_u32 s64, 20
    s_cselect_b32 s64, 0, s64
    s_and_b32 s40, s7, 0xffffff80
    v_and_b32 v18, 15, v0
    v_lshlrev_b32 v18, 2, v18
    s_mov_b32 s41, 100000
P_48:
    buffer_load_dword v19, v18, s[16:19], s40 offen sc1
    s_waitcnt vmcnt(0)
    v_cmp_gt_u32 vcc, 1, v19
    s_sub_u32 s41, s41, 1
    s_cbranch_vccz P_49
    s_cmp_lg_u32 s41, 0
    s_cbranch_scc1 P_48
P_49:
    buffer_load_dwordx4 v[104:107], v2, s[16:19], s42 offen offset:0 sc1
    buffer_load_dwordx4 v[108:111], v2, s[16:19], s42 offen offset:1024 sc1
    buffer_load_dwordx4 v[112:115], v2, s[16:19], s42 offen offset:2048 sc1
    buffer_load_dwordx4 v[116:119], v2, s[16:19], s42 offen offset:3072 sc1
    s_add_u32 s42, s42, 4096
    buffer_load_dwordx4 v[120:123], v2, s[16:19], s42 offen offset:0 sc1
    buffer_load_dwordx4 v[124:127], v2, s[16:19], s42 offen offset:1024 sc1
    buffer_load_dwordx4 v[128:131], v2, s[16:19], s42 offen offset:2048 sc1
    buffer_load_dwordx4 v[132:135], v2, s[16:19], s42 offen offset:3072 sc1
    s_add_u32 s42, s42, 4096
    buffer_load_dwordx4 v[136:139], v2, s[16:19], s42 offen offset:0 sc1
    buffer_load_dwordx4 v[140:143], v2, s[16:19], s42 offen offset:1024 sc1
    buffer_load_dwordx4 v[144:147], v2, s[16:19], s42 offen offset:2048 sc1
    buffer_load_dwordx4 v[148:151], v2, s[16:19], s42 offen offset:3072 sc1
    s_add_u32 s42, s42, 4096
    buffer_load_dwordx4 v[152:155], v2, s[16:19], s42 offen offset:0 sc1
    buffer_load_dwordx4 v[156:159], v2, s[16:19], s42 offen offset:1024 sc1
    buffer_load_dwordx4 v[160:163], v2, s[16:19], s42 offen offset:2048 sc1
    buffer_load_dwordx4 v[164:167], v2, s[16:19], s42 offen offset:3072 sc1
    s_add_u32 s42, s42, 4096
    buffer_load_dwordx4 v[168:171], v2, s[16:19], s42 offen offset:0 sc1
    buffer_load_dwordx4 v[172:175], v2, s[16:19], s42 offen offset:1024 sc1
    buffer_load_dwordx4 v[176:179], v2, s[16:19], s42 offen offset:2048 sc1
    buffer_load_dwordx4 v[180:183], v2, s[16:19], s42 offen offset:3072 sc1
    s_add_u32 s42, s42, 4096
    v_mfma_f32_16x16x32_bf16 v[208:211], a[0:3], v[204:207], 0
    v_mfma_f32_16x16x32_bf16 v[212:215], a[4:7], v[204:207], 0
    v_mfma_f32_16x16x32_bf16 v[216:219], a[8:11], v[204:207], 0
    v_mfma_f32_16x16x32_bf16 v[208:211], a[12:15], v[204:207], v[208:211]
    v_mfma_f32_16x16x32_bf16 v[212:215], a[16:19], v[204:207], v[212:215]
    v_mfma_f32_16x16x32_bf16 v[216:219], a[20:23], v[204:207], v[216:219]
    v_mfma_f32_16x16x32_bf16 v[208:211], a[24:27], v[204:207], v[208:211]
    v_mfma_f32_16x16x32_bf16 v[212:215], a[28:31], v[204:207], v[212:215]
    v_mfma_f32_16x16x32_bf16 v[216:219], a[32:35], v[204:207], v[216:219]
    v_mfma_f32_16x16x32_bf16 v[208:211], a[36:39], v[204:207], v[208:211]
    v_mfma_f32_16x16x32_bf16 v[212:215], a[40:43], v[204:207], v[212:215]
    v_mfma_f32_16x16x32_bf16 v[216:219], a[44:47], v[204:207], v[216:219]
    v_mfma_f32_16x16x32_bf16 v[208:211], a[48:51], v[204:207], v[208:211]
    v_mfma_f32_16x16x32_bf16 v[212:215], a[52:55], v[204:207], v[212:215]
    v_mfma_f32_16x16x32_bf16 v[216:219], a[56:59], v[204:207], v[216:219]
    v_mfma_f32_16x16x32_bf16 v[208:211], a[60:63], v[204:207], v[208:211]
    v_mfma_f32_16x16x32_bf16 v[212:215], a[64:67], v[204:207], v[212:215]
    v_mfma_f32_16x16x32_bf16 v[216:219], a[68:71], v[204:207], v[216:219]
    v_mfma_f32_16x16x32_bf16 v[208:211], a[72:75], v[204:207], v[208:211]
    v_mfma_f32_16x16x32_bf16 v[212:215], a[76:79], v[204:207], v[212:215]
    v_mfma_f32_16x16x32_bf16 v[216:219], a[80:83], v[204:207], v[216:219]
    v_mfma_f32_16x16x32_bf16 v[208:211], a[84:87], v[204:207], v[208:211]
    v_mfma_f32_16x16x32_bf16 v[212:215], a[88:91], v[204:207], v[212:215]
    v_mfma_f32_16x16x32_bf16 v[216:219], a[92:95], v[204:207], v[216:219]
    v_mfma_f32_16x16x32_bf16 v[208:211], a[96:99], v[204:207], v[208:211]
    v_mfma_f32_16x16x32_bf16 v[212:215], a[100:103], v[204:207], v[212:215]
    v_mfma_f32_16x16x32_bf16 v[216:219], a[104:107], v[204:207], v[216:219]
    v_mfma_f32_16x16x32_bf16 v[208:211], a[108:111], v[204:207], v[208:211]
    v_mfma_f32_16x16x32_bf16 v[212:215], a[112:115], v[204:207], v[212:215]
    v_mfma_f32_16x16x32_bf16 v[216:219], a[116:119], v[204:207], v[216:219]
    v_mfma_f32_16x16x32_bf16 v[208:211], a[120:123], v[204:207], v[208:211]
    v_mfma_f32_16x16x32_bf16 v[212:215], a[124:127], v[204:207], v[212:215]
    v_mfma_f32_16x16x32_bf16 v[216:219], a[128:131], v[204:207], v[216:219]
    v_mfma_f32_16x16x32_bf16 v[208:211], a[132:135], v[204:207], v[208:211]
    v_mfma_f32_16x16x32_bf16 v[212:215], a[136:139], v[204:207], v[212:215]
    v_mfma_f32_16x16x32_bf16 v[216:219], a[140:143], v[204:207], v[216:219]
    v_mfma_f32_16x16x32_bf16 v[208:211], a[144:147], v[204:207], v[208:211]
    v_mfma_f32_16x16x32_bf16 v[212:215], a[148:151], v[204:207], v[212:215]
    v_mfma_f32_16x16x32_bf16 v[216:219], a[152:155], v[204:207], v[216:219]
    v_mfma_f32_16x16x32_bf16 v[208:211], a[156:159], v[204:207], v[208:211]
    v_mfma_f32_16x16x32_bf16 v[212:215], a[160:163], v[204:207], v[212:215]
    v_mfma_f32_16x16x32_bf16 v[216:219], a[164:167], v[204:207], v[216:219]
    v_mfma_f32_16x16x32_bf16 v[208:211], a[168:171], v[204:207], v[208:211]
    v_mfma_f32_16x16x32_bf16 v[212:215], a[172:175], v[204:207], v[212:215]
    v_mfma_f32_16x16x32_bf16 v[216:219], a[176:179], v[204:207], v[216:219]
    v_mfma_f32_16x16x32_bf16 v[208:211], a[180:183], v[204:207], v[208:211]
    v_mfma_f32_16x16x32_bf16 v[212:215], a[184:187], v[204:207], v[212:215]
    v_mfma_f32_16x16x32_bf16 v[216:219], a[188:191], v[204:207], v[216:219]
    s_waitcnt lgkmcnt(10) vmcnt(19)
    v_mfma_f32_16x16x32_bf16 v[84:87], v[184:187], v[104:107], 0
    ds_read_b64_tr_b16 v[64:65], v25 offset:10240
    ds_read_b64_tr_b16 v[66:67], v25 offset:12800
    ds_read_b64_tr_b16 v[68:69], v25 offset:10272
    v_mfma_f32_16x16x32_bf16 v[88:91], v[188:191], v[104:107], 0
    ds_read_b64_tr_b16 v[70:71], v25 offset:12832
    ds_read_b64_tr_b16 v[72:73], v25 offset:10304
    ds_read_b64_tr_b16 v[74:75], v25 offset:12864
    v_mfma_f32_16x16x32_bf16 v[92:95], v[192:195], v[104:107], 0
    ds_read_b64_tr_b16 v[76:77], v25 offset:10336
    ds_read_b64_tr_b16 v[78:79], v25 offset:12896
    ds_read_b64_tr_b16 v[80:81], v25 offset:10368
    v_mfma_f32_16x16x32_bf16 v[96:99], v[196:199], v[104:107], 0
    ds_read_b64_tr_b16 v[82:83], v25 offset:12928
    v_mfma_f32_16x16x32_bf16 v[100:103], v[200:203], v[104:107], 0
    s_waitcnt lgkmcnt(10) vmcnt(18)
    v_mfma_f32_16x16x32_bf16 v[84:87], v[44:47], v[108:111], v[84:87]
    ds_read_b64_tr_b16 v[184:185], v25 offset:15360
    ds_read_b64_tr_b16 v[186:187], v25 offset:17920
    ds_read_b64_tr_b16 v[188:189], v25 offset:15392
    v_mfma_f32_16x16x32_bf16 v[88:91], v[48:51], v[108:111], v[88:91]
    ds_read_b64_tr_b16 v[190:191], v25 offset:17952
    ds_read_b64_tr_b16 v[192:193], v25 offset:15424
    ds_read_b64_tr_b16 v[194:195], v25 offset:17984
    v_mfma_f32_16x16x32_bf16 v[92:95], v[52:55], v[108:111], v[92:95]
    ds_read_b64_tr_b16 v[196:197], v25 offset:15456
    ds_read_b64_tr_b16 v[198:199], v25 offset:18016
    ds_read_b64_tr_b16 v[200:201], v25 offset:15488
    v_mfma_f32_16x16x32_bf16 v[96:99], v[56:59], v[108:111], v[96:99]
    ds_read_b64_tr_b16 v[202:203], v25 offset:18048
    s_mul_i32 s63, s64, 196608
    v_mfma_f32_16x16x32_bf16 v[100:103], v[60:63], v[108:111], v[100:103]
    s_add_u32 s63, s63, s65
    buffer_load_dwordx4 a[192:195], v2, s[16:19], s63 offen offset:0 sc1
    s_waitcnt lgkmcnt(10) vmcnt(18)
    v_mfma_f32_16x16x32_bf16 v[84:87], v[64:67], v[112:115], v[84:87]
    ds_read_b64_tr_b16 v[44:45], v25 offset:20480
    ds_read_b64_tr_b16 v[46:47], v25 offset:23040
    ds_read_b64_tr_b16 v[48:49], v25 offset:20512
    v_mfma_f32_16x16x32_bf16 v[88:91], v[68:71], v[112:115], v[88:91]
    ds_read_b64_tr_b16 v[50:51], v25 offset:23072
    ds_read_b64_tr_b16 v[52:53], v25 offset:20544
    ds_read_b64_tr_b16 v[54:55], v25 offset:23104
    v_mfma_f32_16x16x32_bf16 v[92:95], v[72:75], v[112:115], v[92:95]
    ds_read_b64_tr_b16 v[56:57], v25 offset:20576
    ds_read_b64_tr_b16 v[58:59], v25 offset:23136
    ds_read_b64_tr_b16 v[60:61], v25 offset:20608
    v_mfma_f32_16x16x32_bf16 v[96:99], v[76:79], v[112:115], v[96:99]
    ds_read_b64_tr_b16 v[62:63], v25 offset:23168
    v_mfma_f32_16x16x32_bf16 v[100:103], v[80:83], v[112:115], v[100:103]
    s_waitcnt lgkmcnt(10) vmcnt(17)
    v_mfma_f32_16x16x32_bf16 v[84:87], v[184:187], v[116:119], v[84:87]
    ds_read_b64_tr_b16 v[64:65], v25 offset:25600
    ds_read_b64_tr_b16 v[66:67], v25 offset:28160
    ds_read_b64_tr_b16 v[68:69], v25 offset:25632
    v_mfma_f32_16x16x32_bf16 v[88:91], v[188:191], v[116:119], v[88:91]
    ds_read_b64_tr_b16 v[70:71], v25 offset:28192
    ds_read_b64_tr_b16 v[72:73], v25 offset:25664
    ds_read_b64_tr_b16 v[74:75], v25 offset:28224
    v_mfma_f32_16x16x32_bf16 v[92:95], v[192:195], v[116:119], v[92:95]
    ds_read_b64_tr_b16 v[76:77], v25 offset:25696
    ds_read_b64_tr_b16 v[78:79], v25 offset:28256
    ds_read_b64_tr_b16 v[80:81], v25 offset:25728
    v_mfma_f32_16x16x32_bf16 v[96:99], v[196:199], v[116:119], v[96:99]
    ds_read_b64_tr_b16 v[82:83], v25 offset:28288
    v_mfma_f32_16x16x32_bf16 v[100:103], v[200:203], v[116:119], v[100:103]
    buffer_load_dwordx4 a[196:199], v2, s[16:19], s63 offen offset:1024 sc1
    s_waitcnt lgkmcnt(10) vmcnt(17)
    v_mfma_f32_16x16x32_bf16 v[84:87], v[44:47], v[120:123], v[84:87]
    ds_read_b64_tr_b16 v[184:185], v25 offset:30720
    ds_read_b64_tr_b16 v[186:187], v25 offset:33280
    ds_read_b64_tr_b16 v[188:189], v25 offset:30752
    v_mfma_f32_16x16x32_bf16 v[88:91], v[48:51], v[120:123], v[88:91]
    ds_read_b64_tr_b16 v[190:191], v25 offset:33312
    ds_read_b64_tr_b16 v[192:193], v25 offset:30784
    ds_read_b64_tr_b16 v[194:195], v25 offset:33344
    v_mfma_f32_16x16x32_bf16 v[92:95], v[52:55], v[120:123], v[92:95]
    ds_read_b64_tr_b16 v[196:197], v25 offset:30816
    ds_read_b64_tr_b16 v[198:199], v25 offset:33376
    ds_read_b64_tr_b16 v[200:201], v25 offset:30848
    v_mfma_f32_16x16x32_bf16 v[96:99], v[56:59], v[120:123], v[96:99]
    ds_read_b64_tr_b16 v[202:203], v25 offset:33408
    buffer_load_dwordx4 a[200:203], v2, s[16:19], s63 offen offset:2048 sc1
    s_add_u32 s64, s64, 1
    v_mfma_f32_16x16x32_bf16 v[100:103], v[60:63], v[120:123], v[100:103]
    s_cmp_eq_u32 s64, 20
    s_cselect_b32 s64, 0, s64
    s_waitcnt lgkmcnt(10) vmcnt(17)
    v_mfma_f32_16x16x32_bf16 v[84:87], v[64:67], v[124:127], v[84:87]
    ds_read_b64_tr_b16 v[44:45], v25 offset:35840
    ds_read_b64_tr_b16 v[46:47], v25 offset:38400
    ds_read_b64_tr_b16 v[48:49], v25 offset:35872
    v_mfma_f32_16x16x32_bf16 v[88:91], v[68:71], v[124:127], v[88:91]
    ds_read_b64_tr_b16 v[50:51], v25 offset:38432
    ds_read_b64_tr_b16 v[52:53], v25 offset:35904
    ds_read_b64_tr_b16 v[54:55], v25 offset:38464
    v_mfma_f32_16x16x32_bf16 v[92:95], v[72:75], v[124:127], v[92:95]
    ds_read_b64_tr_b16 v[56:57], v25 offset:35936
    ds_read_b64_tr_b16 v[58:59], v25 offset:38496
    ds_read_b64_tr_b16 v[60:61], v25 offset:35968
    v_mfma_f32_16x16x32_bf16 v[96:99], v[76:79], v[124:127], v[96:99]
    ds_read_b64_tr_b16 v[62:63], v25 offset:38528
    v_mfma_f32_16x16x32_bf16 v[100:103], v[80:83], v[124:127], v[100:103]
    s_waitcnt lgkmcnt(10) vmcnt(16)
    v_mfma_f32_16x16x32_bf16 v[84:87], v[184:187], v[128:131], v[84:87]
    ds_read_b64_tr_b16 v[64:65], v25 offset:40960
    ds_read_b64_tr_b16 v[66:67], v25 offset:43520
    ds_read_b64_tr_b16 v[68:69], v25 offset:40992
    v_mfma_f32_16x16x32_bf16 v[88:91], v[188:191], v[128:131], v[88:91]
    ds_read_b64_tr_b16 v[70:71], v25 offset:43552
    ds_read_b64_tr_b16 v[72:73], v25 offset:41024
    ds_read_b64_tr_b16 v[74:75], v25 offset:43584
    v_mfma_f32_16x16x32_bf16 v[92:95], v[192:195], v[128:131], v[92:95]
    ds_read_b64_tr_b16 v[76:77], v25 offset:41056
    ds_read_b64_tr_b16 v[78:79], v25 offset:43616
    ds_read_b64_tr_b16 v[80:81], v25 offset:41088
    v_mfma_f32_16x16x32_bf16 v[96:99], v[196:199], v[128:131], v[96:99]
    ds_read_b64_tr_b16 v[82:83], v25 offset:43648
    s_mul_i32 s63, s64, 196608
    v_mfma_f32_16x16x32_bf16 v[100:103], v[200:203], v[128:131], v[100:103]
    s_add_u32 s63, s63, s65
    buffer_load_dwordx4 a[204:207], v2, s[16:19], s63 offen offset:0 sc1
    s_waitcnt lgkmcnt(10) vmcnt(16)
    v_mfma_f32_16x16x32_bf16 v[84:87], v[44:47], v[132:135], v[84:87]
    ds_read_b64_tr_b16 v[184:185], v25 offset:46080
    ds_read_b64_tr_b16 v[186:187], v25 offset:48640
    ds_read_b64_tr_b16 v[188:189], v25 offset:46112
    v_mfma_f32_16x16x32_bf16 v[88:91], v[48:51], v[132:135], v[88:91]
    ds_read_b64_tr_b16 v[190:191], v25 offset:48672
    ds_read_b64_tr_b16 v[192:193], v25 offset:46144
    ds_read_b64_tr_b16 v[194:195], v25 offset:48704
    v_mfma_f32_16x16x32_bf16 v[92:95], v[52:55], v[132:135], v[92:95]
    ds_read_b64_tr_b16 v[196:197], v25 offset:46176
    ds_read_b64_tr_b16 v[198:199], v25 offset:48736
    ds_read_b64_tr_b16 v[200:201], v25 offset:46208
    v_mfma_f32_16x16x32_bf16 v[96:99], v[56:59], v[132:135], v[96:99]
    ds_read_b64_tr_b16 v[202:203], v25 offset:48768
    v_mfma_f32_16x16x32_bf16 v[100:103], v[60:63], v[132:135], v[100:103]
    s_waitcnt lgkmcnt(10) vmcnt(15)
    v_mfma_f32_16x16x32_bf16 v[84:87], v[64:67], v[136:139], v[84:87]
    ds_read_b64_tr_b16 v[44:45], v25 offset:51200
    ds_read_b64_tr_b16 v[46:47], v25 offset:53760
    ds_read_b64_tr_b16 v[48:49], v25 offset:51232
    v_mfma_f32_16x16x32_bf16 v[88:91], v[68:71], v[136:139], v[88:91]
    ds_read_b64_tr_b16 v[50:51], v25 offset:53792
    ds_read_b64_tr_b16 v[52:53], v25 offset:51264
    ds_read_b64_tr_b16 v[54:55], v25 offset:53824
    v_mfma_f32_16x16x32_bf16 v[92:95], v[72:75], v[136:139], v[92:95]
    ds_read_b64_tr_b16 v[56:57], v25 offset:51296
    ds_read_b64_tr_b16 v[58:59], v25 offset:53856
    ds_read_b64_tr_b16 v[60:61], v25 offset:51328
    v_mfma_f32_16x16x32_bf16 v[96:99], v[76:79], v[136:139], v[96:99]
    ds_read_b64_tr_b16 v[62:63], v25 offset:53888
    v_mfma_f32_16x16x32_bf16 v[100:103], v[80:83], v[136:139], v[100:103]
    buffer_load_dwordx4 a[208:211], v2, s[16:19], s63 offen offset:1024 sc1
    s_waitcnt lgkmcnt(10) vmcnt(15)
    v_mfma_f32_16x16x32_bf16 v[84:87], v[184:187], v[140:143], v[84:87]
    ds_read_b64_tr_b16 v[64:65], v25 offset:56320
    ds_read_b64_tr_b16 v[66:67], v25 offset:58880
    ds_read_b64_tr_b16 v[68:69], v25 offset:56352
    v_mfma_f32_16x16x32_bf16 v[88:91], v[188:191], v[140:143], v[88:91]
    ds_read_b64_tr_b16 v[70:71], v25 offset:58912
    ds_read_b64_tr_b16 v[72:73], v25 offset:56384
    ds_read_b64_tr_b16 v[74:75], v25 offset:58944
    v_mfma_f32_16x16x32_bf16 v[92:95], v[192:195], v[140:143], v[92:95]
    ds_read_b64_tr_b16 v[76:77], v25 offset:56416
    ds_read_b64_tr_b16 v[78:79], v25 offset:58976
    ds_read_b64_tr_b16 v[80:81], v25 offset:56448
    v_mfma_f32_16x16x32_bf16 v[96:99], v[196:199], v[140:143], v[96:99]
    ds_read_b64_tr_b16 v[82:83], v25 offset:59008
    buffer_load_dwordx4 a[212:215], v2, s[16:19], s63 offen offset:2048 sc1
    s_add_u32 s64, s64, 1
    v_mfma_f32_16x16x32_bf16 v[100:103], v[200:203], v[140:143], v[100:103]
    s_cmp_eq_u32 s64, 20
    s_cselect_b32 s64, 0, s64
    s_waitcnt lgkmcnt(10) vmcnt(15)
    v_mfma_f32_16x16x32_bf16 v[84:87], v[44:47], v[144:147], v[84:87]
    ds_read_b64_tr_b16 v[184:185], v23 offset:0
    ds_read_b64_tr_b16 v[186:187], v23 offset:2560
    ds_read_b64_tr_b16 v[188:189], v23 offset:32
    v_mfma_f32_16x16x32_bf16 v[88:91], v[48:51], v[144:147], v[88:91]
    ds_read_b64_tr_b16 v[190:191], v23 offset:2592
    ds_read_b64_tr_b16 v[192:193], v23 offset:64
    ds_read_b64_tr_b16 v[194:195], v23 offset:2624
    v_mfma_f32_16x16x32_bf16 v[92:95], v[52:55], v[144:147], v[92:95]
    ds_read_b64_tr_b16 v[196:197], v23 offset:96
    ds_read_b64_tr_b16 v[198:199], v23 offset:2656
    ds_read_b64_tr_b16 v[200:201], v23 offset:128
    v_mfma_f32_16x16x32_bf16 v[96:99], v[56:59], v[144:147], v[96:99]
    ds_read_b64_tr_b16 v[202:203], v23 offset:2688
    v_mfma_f32_16x16x32_bf16 v[100:103], v[60:63], v[144:147], v[100:103]
    s_waitcnt lgkmcnt(10) vmcnt(14)
    v_mfma_f32_16x16x32_bf16 v[84:87], v[64:67], v[148:151], v[84:87]
    ds_read_b64_tr_b16 v[44:45], v23 offset:5120
    ds_read_b64_tr_b16 v[46:47], v23 offset:7680
    ds_read_b64_tr_b16 v[48:49], v23 offset:5152
    v_mfma_f32_16x16x32_bf16 v[88:91], v[68:71], v[148:151], v[88:91]
    ds_read_b64_tr_b16 v[50:51], v23 offset:7712
    ds_read_b64_tr_b16 v[52:53], v23 offset:5184
    ds_read_b64_tr_b16 v[54:55], v23 offset:7744
    v_mfma_f32_16x16x32_bf16 v[92:95], v[72:75], v[148:151], v[92:95]
    ds_read_b64_tr_b16 v[56:57], v23 offset:5216
    ds_read_b64_tr_b16 v[58:59], v23 offset:7776
    ds_read_b64_tr_b16 v[60:61], v23 offset:5248
    v_mfma_f32_16x16x32_bf16 v[96:99], v[76:79], v[148:151], v[96:99]
    ds_read_b64_tr_b16 v[62:63], v23 offset:7808
    s_mul_i32 s63, s64, 196608
    v_mfma_f32_16x16x32_bf16 v[100:103], v[80:83], v[148:151], v[100:103]
    s_add_u32 s63, s63, s65
    buffer_load_dwordx4 a[216:219], v2, s[16:19], s63 offen offset:0 sc1
    s_waitcnt lgkmcnt(10) vmcnt(14)
    v_mfma_f32_16x16x32_bf16 v[84:87], v[184:187], v[152:155], v[84:87]
    ds_read_b64_tr_b16 v[64:65], v23 offset:10240
    ds_read_b64_tr_b16 v[66:67], v23 offset:12800
    ds_read_b64_tr_b16 v[68:69], v23 offset:10272
    v_mfma_f32_16x16x32_bf16 v[88:91], v[188:191], v[152:155], v[88:91]
    ds_read_b64_tr_b16 v[70:71], v23 offset:12832
    ds_read_b64_tr_b16 v[72:73], v23 offset:10304
    ds_read_b64_tr_b16 v[74:75], v23 offset:12864
    v_mfma_f32_16x16x32_bf16 v[92:95], v[192:195], v[152:155], v[92:95]
    ds_read_b64_tr_b16 v[76:77], v23 offset:10336
    ds_read_b64_tr_b16 v[78:79], v23 offset:12896
    ds_read_b64_tr_b16 v[80:81], v23 offset:10368
    v_mfma_f32_16x16x32_bf16 v[96:99], v[196:199], v[152:155], v[96:99]
    ds_read_b64_tr_b16 v[82:83], v23 offset:12928
    v_mfma_f32_16x16x32_bf16 v[100:103], v[200:203], v[152:155], v[100:103]
    s_waitcnt lgkmcnt(10) vmcnt(13)
    v_mfma_f32_16x16x32_bf16 v[84:87], v[44:47], v[156:159], v[84:87]
    ds_read_b64_tr_b16 v[184:185], v23 offset:15360
    ds_read_b64_tr_b16 v[186:187], v23 offset:17920
    ds_read_b64_tr_b16 v[188:189], v23 offset:15392
    v_mfma_f32_16x16x32_bf16 v[88:91], v[48:51], v[156:159], v[88:91]
    ds_read_b64_tr_b16 v[190:191], v23 offset:17952
    ds_read_b64_tr_b16 v[192:193], v23 offset:15424
    ds_read_b64_tr_b16 v[194:195], v23 offset:17984
    v_mfma_f32_16x16x32_bf16 v[92:95], v[52:55], v[156:159], v[92:95]
    ds_read_b64_tr_b16 v[196:197], v23 offset:15456
    ds_read_b64_tr_b16 v[198:199], v23 offset:18016
    ds_read_b64_tr_b16 v[200:201], v23 offset:15488
    v_mfma_f32_16x16x32_bf16 v[96:99], v[56:59], v[156:159], v[96:99]
    ds_read_b64_tr_b16 v[202:203], v23 offset:18048
    v_mfma_f32_16x16x32_bf16 v[100:103], v[60:63], v[156:159], v[100:103]
    buffer_load_dwordx4 a[220:223], v2, s[16:19], s63 offen offset:1024 sc1
    s_waitcnt lgkmcnt(10) vmcnt(13)
    v_mfma_f32_16x16x32_bf16 v[84:87], v[64:67], v[160:163], v[84:87]
    ds_read_b64_tr_b16 v[44:45], v23 offset:20480
    ds_read_b64_tr_b16 v[46:47], v23 offset:23040
    ds_read_b64_tr_b16 v[48:49], v23 offset:20512
    v_mfma_f32_16x16x32_bf16 v[88:91], v[68:71], v[160:163], v[88:91]
    ds_read_b64_tr_b16 v[50:51], v23 offset:23072
    ds_read_b64_tr_b16 v[52:53], v23 offset:20544
    ds_read_b64_tr_b16 v[54:55], v23 offset:23104
    v_mfma_f32_16x16x32_bf16 v[92:95], v[72:75], v[160:163], v[92:95]
    ds_read_b64_tr_b16 v[56:57], v23 offset:20576
    ds_read_b64_tr_b16 v[58:59], v23 offset:23136
    ds_read_b64_tr_b16 v[60:61], v23 offset:20608
    v_mfma_f32_16x16x32_bf16 v[96:99], v[76:79], v[160:163], v[96:99]
    ds_read_b64_tr_b16 v[62:63], v23 offset:23168
    buffer_load_dwordx4 a[224:227], v2, s[16:19], s63 offen offset:2048 sc1
    s_add_u32 s64, s64, 1
    v_mfma_f32_16x16x32_bf16 v[100:103], v[80:83], v[160:163], v[100:103]
    s_cmp_eq_u32 s64, 20
    s_cselect_b32 s64, 0, s64
    s_waitcnt lgkmcnt(10) vmcnt(13)
    v_mfma_f32_16x16x32_bf16 v[84:87], v[184:187], v[164:167], v[84:87]
    ds_read_b64_tr_b16 v[64:65], v23 offset:25600
    ds_read_b64_tr_b16 v[66:67], v23 offset:28160
    ds_read_b64_tr_b16 v[68:69], v23 offset:25632
    v_mfma_f32_16x16x32_bf16 v[88:91], v[188:191], v[164:167], v[88:91]
    ds_read_b64_tr_b16 v[70:71], v23 offset:28192
    ds_read_b64_tr_b16 v[72:73], v23 offset:25664
    ds_read_b64_tr_b16 v[74:75], v23 offset:28224
    v_mfma_f32_16x16x32_bf16 v[92:95], v[192:195], v[164:167], v[92:95]
    ds_read_b64_tr_b16 v[76:77], v23 offset:25696
    ds_read_b64_tr_b16 v[78:79], v23 offset:28256
    ds_read_b64_tr_b16 v[80:81], v23 offset:25728
    v_mfma_f32_16x16x32_bf16 v[96:99], v[196:199], v[164:167], v[96:99]
    ds_read_b64_tr_b16 v[82:83], v23 offset:28288
    v_mfma_f32_16x16x32_bf16 v[100:103], v[200:203], v[164:167], v[100:103]
    s_waitcnt lgkmcnt(10) vmcnt(12)
    v_mfma_f32_16x16x32_bf16 v[84:87], v[44:47], v[168:171], v[84:87]
    ds_read_b64_tr_b16 v[184:185], v23 offset:30720
    ds_read_b64_tr_b16 v[186:187], v23 offset:33280
    ds_read_b64_tr_b16 v[188:189], v23 offset:30752
    v_mfma_f32_16x16x32_bf16 v[88:91], v[48:51], v[168:171], v[88:91]
    ds_read_b64_tr_b16 v[190:191], v23 offset:33312
    ds_read_b64_tr_b16 v[192:193], v23 offset:30784
    ds_read_b64_tr_b16 v[194:195], v23 offset:33344
    v_mfma_f32_16x16x32_bf16 v[92:95], v[52:55], v[168:171], v[92:95]
    ds_read_b64_tr_b16 v[196:197], v23 offset:30816
    ds_read_b64_tr_b16 v[198:199], v23 offset:33376
    ds_read_b64_tr_b16 v[200:201], v23 offset:30848
    v_mfma_f32_16x16x32_bf16 v[96:99], v[56:59], v[168:171], v[96:99]
    ds_read_b64_tr_b16 v[202:203], v23 offset:33408
    s_mul_i32 s63, s64, 196608
    v_mfma_f32_16x16x32_bf16 v[100:103], v[60:63], v[168:171], v[100:103]
    s_add_u32 s63, s63, s65
    buffer_load_dwordx4 a[228:231], v2, s[16:19], s63 offen offset:0 sc1
    s_waitcnt lgkmcnt(10) vmcnt(12)
    v_mfma_f32_16x16x32_bf16 v[84:87], v[64:67], v[172:175], v[84:87]
    ds_read_b64_tr_b16 v[44:45], v23 offset:35840
    ds_read_b64_tr_b16 v[46:47], v23 offset:38400
    ds_read_b64_tr_b16 v[48:49], v23 offset:35872
    v_mfma_f32_16x16x32_bf16 v[88:91], v[68:71], v[172:175], v[88:91]
    ds_read_b64_tr_b16 v[50:51], v23 offset:38432
    ds_read_b64_tr_b16 v[52:53], v23 offset:35904
    ds_read_b64_tr_b16 v[54:55], v23 offset:38464
    v_mfma_f32_16x16x32_bf16 v[92:95], v[72:75], v[172:175], v[92:95]
    ds_read_b64_tr_b16 v[56:57], v23 offset:35936
    ds_read_b64_tr_b16 v[58:59], v23 offset:38496
    ds_read_b64_tr_b16 v[60:61], v23 offset:35968
    v_mfma_f32_16x16x32_bf16 v[96:99], v[76:79], v[172:175], v[96:99]
    ds_read_b64_tr_b16 v[62:63], v23 offset:38528
    v_mfma_f32_16x16x32_bf16 v[100:103], v[80:83], v[172:175], v[100:103]
    s_waitcnt lgkmcnt(10) vmcnt(11)
    v_mfma_f32_16x16x32_bf16 v[84:87], v[184:187], v[176:179], v[84:87]
    buffer_load_dwordx4 a[232:235], v2, s[16:19], s63 offen offset:1024 sc1
    v_mfma_f32_16x16x32_bf16 v[88:91], v[188:191], v[176:179], v[88:91]
    v_mfma_f32_16x16x32_bf16 v[92:95], v[192:195], v[176:179], v[92:95]
    v_mfma_f32_16x16x32_bf16 v[96:99], v[196:199], v[176:179], v[96:99]
    v_mfma_f32_16x16x32_bf16 v[100:103], v[200:203], v[176:179], v[100:103]
    s_waitcnt lgkmcnt(0) vmcnt(11)
    v_mfma_f32_16x16x32_bf16 v[84:87], v[44:47], v[180:183], v[84:87]
    buffer_load_dwordx4 a[236:239], v2, s[16:19], s63 offen offset:2048 sc1
    v_mfma_f32_16x16x32_bf16 v[88:91], v[48:51], v[180:183], v[88:91]
    s_add_u32 s64, s64, 1
    v_mfma_f32_16x16x32_bf16 v[92:95], v[52:55], v[180:183], v[92:95]
    s_cmp_eq_u32 s64, 20
    v_mfma_f32_16x16x32_bf16 v[96:99], v[56:59], v[180:183], v[96:99]
    s_cselect_b32 s64, 0, s64
    v_mfma_f32_16x16x32_bf16 v[100:103], v[60:63], v[180:183], v[100:103]
    s_mul_i32 s43, s38, 20480
    s_add_u32 s43, s43, 10485760
    s_lshr_b32 s44, s37, 1
    s_lshl_b32 s44, s44, 10
    s_add_u32 s44, s44, s43
    s_and_b32 s45, s37, 1
    s_lshl_b32 s45, s45, 3
    s_add_u32 s44, s44, s45
    s_add_u32 s44, s44, 16384
    s_lshl_b32 s45, s37, 11
    s_add_u32 s43, s43, s45
    v_lshlrev_b32 v26, 16, v220
    v_and_b32 v27, 0xffff0000, v220
    v_pk_add_f32 v[84:85], v[84:85], v[26:27]
    v_cvt_pk_bf16_f32 v220, v84, v85
    v_lshlrev_b32 v26, 16, v221
    v_and_b32 v27, 0xffff0000, v221
    v_pk_add_f32 v[86:87], v[86:87], v[26:27]
    v_cvt_pk_bf16_f32 v221, v86, v87
    v_lshlrev_b32 v26, 16, v222
    v_and_b32 v27, 0xffff0000, v222
    v_pk_add_f32 v[88:89], v[88:89], v[26:27]
    v_cvt_pk_bf16_f32 v222, v88, v89
    v_lshlrev_b32 v26, 16, v223
    v_and_b32 v27, 0xffff0000, v223
    v_pk_add_f32 v[90:91], v[90:91], v[26:27]
    v_cvt_pk_bf16_f32 v223, v90, v91
    v_lshlrev_b32 v26, 16, v224
    v_and_b32 v27, 0xffff0000, v224
    v_pk_add_f32 v[92:93], v[92:93], v[26:27]
    v_cvt_pk_bf16_f32 v224, v92, v93
    v_lshlrev_b32 v26, 16, v225
    v_and_b32 v27, 0xffff0000, v225
    v_pk_add_f32 v[94:95], v[94:95], v[26:27]
    v_cvt_pk_bf16_f32 v225, v94, v95
    v_lshlrev_b32 v26, 16, v226
    v_and_b32 v27, 0xffff0000, v226
    v_pk_add_f32 v[96:97], v[96:97], v[26:27]
    v_cvt_pk_bf16_f32 v226, v96, v97
    v_lshlrev_b32 v26, 16, v227
    v_and_b32 v27, 0xffff0000, v227
    v_pk_add_f32 v[98:99], v[98:99], v[26:27]
    v_cvt_pk_bf16_f32 v227, v98, v99
    v_lshlrev_b32 v26, 16, v228
    v_and_b32 v27, 0xffff0000, v228
    v_pk_add_f32 v[100:101], v[100:101], v[26:27]
    v_cvt_pk_bf16_f32 v228, v100, v101
    v_lshlrev_b32 v26, 16, v229
    v_and_b32 v27, 0xffff0000, v229
    v_pk_add_f32 v[102:103], v[102:103], v[26:27]
    v_cvt_pk_bf16_f32 v229, v102, v103
    buffer_store_dwordx4 v[220:223], v2, s[16:19], s43 offen offset:0 sc0 sc1
    buffer_store_dwordx4 v[224:227], v2, s[16:19], s43 offen offset:1024 sc0 sc1
    buffer_store_dwordx2 v[228:229], v2, s[16:19], s44 offen offset:0 sc0 sc1
    v_mov_b32 v10, 0
    v_mov_b32 v11, 0
    v_mov_b32 v12, 0x3f803f80
    v_dot2c_f32_bf16 v10, v220, v12
    v_dot2c_f32_bf16 v11, v220, v220
    v_dot2c_f32_bf16 v10, v221, v12
    v_dot2c_f32_bf16 v11, v221, v221
    v_dot2c_f32_bf16 v10, v222, v12
    v_dot2c_f32_bf16 v11, v222, v222
    v_dot2c_f32_bf16 v10, v223, v12
    v_dot2c_f32_bf16 v11, v223, v223
    v_dot2c_f32_bf16 v10, v224, v12
    v_dot2c_f32_bf16 v11, v224, v224
    v_dot2c_f32_bf16 v10, v225, v12
    v_dot2c_f32_bf16 v11, v225, v225
    v_dot2c_f32_bf16 v10, v226, v12
    v_dot2c_f32_bf16 v11, v226, v226
    v_dot2c_f32_bf16 v10, v227, v12
    v_dot2c_f32_bf16 v11, v227, v227
    v_dot2c_f32_bf16 v10, v228, v12
    v_dot2c_f32_bf16 v11, v228, v228
    v_dot2c_f32_bf16 v10, v229, v12
    v_dot2c_f32_bf16 v11, v229, v229
    s_nop 1
    v_mov_b32 v12, v10
    v_mov_b32 v13, v11
    s_nop 1
    v_permlane32_swap_b32 v10, v12
    v_permlane32_swap_b32 v11, v13
    s_nop 1
    v_add_f32 v10, v10, v12
    v_add_f32 v11, v11, v13
    s_nop 1
    v_mov_b32 v12, v10
    v_mov_b32 v13, v11
    s_nop 1
    v_permlane16_swap_b32 v10, v12
    v_permlane16_swap_b32 v11, v13
    s_nop 1
    v_add_f32 v10, v10, v12
    v_add_f32 v11, v11, v13
    s_lshl_b32 s40, s38, 10
    s_lshl_b32 s41, s37, 3
    s_add_u32 s40, s40, s41
    s_add_u32 s40, s40, 20971520
    v_lshlrev_b32 v12, 6, v0
    s_mov_b64 exec, 0xffff
    buffer_store_dwordx2 v[10:11], v12, s[16:19], s40 offen offset:0 sc0 sc1
    s_mov_b64 exec, -1
    s_nop 0
    s_waitcnt vmcnt(0)
    s_barrier
    s_cmp_lg_u32 s36, 0
    s_cbranch_scc1 W_50
    s_mov_b64 exec, 1
    v_mov_b32 v16, 0
    v_mov_b32 v17, 2
    buffer_store_dword v17, v16, s[16:19], s7 offen sc1
    s_mov_b64 exec, -1
W_50:
    v_mfma_f32_16x16x32_bf16 v[208:211], a[192:195], v[204:207], v[208:211]
    v_mfma_f32_16x16x32_bf16 v[212:215], a[196:199], v[204:207], v[212:215]
    v_mfma_f32_16x16x32_bf16 v[216:219], a[200:203], v[204:207], v[216:219]
    v_mfma_f32_16x16x32_bf16 v[208:211], a[204:207], v[204:207], v[208:211]
    v_mfma_f32_16x16x32_bf16 v[212:215], a[208:211], v[204:207], v[212:215]
    v_mfma_f32_16x16x32_bf16 v[216:219], a[212:215], v[204:207], v[216:219]
    v_mfma_f32_16x16x32_bf16 v[208:211], a[216:219], v[204:207], v[208:211]
    v_mfma_f32_16x16x32_bf16 v[212:215], a[220:223], v[204:207], v[212:215]
    v_mfma_f32_16x16x32_bf16 v[216:219], a[224:227], v[204:207], v[216:219]
    v_mfma_f32_16x16x32_bf16 v[208:211], a[228:231], v[204:207], v[208:211]
    v_mfma_f32_16x16x32_bf16 v[212:215], a[232:235], v[204:207], v[212:215]
    v_mfma_f32_16x16x32_bf16 v[216:219], a[236:239], v[204:207], v[216:219]
    s_and_b32 s40, s7, 0xffffff80
    v_and_b32 v18, 15, v0
    v_lshlrev_b32 v18, 2, v18
    s_mov_b32 s41, 100000
P_51:
    buffer_load_dword v19, v18, s[16:19], s40 offen sc1
    s_waitcnt vmcnt(0)
    v_cmp_gt_u32 vcc, 2, v19
    s_sub_u32 s41, s41, 1
    s_cbranch_vccz P_52
    s_cmp_lg_u32 s41, 0
    s_cbranch_scc1 P_51
P_52:
    s_lshl_b32 s44, s34, 2
    s_add_u32 s44, s44, s36
    s_mul_i32 s44, s44, 40960
    s_add_u32 s44, s44, 10485760
    s_lshl_b32 s46, s36, 11
    s_lshl_b32 s41, s64, 10
    s_add_u32 m0, s46, 0
    s_add_u32 s41, s41, s44
    buffer_load_dwordx4 v2, s[16:19], s41 offen sc1 lds
    s_add_u32 m0, s46, 1024
    s_add_u32 s41, s41, 20480
    buffer_load_dwordx4 v2, s[16:19], s41 offen sc1 lds
    s_add_u32 s64, s64, 1
    s_cmp_eq_u32 s64, 20
    s_cselect_b32 s64, 0, s64
    s_lshl_b32 s41, s64, 10
    s_add_u32 m0, s46, 8192
    s_add_u32 s41, s41, s44
    buffer_load_dwordx4 v2, s[16:19], s41 offen sc1 lds
    s_add_u32 m0, s46, 9216
    s_add_u32 s41, s41, 20480
    buffer_load_dwordx4 v2, s[16:19], s41 offen sc1 lds
    s_add_u32 s64, s64, 1
    s_cmp_eq_u32 s64, 20
    s_cselect_b32 s64, 0, s64
    s_lshl_b32 s41, s64, 10
    s_add_u32 m0, s46, 16384
    s_add_u32 s41, s41, s44
    buffer_load_dwordx4 v2, s[16:19], s41 offen sc1 lds
    s_add_u32 m0, s46, 17408
    s_add_u32 s41, s41, 20480
    buffer_load_dwordx4 v2, s[16:19], s41 offen sc1 lds
    s_add_u32 s64, s64, 1
    s_cmp_eq_u32 s64, 20
    s_cselect_b32 s64, 0, s64
    s_lshl_b32 s41, s64, 10
    s_add_u32 m0, s46, 24576
    s_add_u32 s41, s41, s44
    buffer_load_dwordx4 v2, s[16:19], s41 offen sc1 lds
    s_add_u32 m0, s46, 25600
    s_add_u32 s41, s41, 20480
    buffer_load_dwordx4 v2, s[16:19], s41 offen sc1 lds
    s_add_u32 s64, s64, 1
    s_cmp_eq_u32 s64, 20
    s_cselect_b32 s64, 0, s64
    s_lshl_b32 s41, s64, 10
    s_add_u32 m0, s46, 32768
    s_add_u32 s41, s41, s44
    buffer_load_dwordx4 v2, s[16:19], s41 offen sc1 lds
    s_add_u32 m0, s46, 33792
    s_add_u32 s41, s41, 20480
    buffer_load_dwordx4 v2, s[16:19], s41 offen sc1 lds
    s_add_u32 s64, s64, 1
    s_cmp_eq_u32 s64, 20
    s_cselect_b32 s64, 0, s64
    s_lshl_b32 s41, s64, 10
    s_add_u32 m0, s46, 40960
    s_add_u32 s41, s41, s44
    buffer_load_dwordx4 v2, s[16:19], s41 offen sc1 lds
    s_add_u32 m0, s46, 41984
    s_add_u32 s41, s41, 20480
    buffer_load_dwordx4 v2, s[16:19], s41 offen sc1 lds
    s_add_u32 s64, s64, 1
    s_cmp_eq_u32 s64, 20
    s_cselect_b32 s64, 0, s64
    v_lshl_add_u32 v6, s36, 6, v0
    v_and_b32 v6, 127, v6
    v_lshlrev_b32 v7, 6, v6
    s_lshl_b32 s41, s34, 13
    s_add_u32 s41, s41, 20971520
    buffer_load_dwordx4 v[184:187], v7, s[16:19], s41 offen offset:0 sc1
    buffer_load_dwordx4 v[188:191], v7, s[16:19], s41 offen offset:16 sc1
    buffer_load_dwordx4 v[192:195], v7, s[16:19], s41 offen offset:32 sc1
    buffer_load_dwordx4 v[196:199], v7, s[16:19], s41 offen offset:48 sc1
    v_add_u32 v5, 0x10000, v2
    v_add_u32 v4, 4096, v2
    v_lshlrev_b32 v6, 3, v6
    v_add_u32 v6, 0x20000, v6
    s_mov_b32 s47, 0x3acccccd
    s_lshr_b32 s4, s38, 2
    s_mul_i32 s5, s37, 0
    s_add_u32 s4, s4, s5
    s_mul_i32 s41, s4, 5462
    s_lshr_b32 s41, s41, 16
    s_mul_i32 s41, s41, 12
    s_sub_u32 s4, s4, s41
    s_lshl_b32 s5, s37, 2
    s_add_u32 s5, s5, s36
    s_mul_i32 s5, s5, 61440
    s_add_u32 s5, s5, 5242880
    s_waitcnt vmcnt(12)
    s_barrier
    ds_read_b128 v[24:27], v2 offset:0
    ds_read_b128 v[28:31], v2 offset:1024
    ds_read_b128 v[32:35], v2 offset:2048
    ds_read_b128 v[36:39], v2 offset:3072
    ds_read_b128 v[40:43], v2 offset:4096
    ds_read_b128 v[44:47], v2 offset:5120
    ds_read_b128 v[48:51], v2 offset:6144
    ds_read_b128 v[52:55], v2 offset:7168
    s_waitcnt lgkmcnt(0)
    v_mfma_f32_16x16x32_bf16 v[88:91], a[0:3], v[24:27], 0
    ds_read_b128 v[56:59], v2 offset:8192
    s_lshl_b32 s41, s64, 10
    v_mfma_f32_16x16x32_bf16 v[92:95], a[4:7], v[24:27], 0
    ds_read_b128 v[60:63], v2 offset:9216
    v_mfma_f32_16x16x32_bf16 v[96:99], a[8:11], v[24:27], 0
    ds_read_b128 v[64:67], v2 offset:10240
    v_mfma_f32_16x16x32_bf16 v[100:103], a[0:3], v[28:31], 0
    ds_read_b128 v[68:71], v2 offset:11264
    v_mfma_f32_16x16x32_bf16 v[104:107], a[4:7], v[28:31], 0
    ds_read_b128 v[72:75], v2 offset:12288
    v_mfma_f32_16x16x32_bf16 v[108:111], a[8:11], v[28:31], 0
    ds_read_b128 v[76:79], v2 offset:13312
    v_mfma_f32_16x16x32_bf16 v[112:115], a[0:3], v[32:35], 0
    ds_read_b128 v[80:83], v2 offset:14336
    s_add_u32 m0, s46, 49152
    v_mfma_f32_16x16x32_bf16 v[116:119], a[4:7], v[32:35], 0
    ds_read_b128 v[84:87], v2 offset:15360
    v_mfma_f32_16x16x32_bf16 v[120:123], a[8:11], v[32:35], 0
    s_add_u32 s41, s41, s44
    v_mfma_f32_16x16x32_bf16 v[124:127], a[0:3], v[36:39], 0
    buffer_load_dwordx4 v2, s[16:19], s41 offen sc1 lds
    v_mfma_f32_16x16x32_bf16 v[128:131], a[4:7], v[36:39], 0
    s_add_u32 m0, s46, 50176
    v_mfma_f32_16x16x32_bf16 v[132:135], a[8:11], v[36:39], 0
    s_add_u32 s41, s41, 20480
    v_mfma_f32_16x16x32_bf16 v[136:139], a[0:3], v[40:43], 0
    buffer_load_dwordx4 v2, s[16:19], s41 offen sc1 lds
    s_add_u32 s64, s64, 1
    v_mfma_f32_16x16x32_bf16 v[140:143], a[4:7], v[40:43], 0
    s_cmp_eq_u32 s64, 20
    v_mfma_f32_16x16x32_bf16 v[144:147], a[8:11], v[40:43], 0
    s_cselect_b32 s64, 0, s64
    v_mfma_f32_16x16x32_bf16 v[148:151], a[0:3], v[44:47], 0
    s_lshl_b32 s41, s64, 10
    v_mfma_f32_16x16x32_bf16 v[152:155], a[4:7], v[44:47], 0
    s_add_u32 m0, s46, 57344
    v_mfma_f32_16x16x32_bf16 v[156:159], a[8:11], v[44:47], 0
    s_add_u32 s41, s41, s44
    v_mfma_f32_16x16x32_bf16 v[160:163], a[0:3], v[48:51], 0
    buffer_load_dwordx4 v2, s[16:19], s41 offen sc1 lds
    s_add_u32 m0, s46, 58368
    v_mfma_f32_16x16x32_bf16 v[164:167], a[4:7], v[48:51], 0
    s_add_u32 s41, s41, 20480
    v_mfma_f32_16x16x32_bf16 v[168:171], a[8:11], v[48:51], 0
    buffer_load_dwordx4 v2, s[16:19], s41 offen sc1 lds
    v_mfma_f32_16x16x32_bf16 v[172:175], a[0:3], v[52:55], 0
    s_add_u32 s64, s64, 1
    v_mfma_f32_16x16x32_bf16 v[176:179], a[4:7], v[52:55], 0
    s_cmp_eq_u32 s64, 20
    v_mfma_f32_16x16x32_bf16 v[180:183], a[8:11], v[52:55], 0
    s_cselect_b32 s64, 0, s64
    s_waitcnt lgkmcnt(0)
    s_waitcnt vmcnt(12)
    s_barrier
    v_mfma_f32_16x16x32_bf16 v[88:91], a[12:15], v[56:59], v[88:91]
    ds_read_b128 v[24:27], v2 offset:16384
    s_lshl_b32 s41, s64, 10
    v_mfma_f32_16x16x32_bf16 v[92:95], a[16:19], v[56:59], v[92:95]
    ds_read_b128 v[28:31], v2 offset:17408
    v_mfma_f32_16x16x32_bf16 v[96:99], a[20:23], v[56:59], v[96:99]
    ds_read_b128 v[32:35], v2 offset:18432
    v_mfma_f32_16x16x32_bf16 v[100:103], a[12:15], v[60:63], v[100:103]
    ds_read_b128 v[36:39], v2 offset:19456
    s_add_u32 m0, s46, 65536
    v_mfma_f32_16x16x32_bf16 v[104:107], a[16:19], v[60:63], v[104:107]
    ds_read_b128 v[40:43], v2 offset:20480
    v_mfma_f32_16x16x32_bf16 v[108:111], a[20:23], v[60:63], v[108:111]
    ds_read_b128 v[44:47], v2 offset:21504
    v_mfma_f32_16x16x32_bf16 v[112:115], a[12:15], v[64:67], v[112:115]
    ds_read_b128 v[48:51], v2 offset:22528
    s_add_u32 s41, s41, s44
    v_mfma_f32_16x16x32_bf16 v[116:119], a[16:19], v[64:67], v[116:119]
    ds_read_b128 v[52:55], v2 offset:23552
    v_mfma_f32_16x16x32_bf16 v[120:123], a[20:23], v[64:67], v[120:123]
    buffer_load_dwordx4 v2, s[16:19], s41 offen sc1 lds
    v_mfma_f32_16x16x32_bf16 v[124:127], a[12:15], v[68:71], v[124:127]
    s_add_u32 m0, s46, 66560
    v_mfma_f32_16x16x32_bf16 v[128:131], a[16:19], v[68:71], v[128:131]
    s_add_u32 s41, s41, 20480
    buffer_load_dwordx4 v2, s[16:19], s41 offen sc1 lds
    v_mfma_f32_16x16x32_bf16 v[132:135], a[20:23], v[68:71], v[132:135]
    s_add_u32 s64, s64, 1
    v_mfma_f32_16x16x32_bf16 v[136:139], a[12:15], v[72:75], v[136:139]
    s_cmp_eq_u32 s64, 20
    v_mfma_f32_16x16x32_bf16 v[140:143], a[16:19], v[72:75], v[140:143]
    s_cselect_b32 s64, 0, s64
    s_lshl_b32 s41, s64, 10
    v_mfma_f32_16x16x32_bf16 v[144:147], a[20:23], v[72:75], v[144:147]
    s_add_u32 m0, s46, 73728
    v_mfma_f32_16x16x32_bf16 v[148:151], a[12:15], v[76:79], v[148:151]
    s_add_u32 s41, s41, s44
    v_mfma_f32_16x16x32_bf16 v[152:155], a[16:19], v[76:79], v[152:155]
    buffer_load_dwordx4 v2, s[16:19], s41 offen sc1 lds
    v_mfma_f32_16x16x32_bf16 v[156:159], a[20:23], v[76:79], v[156:159]
    s_add_u32 m0, s46, 74752
    s_add_u32 s41, s41, 20480
    v_mfma_f32_16x16x32_bf16 v[160:163], a[12:15], v[80:83], v[160:163]
    buffer_load_dwordx4 v2, s[16:19], s41 offen sc1 lds
    v_mfma_f32_16x16x32_bf16 v[164:167], a[16:19], v[80:83], v[164:167]
    s_add_u32 s64, s64, 1
    v_mfma_f32_16x16x32_bf16 v[168:171], a[20:23], v[80:83], v[168:171]
    s_cmp_eq_u32 s64, 20
    s_cselect_b32 s64, 0, s64
    v_mfma_f32_16x16x32_bf16 v[172:175], a[12:15], v[84:87], v[172:175]
    s_mul_i32 s43, s4, 5120
    v_mfma_f32_16x16x32_bf16 v[176:179], a[16:19], v[84:87], v[176:179]
    s_add_u32 s43, s43, s5
    v_mfma_f32_16x16x32_bf16 v[180:183], a[20:23], v[84:87], v[180:183]
    buffer_load_dwordx4 a[0:3], v2, s[16:19], s43 offen offset:0 sc1
    s_waitcnt lgkmcnt(0)
    v_mfma_f32_16x16x32_bf16 v[88:91], a[24:27], v[24:27], v[88:91]
    ds_read_b128 v[56:59], v2 offset:24576
    s_lshl_b32 s41, s64, 10
    v_mfma_f32_16x16x32_bf16 v[92:95], a[28:31], v[24:27], v[92:95]
    ds_read_b128 v[60:63], v2 offset:25600
    v_mfma_f32_16x16x32_bf16 v[96:99], a[32:35], v[24:27], v[96:99]
    ds_read_b128 v[64:67], v2 offset:26624
    v_mfma_f32_16x16x32_bf16 v[100:103], a[24:27], v[28:31], v[100:103]
    ds_read_b128 v[68:71], v2 offset:27648
    v_mfma_f32_16x16x32_bf16 v[104:107], a[28:31], v[28:31], v[104:107]
    ds_read_b128 v[72:75], v2 offset:28672
    s_add_u32 m0, s46, 81920
    v_mfma_f32_16x16x32_bf16 v[108:111], a[32:35], v[28:31], v[108:111]
    ds_read_b128 v[76:79], v2 offset:29696
    v_mfma_f32_16x16x32_bf16 v[112:115], a[24:27], v[32:35], v[112:115]
    ds_read_b128 v[80:83], v2 offset:30720
    v_mfma_f32_16x16x32_bf16 v[116:119], a[28:31], v[32:35], v[116:119]
    ds_read_b128 v[84:87], v2 offset:31744
    v_mfma_f32_16x16x32_bf16 v[120:123], a[32:35], v[32:35], v[120:123]
    s_add_u32 s41, s41, s44
    v_mfma_f32_16x16x32_bf16 v[124:127], a[24:27], v[36:39], v[124:127]
    buffer_load_dwordx4 v2, s[16:19], s41 offen sc1 lds
    s_add_u32 m0, s46, 82944
    v_mfma_f32_16x16x32_bf16 v[128:131], a[28:31], v[36:39], v[128:131]
    s_add_u32 s41, s41, 20480
    v_mfma_f32_16x16x32_bf16 v[132:135], a[32:35], v[36:39], v[132:135]
    buffer_load_dwordx4 v2, s[16:19], s41 offen sc1 lds
    v_mfma_f32_16x16x32_bf16 v[136:139], a[24:27], v[40:43], v[136:139]
    s_add_u32 s64, s64, 1
    v_mfma_f32_16x16x32_bf16 v[140:143], a[28:31], v[40:43], v[140:143]
    s_cmp_eq_u32 s64, 20
    v_mfma_f32_16x16x32_bf16 v[144:147], a[32:35], v[40:43], v[144:147]
    s_cselect_b32 s64, 0, s64
    s_lshl_b32 s41, s64, 10
    v_mfma_f32_16x16x32_bf16 v[148:151], a[24:27], v[44:47], v[148:151]
    s_add_u32 m0, s46, 90112
    v_mfma_f32_16x16x32_bf16 v[152:155], a[28:31], v[44:47], v[152:155]
    s_add_u32 s41, s41, s44
    v_mfma_f32_16x16x32_bf16 v[156:159], a[32:35], v[44:47], v[156:159]
    buffer_load_dwordx4 v2, s[16:19], s41 offen sc1 lds
    v_mfma_f32_16x16x32_bf16 v[160:163], a[24:27], v[48:51], v[160:163]
    s_add_u32 m0, s46, 91136
    v_mfma_f32_16x16x32_bf16 v[164:167], a[28:31], v[48:51], v[164:167]
    s_add_u32 s41, s41, 20480
    buffer_load_dwordx4 v2, s[16:19], s41 offen sc1 lds
    v_mfma_f32_16x16x32_bf16 v[168:171], a[32:35], v[48:51], v[168:171]
    s_add_u32 s64, s64, 1
    v_mfma_f32_16x16x32_bf16 v[172:175], a[24:27], v[52:55], v[172:175]
    s_cmp_eq_u32 s64, 20
    v_mfma_f32_16x16x32_bf16 v[176:179], a[28:31], v[52:55], v[176:179]
    s_cselect_b32 s64, 0, s64
    v_mfma_f32_16x16x32_bf16 v[180:183], a[32:35], v[52:55], v[180:183]
    buffer_load_dwordx4 a[4:7], v2, s[16:19], s43 offen offset:1024 sc1
    s_waitcnt lgkmcnt(0)
    s_waitcnt vmcnt(18)
    s_barrier
    v_mfma_f32_16x16x32_bf16 v[88:91], a[36:39], v[56:59], v[88:91]
    ds_read_b128 v[24:27], v2 offset:32768
    s_lshl_b32 s41, s64, 10
    v_mfma_f32_16x16x32_bf16 v[92:95], a[40:43], v[56:59], v[92:95]
    ds_read_b128 v[28:31], v2 offset:33792
    v_mfma_f32_16x16x32_bf16 v[96:99], a[44:47], v[56:59], v[96:99]
    ds_read_b128 v[32:35], v2 offset:34816
    v_mfma_f32_16x16x32_bf16 v[100:103], a[36:39], v[60:63], v[100:103]
    ds_read_b128 v[36:39], v2 offset:35840
    v_mfma_f32_16x16x32_bf16 v[104:107], a[40:43], v[60:63], v[104:107]
    ds_read_b128 v[40:43], v2 offset:36864
    s_add_u32 m0, s46, 98304
    v_mfma_f32_16x16x32_bf16 v[108:111], a[44:47], v[60:63], v[108:111]
    ds_read_b128 v[44:47], v2 offset:37888
    v_mfma_f32_16x16x32_bf16 v[112:115], a[36:39], v[64:67], v[112:115]
    ds_read_b128 v[48:51], v2 offset:38912
    v_mfma_f32_16x16x32_bf16 v[116:119], a[40:43], v[64:67], v[116:119]
    ds_read_b128 v[52:55], v2 offset:39936
    v_mfma_f32_16x16x32_bf16 v[120:123], a[44:47], v[64:67], v[120:123]
    s_add_u32 s41, s41, s44
    v_mfma_f32_16x16x32_bf16 v[124:127], a[36:39], v[68:71], v[124:127]
    buffer_load_dwordx4 v2, s[16:19], s41 offen sc1 lds
    s_add_u32 m0, s46, 99328
    v_mfma_f32_16x16x32_bf16 v[128:131], a[40:43], v[68:71], v[128:131]
    s_add_u32 s41, s41, 20480
    v_mfma_f32_16x16x32_bf16 v[132:135], a[44:47], v[68:71], v[132:135]
    buffer_load_dwordx4 v2, s[16:19], s41 offen sc1 lds
    v_mfma_f32_16x16x32_bf16 v[136:139], a[36:39], v[72:75], v[136:139]
    s_add_u32 s64, s64, 1
    v_mfma_f32_16x16x32_bf16 v[140:143], a[40:43], v[72:75], v[140:143]
    s_cmp_eq_u32 s64, 20
    v_mfma_f32_16x16x32_bf16 v[144:147], a[44:47], v[72:75], v[144:147]
    s_cselect_b32 s64, 0, s64
    s_lshl_b32 s41, s64, 10
    v_mfma_f32_16x16x32_bf16 v[148:151], a[36:39], v[76:79], v[148:151]
    s_add_u32 m0, s46, 106496
    v_mfma_f32_16x16x32_bf16 v[152:155], a[40:43], v[76:79], v[152:155]
    s_add_u32 s41, s41, s44
    v_mfma_f32_16x16x32_bf16 v[156:159], a[44:47], v[76:79], v[156:159]
    buffer_load_dwordx4 v2, s[16:19], s41 offen sc1 lds
    v_mfma_f32_16x16x32_bf16 v[160:163], a[36:39], v[80:83], v[160:163]
    s_add_u32 m0, s46, 107520
    v_mfma_f32_16x16x32_bf16 v[164:167], a[40:43], v[80:83], v[164:167]
    s_add_u32 s41, s41, 20480
    buffer_load_dwordx4 v2, s[16:19], s41 offen sc1 lds
    v_mfma_f32_16x16x32_bf16 v[168:171], a[44:47], v[80:83], v[168:171]
    s_add_u32 s64, s64, 1
    v_mfma_f32_16x16x32_bf16 v[172:175], a[36:39], v[84:87], v[172:175]
    s_cmp_eq_u32 s64, 20
    v_mfma_f32_16x16x32_bf16 v[176:179], a[40:43], v[84:87], v[176:179]
    s_cselect_b32 s64, 0, s64
    v_mfma_f32_16x16x32_bf16 v[180:183], a[44:47], v[84:87], v[180:183]
    buffer_load_dwordx4 a[8:11], v2, s[16:19], s43 offen offset:2048 sc1
    s_waitcnt lgkmcnt(0)
    v_mfma_f32_16x16x32_bf16 v[88:91], a[48:51], v[24:27], v[88:91]
    ds_read_b128 v[56:59], v2 offset:40960
    s_lshl_b32 s41, s64, 10
    v_mfma_f32_16x16x32_bf16 v[92:95], a[52:55], v[24:27], v[92:95]
    ds_read_b128 v[60:63], v2 offset:41984
    v_mfma_f32_16x16x32_bf16 v[96:99], a[56:59], v[24:27], v[96:99]
    ds_read_b128 v[64:67], v2 offset:43008
    v_mfma_f32_16x16x32_bf16 v[100:103], a[48:51], v[28:31], v[100:103]
    ds_read_b128 v[68:71], v2 offset:44032
    v_mfma_f32_16x16x32_bf16 v[104:107], a[52:55], v[28:31], v[104:107]
    ds_read_b128 v[72:75], v2 offset:45056
    s_add_u32 m0, s46, 114688
    v_mfma_f32_16x16x32_bf16 v[108:111], a[56:59], v[28:31], v[108:111]
    ds_read_b128 v[76:79], v2 offset:46080
    v_mfma_f32_16x16x32_bf16 v[112:115], a[48:51], v[32:35], v[112:115]
    ds_read_b128 v[80:83], v2 offset:47104
    v_mfma_f32_16x16x32_bf16 v[116:119], a[52:55], v[32:35], v[116:119]
    ds_read_b128 v[84:87], v2 offset:48128
    v_mfma_f32_16x16x32_bf16 v[120:123], a[56:59], v[32:35], v[120:123]
    s_add_u32 s41, s41, s44
    v_mfma_f32_16x16x32_bf16 v[124:127], a[48:51], v[36:39], v[124:127]
    buffer_load_dwordx4 v2, s[16:19], s41 offen sc1 lds
    s_add_u32 m0, s46, 115712
    v_mfma_f32_16x16x32_bf16 v[128:131], a[52:55], v[36:39], v[128:131]
    s_add_u32 s41, s41, 20480
    v_mfma_f32_16x16x32_bf16 v[132:135], a[56:59], v[36:39], v[132:135]
    buffer_load_dwordx4 v2, s[16:19], s41 offen sc1 lds
    v_mfma_f32_16x16x32_bf16 v[136:139], a[48:51], v[40:43], v[136:139]
    s_add_u32 s64, s64, 1
    v_mfma_f32_16x16x32_bf16 v[140:143], a[52:55], v[40:43], v[140:143]
    s_cmp_eq_u32 s64, 20
    v_mfma_f32_16x16x32_bf16 v[144:147], a[56:59], v[40:43], v[144:147]
    s_cselect_b32 s64, 0, s64
    s_lshl_b32 s41, s64, 10
    v_mfma_f32_16x16x32_bf16 v[148:151], a[48:51], v[44:47], v[148:151]
    s_add_u32 m0, s46, 122880
    v_mfma_f32_16x16x32_bf16 v[152:155], a[52:55], v[44:47], v[152:155]
    s_add_u32 s41, s41, s44
    v_mfma_f32_16x16x32_bf16 v[156:159], a[56:59], v[44:47], v[156:159]
    buffer_load_dwordx4 v2, s[16:19], s41 offen sc1 lds
    v_mfma_f32_16x16x32_bf16 v[160:163], a[48:51], v[48:51], v[160:163]
    s_add_u32 m0, s46, 123904
    v_mfma_f32_16x16x32_bf16 v[164:167], a[52:55], v[48:51], v[164:167]
    s_add_u32 s41, s41, 20480
    buffer_load_dwordx4 v2, s[16:19], s41 offen sc1 lds
    v_mfma_f32_16x16x32_bf16 v[168:171], a[56:59], v[48:51], v[168:171]
    s_add_u32 s64, s64, 1
    v_mfma_f32_16x16x32_bf16 v[172:175], a[48:51], v[52:55], v[172:175]
    s_cmp_eq_u32 s64, 20
    v_mfma_f32_16x16x32_bf16 v[176:179], a[52:55], v[52:55], v[176:179]
    s_cselect_b32 s64, 0, s64
    v_mfma_f32_16x16x32_bf16 v[180:183], a[56:59], v[52:55], v[180:183]
    buffer_load_dwordx4 a[12:15], v2, s[16:19], s43 offen offset:3072 sc1
    s_waitcnt lgkmcnt(0)
    s_waitcnt vmcnt(20)
    s_barrier
    v_mfma_f32_16x16x32_bf16 v[88:91], a[60:63], v[56:59], v[88:91]
    ds_read_b128 v[24:27], v2 offset:49152
    s_lshl_b32 s41, s64, 10
    v_mfma_f32_16x16x32_bf16 v[92:95], a[64:67], v[56:59], v[92:95]
    ds_read_b128 v[28:31], v2 offset:50176
    v_mfma_f32_16x16x32_bf16 v[96:99], a[68:71], v[56:59], v[96:99]
    ds_read_b128 v[32:35], v2 offset:51200
    v_mfma_f32_16x16x32_bf16 v[100:103], a[60:63], v[60:63], v[100:103]
    ds_read_b128 v[36:39], v2 offset:52224
    s_add_u32 m0, s46, 0
    v_mfma_f32_16x16x32_bf16 v[104:107], a[64:67], v[60:63], v[104:107]
    ds_read_b128 v[40:43], v2 offset:53248
    v_mfma_f32_16x16x32_bf16 v[108:111], a[68:71], v[60:63], v[108:111]
    ds_read_b128 v[44:47], v2 offset:54272
    v_mfma_f32_16x16x32_bf16 v[112:115], a[60:63], v[64:67], v[112:115]
    ds_read_b128 v[48:51], v2 offset:55296
    s_add_u32 s41, s41, s44
    v_mfma_f32_16x16x32_bf16 v[116:119], a[64:67], v[64:67], v[116:119]
    ds_read_b128 v[52:55], v2 offset:56320
    v_mfma_f32_16x16x32_bf16 v[120:123], a[68:71], v[64:67], v[120:123]
    buffer_load_dwordx4 v2, s[16:19], s41 offen sc1 lds
    v_mfma_f32_16x16x32_bf16 v[124:127], a[60:63], v[68:71], v[124:127]
    s_add_u32 m0, s46, 1024
    s_add_u32 s41, s41, 20480
    v_mfma_f32_16x16x32_bf16 v[128:131], a[64:67], v[68:71], v[128:131]
    buffer_load_dwordx4 v2, s[16:19], s41 offen sc1 lds
    v_mfma_f32_16x16x32_bf16 v[132:135], a[68:71], v[68:71], v[132:135]
    s_add_u32 s64, s64, 1
    v_mfma_f32_16x16x32_bf16 v[136:139], a[60:63], v[72:75], v[136:139]
    s_cmp_eq_u32 s64, 20
    s_cselect_b32 s64, 0, s64
    v_mfma_f32_16x16x32_bf16 v[140:143], a[64:67], v[72:75], v[140:143]
    s_lshl_b32 s41, s64, 10
    v_mfma_f32_16x16x32_bf16 v[144:147], a[68:71], v[72:75], v[144:147]
    s_add_u32 m0, s46, 8192
    v_mfma_f32_16x16x32_bf16 v[148:151], a[60:63], v[76:79], v[148:151]
    s_add_u32 s41, s41, s44
    buffer_load_dwordx4 v2, s[16:19], s41 offen sc1 lds
    v_mfma_f32_16x16x32_bf16 v[152:155], a[64:67], v[76:79], v[152:155]
    s_add_u32 m0, s46, 9216
    v_mfma_f32_16x16x32_bf16 v[156:159], a[68:71], v[76:79], v[156:159]
    s_add_u32 s41, s41, 20480
    v_mfma_f32_16x16x32_bf16 v[160:163], a[60:63], v[80:83], v[160:163]
    buffer_load_dwordx4 v2, s[16:19], s41 offen sc1 lds
    s_add_u32 s64, s64, 1
    v_mfma_f32_16x16x32_bf16 v[164:167], a[64:67], v[80:83], v[164:167]
    s_cmp_eq_u32 s64, 20
    v_mfma_f32_16x16x32_bf16 v[168:171], a[68:71], v[80:83], v[168:171]
    s_cselect_b32 s64, 0, s64
    v_mfma_f32_16x16x32_bf16 v[172:175], a[60:63], v[84:87], v[172:175]
    buffer_load_dwordx4 a[16:19], v4, s[16:19], s43 offen offset:0 sc1
    s_add_u32 s4, s4, 1
    v_mfma_f32_16x16x32_bf16 v[176:179], a[64:67], v[84:87], v[176:179]
    s_cmp_eq_u32 s4, 12
    v_mfma_f32_16x16x32_bf16 v[180:183], a[68:71], v[84:87], v[180:183]
    s_cselect_b32 s4, 0, s4
    s_waitcnt lgkmcnt(0)
    v_mfma_f32_16x16x32_bf16 v[88:91], a[72:75], v[24:27], v[88:91]
    ds_read_b128 v[56:59], v2 offset:57344
    s_lshl_b32 s41, s64, 10
    v_mfma_f32_16x16x32_bf16 v[92:95], a[76:79], v[24:27], v[92:95]
    ds_read_b128 v[60:63], v2 offset:58368
    v_mfma_f32_16x16x32_bf16 v[96:99], a[80:83], v[24:27], v[96:99]
    ds_read_b128 v[64:67], v2 offset:59392
    v_mfma_f32_16x16x32_bf16 v[100:103], a[72:75], v[28:31], v[100:103]
    ds_read_b128 v[68:71], v2 offset:60416
    s_add_u32 m0, s46, 16384
    v_mfma_f32_16x16x32_bf16 v[104:107], a[76:79], v[28:31], v[104:107]
    ds_read_b128 v[72:75], v2 offset:61440
    v_mfma_f32_16x16x32_bf16 v[108:111], a[80:83], v[28:31], v[108:111]
    ds_read_b128 v[76:79], v2 offset:62464
    v_mfma_f32_16x16x32_bf16 v[112:115], a[72:75], v[32:35], v[112:115]
    ds_read_b128 v[80:83], v2 offset:63488
    s_add_u32 s41, s41, s44
    v_mfma_f32_16x16x32_bf16 v[116:119], a[76:79], v[32:35], v[116:119]
    ds_read_b128 v[84:87], v2 offset:64512
    v_mfma_f32_16x16x32_bf16 v[120:123], a[80:83], v[32:35], v[120:123]
    buffer_load_dwordx4 v2, s[16:19], s41 offen sc1 lds
    v_mfma_f32_16x16x32_bf16 v[124:127], a[72:75], v[36:39], v[124:127]
    s_add_u32 m0, s46, 17408
    v_mfma_f32_16x16x32_bf16 v[128:131], a[76:79], v[36:39], v[128:131]
    s_add_u32 s41, s41, 20480
    buffer_load_dwordx4 v2, s[16:19], s41 offen sc1 lds
    v_mfma_f32_16x16x32_bf16 v[132:135], a[80:83], v[36:39], v[132:135]
    s_add_u32 s64, s64, 1
    v_mfma_f32_16x16x32_bf16 v[136:139], a[72:75], v[40:43], v[136:139]
    s_cmp_eq_u32 s64, 20
    v_mfma_f32_16x16x32_bf16 v[140:143], a[76:79], v[40:43], v[140:143]
    s_cselect_b32 s64, 0, s64
    s_lshl_b32 s41, s64, 10
    v_mfma_f32_16x16x32_bf16 v[144:147], a[80:83], v[40:43], v[144:147]
    s_add_u32 m0, s46, 24576
    v_mfma_f32_16x16x32_bf16 v[148:151], a[72:75], v[44:47], v[148:151]
    s_add_u32 s41, s41, s44
    v_mfma_f32_16x16x32_bf16 v[152:155], a[76:79], v[44:47], v[152:155]
    buffer_load_dwordx4 v2, s[16:19], s41 offen sc1 lds
    v_mfma_f32_16x16x32_bf16 v[156:159], a[80:83], v[44:47], v[156:159]
    s_add_u32 m0, s46, 25600
    s_add_u32 s41, s41, 20480
    v_mfma_f32_16x16x32_bf16 v[160:163], a[72:75], v[48:51], v[160:163]
    buffer_load_dwordx4 v2, s[16:19], s41 offen sc1 lds
    v_mfma_f32_16x16x32_bf16 v[164:167], a[76:79], v[48:51], v[164:167]
    s_add_u32 s64, s64, 1
    v_mfma_f32_16x16x32_bf16 v[168:171], a[80:83], v[48:51], v[168:171]
    s_cmp_eq_u32 s64, 20
    s_cselect_b32 s64, 0, s64
    v_mfma_f32_16x16x32_bf16 v[172:175], a[72:75], v[52:55], v[172:175]
    s_mul_i32 s43, s4, 5120
    v_mfma_f32_16x16x32_bf16 v[176:179], a[76:79], v[52:55], v[176:179]
    s_add_u32 s43, s43, s5
    v_mfma_f32_16x16x32_bf16 v[180:183], a[80:83], v[52:55], v[180:183]
    buffer_load_dwordx4 a[20:23], v2, s[16:19], s43 offen offset:0 sc1
    s_waitcnt lgkmcnt(0)
    s_waitcnt vmcnt(26)
    s_barrier
    v_mfma_f32_16x16x32_bf16 v[88:91], a[84:87], v[56:59], v[88:91]
    ds_read_b128 v[24:27], v5 offset:0
    v_pk_add_f32 v[184:185], v[184:185], v[186:187]
    v_mfma_f32_16x16x32_bf16 v[92:95], a[88:91], v[56:59], v[92:95]
    ds_read_b128 v[28:31], v5 offset:1024
    v_mfma_f32_16x16x32_bf16 v[96:99], a[92:95], v[56:59], v[96:99]
    ds_read_b128 v[32:35], v5 offset:2048
    v_pk_add_f32 v[184:185], v[184:185], v[188:189]
    v_mfma_f32_16x16x32_bf16 v[100:103], a[84:87], v[60:63], v[100:103]
    ds_read_b128 v[36:39], v5 offset:3072
    v_mfma_f32_16x16x32_bf16 v[104:107], a[88:91], v[60:63], v[104:107]
    ds_read_b128 v[40:43], v5 offset:4096
    v_mfma_f32_16x16x32_bf16 v[108:111], a[92:95], v[60:63], v[108:111]
    ds_read_b128 v[44:47], v5 offset:5120
    v_pk_add_f32 v[184:185], v[184:185], v[190:191]
    v_mfma_f32_16x16x32_bf16 v[112:115], a[84:87], v[64:67], v[112:115]
    ds_read_b128 v[48:51], v5 offset:6144
    v_mfma_f32_16x16x32_bf16 v[116:119], a[88:91], v[64:67], v[116:119]
    ds_read_b128 v[52:55], v5 offset:7168
    v_mfma_f32_16x16x32_bf16 v[120:123], a[92:95], v[64:67], v[120:123]
    v_pk_add_f32 v[184:185], v[184:185], v[192:193]
    v_pk_add_f32 v[184:185], v[184:185], v[194:195]
    v_mfma_f32_16x16x32_bf16 v[124:127], a[84:87], v[68:71], v[124:127]
    v_pk_add_f32 v[184:185], v[184:185], v[196:197]
    v_mfma_f32_16x16x32_bf16 v[128:131], a[88:91], v[68:71], v[128:131]
    v_pk_add_f32 v[184:185], v[184:185], v[198:199]
    v_mul_f32 v184, s47, v184
    v_mfma_f32_16x16x32_bf16 v[132:135], a[92:95], v[68:71], v[132:135]
    v_mul_f32 v185, s47, v185
    v_mfma_f32_16x16x32_bf16 v[136:139], a[84:87], v[72:75], v[136:139]
    v_fma_f32 v185, -v184, v184, v185
    v_mfma_f32_16x16x32_bf16 v[140:143], a[88:91], v[72:75], v[140:143]
    v_max_f32 v185, 0, v185
    v_add_f32 v185, 0x3727c5ac, v185
    v_mfma_f32_16x16x32_bf16 v[144:147], a[92:95], v[72:75], v[144:147]
    v_rcp_f32 v185, v185
    v_mfma_f32_16x16x32_bf16 v[148:151], a[84:87], v[76:79], v[148:151]
    s_nop 0
    v_mfma_f32_16x16x32_bf16 v[152:155], a[88:91], v[76:79], v[152:155]
    ds_write_b64 v6, v[184:185]
    buffer_load_dwordx4 a[24:27], v2, s[16:19], s43 offen offset:1024 sc1
    v_mfma_f32_16x16x32_bf16 v[156:159], a[92:95], v[76:79], v[156:159]
    buffer_load_dwordx4 a[28:31], v2, s[16:19], s43 offen offset:2048 sc1
    v_mfma_f32_16x16x32_bf16 v[160:163], a[84:87], v[80:83], v[160:163]
    buffer_load_dwordx4 a[32:35], v2, s[16:19], s43 offen offset:3072 sc1
    buffer_load_dwordx4 a[36:39], v4, s[16:19], s43 offen offset:0 sc1
    v_mfma_f32_16x16x32_bf16 v[164:167], a[88:91], v[80:83], v[164:167]
    s_add_u32 s4, s4, 1
    v_mfma_f32_16x16x32_bf16 v[168:171], a[92:95], v[80:83], v[168:171]
    s_cmp_eq_u32 s4, 12
    v_mfma_f32_16x16x32_bf16 v[172:175], a[84:87], v[84:87], v[172:175]
    s_cselect_b32 s4, 0, s4
    s_mul_i32 s43, s4, 5120
    v_mfma_f32_16x16x32_bf16 v[176:179], a[88:91], v[84:87], v[176:179]
    s_add_u32 s43, s43, s5
    v_mfma_f32_16x16x32_bf16 v[180:183], a[92:95], v[84:87], v[180:183]
    buffer_load_dwordx4 a[40:43], v2, s[16:19], s43 offen offset:0 sc1
    s_waitcnt lgkmcnt(0)
    v_mfma_f32_16x16x32_bf16 v[88:91], a[96:99], v[24:27], v[88:91]
    ds_read_b128 v[56:59], v5 offset:8192
    v_mfma_f32_16x16x32_bf16 v[92:95], a[100:103], v[24:27], v[92:95]
    ds_read_b128 v[60:63], v5 offset:9216
    v_mfma_f32_16x16x32_bf16 v[96:99], a[104:107], v[24:27], v[96:99]
    ds_read_b128 v[64:67], v5 offset:10240
    v_mfma_f32_16x16x32_bf16 v[100:103], a[96:99], v[28:31], v[100:103]
    ds_read_b128 v[68:71], v5 offset:11264
    v_mfma_f32_16x16x32_bf16 v[104:107], a[100:103], v[28:31], v[104:107]
    ds_read_b128 v[72:75], v5 offset:12288
    v_mfma_f32_16x16x32_bf16 v[108:111], a[104:107], v[28:31], v[108:111]
    ds_read_b128 v[76:79], v5 offset:13312
    v_mfma_f32_16x16x32_bf16 v[112:115], a[96:99], v[32:35], v[112:115]
    ds_read_b128 v[80:83], v5 offset:14336
    v_mfma_f32_16x16x32_bf16 v[116:119], a[100:103], v[32:35], v[116:119]
    ds_read_b128 v[84:87], v5 offset:15360
    v_mfma_f32_16x16x32_bf16 v[120:123], a[104:107], v[32:35], v[120:123]
    v_mfma_f32_16x16x32_bf16 v[124:127], a[96:99], v[36:39], v[124:127]
    v_mfma_f32_16x16x32_bf16 v[128:131], a[100:103], v[36:39], v[128:131]
    buffer_load_dwordx4 a[44:47], v2, s[16:19], s43 offen offset:1024 sc1
    v_mfma_f32_16x16x32_bf16 v[132:135], a[104:107], v[36:39], v[132:135]
    v_mfma_f32_16x16x32_bf16 v[136:139], a[96:99], v[40:43], v[136:139]
    buffer_load_dwordx4 a[48:51], v2, s[16:19], s43 offen offset:2048 sc1
    v_mfma_f32_16x16x32_bf16 v[140:143], a[100:103], v[40:43], v[140:143]
    buffer_load_dwordx4 a[52:55], v2, s[16:19], s43 offen offset:3072 sc1
    v_mfma_f32_16x16x32_bf16 v[144:147], a[104:107], v[40:43], v[144:147]
    buffer_load_dwordx4 a[56:59], v4, s[16:19], s43 offen offset:0 sc1
    v_mfma_f32_16x16x32_bf16 v[148:151], a[96:99], v[44:47], v[148:151]
    v_mfma_f32_16x16x32_bf16 v[152:155], a[100:103], v[44:47], v[152:155]
    s_add_u32 s4, s4, 1
    v_mfma_f32_16x16x32_bf16 v[156:159], a[104:107], v[44:47], v[156:159]
    s_cmp_eq_u32 s4, 12
    v_mfma_f32_16x16x32_bf16 v[160:163], a[96:99], v[48:51], v[160:163]
    s_cselect_b32 s4, 0, s4
    v_mfma_f32_16x16x32_bf16 v[164:167], a[100:103], v[48:51], v[164:167]
    v_mfma_f32_16x16x32_bf16 v[168:171], a[104:107], v[48:51], v[168:171]
    s_mul_i32 s43, s4, 5120
    v_mfma_f32_16x16x32_bf16 v[172:175], a[96:99], v[52:55], v[172:175]
    s_add_u32 s43, s43, s5
    v_mfma_f32_16x16x32_bf16 v[176:179], a[100:103], v[52:55], v[176:179]
    buffer_load_dwordx4 a[60:63], v2, s[16:19], s43 offen offset:0 sc1
    v_mfma_f32_16x16x32_bf16 v[180:183], a[104:107], v[52:55], v[180:183]
    s_waitcnt lgkmcnt(0)
    s_waitcnt vmcnt(31)
    s_barrier
    v_mfma_f32_16x16x32_bf16 v[88:91], a[108:111], v[56:59], v[88:91]
    ds_read_b128 v[24:27], v5 offset:16384
    v_mfma_f32_16x16x32_bf16 v[92:95], a[112:115], v[56:59], v[92:95]
    ds_read_b128 v[28:31], v5 offset:17408
    v_mfma_f32_16x16x32_bf16 v[96:99], a[116:119], v[56:59], v[96:99]
    ds_read_b128 v[32:35], v5 offset:18432
    v_mfma_f32_16x16x32_bf16 v[100:103], a[108:111], v[60:63], v[100:103]
    ds_read_b128 v[36:39], v5 offset:19456
    v_mfma_f32_16x16x32_bf16 v[104:107], a[112:115], v[60:63], v[104:107]
    ds_read_b128 v[40:43], v5 offset:20480
    v_mfma_f32_16x16x32_bf16 v[108:111], a[116:119], v[60:63], v[108:111]
    ds_read_b128 v[44:47], v5 offset:21504
    v_mfma_f32_16x16x32_bf16 v[112:115], a[108:111], v[64:67], v[112:115]
    ds_read_b128 v[48:51], v5 offset:22528
    v_mfma_f32_16x16x32_bf16 v[116:119], a[112:115], v[64:67], v[116:119]
    ds_read_b128 v[52:55], v5 offset:23552
    v_mfma_f32_16x16x32_bf16 v[120:123], a[116:119], v[64:67], v[120:123]
    v_mfma_f32_16x16x32_bf16 v[124:127], a[108:111], v[68:71], v[124:127]
    v_mfma_f32_16x16x32_bf16 v[128:131], a[112:115], v[68:71], v[128:131]
    buffer_load_dwordx4 a[64:67], v2, s[16:19], s43 offen offset:1024 sc1
    v_mfma_f32_16x16x32_bf16 v[132:135], a[116:119], v[68:71], v[132:135]
    v_mfma_f32_16x16x32_bf16 v[136:139], a[108:111], v[72:75], v[136:139]
    buffer_load_dwordx4 a[68:71], v2, s[16:19], s43 offen offset:2048 sc1
    v_mfma_f32_16x16x32_bf16 v[140:143], a[112:115], v[72:75], v[140:143]
    buffer_load_dwordx4 a[72:75], v2, s[16:19], s43 offen offset:3072 sc1
    v_mfma_f32_16x16x32_bf16 v[144:147], a[116:119], v[72:75], v[144:147]
    buffer_load_dwordx4 a[76:79], v4, s[16:19], s43 offen offset:0 sc1
    v_mfma_f32_16x16x32_bf16 v[148:151], a[108:111], v[76:79], v[148:151]
    v_mfma_f32_16x16x32_bf16 v[152:155], a[112:115], v[76:79], v[152:155]
    s_add_u32 s4, s4, 1
    v_mfma_f32_16x16x32_bf16 v[156:159], a[116:119], v[76:79], v[156:159]
    s_cmp_eq_u32 s4, 12
    v_mfma_f32_16x16x32_bf16 v[160:163], a[108:111], v[80:83], v[160:163]
    s_cselect_b32 s4, 0, s4
    v_mfma_f32_16x16x32_bf16 v[164:167], a[112:115], v[80:83], v[164:167]
    v_mfma_f32_16x16x32_bf16 v[168:171], a[116:119], v[80:83], v[168:171]
    s_mul_i32 s43, s4, 5120
    v_mfma_f32_16x16x32_bf16 v[172:175], a[108:111], v[84:87], v[172:175]
    s_add_u32 s43, s43, s5
    v_mfma_f32_16x16x32_bf16 v[176:179], a[112:115], v[84:87], v[176:179]
    buffer_load_dwordx4 a[80:83], v2, s[16:19], s43 offen offset:0 sc1
    v_mfma_f32_16x16x32_bf16 v[180:183], a[116:119], v[84:87], v[180:183]
    s_waitcnt lgkmcnt(0)
    v_mfma_f32_16x16x32_bf16 v[88:91], a[120:123], v[24:27], v[88:91]
    ds_read_b128 v[56:59], v5 offset:24576
    v_mfma_f32_16x16x32_bf16 v[92:95], a[124:127], v[24:27], v[92:95]
    ds_read_b128 v[60:63], v5 offset:25600
    v_mfma_f32_16x16x32_bf16 v[96:99], a[128:131], v[24:27], v[96:99]
    ds_read_b128 v[64:67], v5 offset:26624
    v_mfma_f32_16x16x32_bf16 v[100:103], a[120:123], v[28:31], v[100:103]
    ds_read_b128 v[68:71], v5 offset:27648
    v_mfma_f32_16x16x32_bf16 v[104:107], a[124:127], v[28:31], v[104:107]
    ds_read_b128 v[72:75], v5 offset:28672
    v_mfma_f32_16x16x32_bf16 v[108:111], a[128:131], v[28:31], v[108:111]
    ds_read_b128 v[76:79], v5 offset:29696
    v_mfma_f32_16x16x32_bf16 v[112:115], a[120:123], v[32:35], v[112:115]
    ds_read_b128 v[80:83], v5 offset:30720
    v_mfma_f32_16x16x32_bf16 v[116:119], a[124:127], v[32:35], v[116:119]
    ds_read_b128 v[84:87], v5 offset:31744
    v_mfma_f32_16x16x32_bf16 v[120:123], a[128:131], v[32:35], v[120:123]
    v_mfma_f32_16x16x32_bf16 v[124:127], a[120:123], v[36:39], v[124:127]
    v_mfma_f32_16x16x32_bf16 v[128:131], a[124:127], v[36:39], v[128:131]
    buffer_load_dwordx4 a[84:87], v2, s[16:19], s43 offen offset:1024 sc1
    v_mfma_f32_16x16x32_bf16 v[132:135], a[128:131], v[36:39], v[132:135]
    v_mfma_f32_16x16x32_bf16 v[136:139], a[120:123], v[40:43], v[136:139]
    buffer_load_dwordx4 a[88:91], v2, s[16:19], s43 offen offset:2048 sc1
    v_mfma_f32_16x16x32_bf16 v[140:143], a[124:127], v[40:43], v[140:143]
    buffer_load_dwordx4 a[92:95], v2, s[16:19], s43 offen offset:3072 sc1
    v_mfma_f32_16x16x32_bf16 v[144:147], a[128:131], v[40:43], v[144:147]
    buffer_load_dwordx4 a[96:99], v4, s[16:19], s43 offen offset:0 sc1
    v_mfma_f32_16x16x32_bf16 v[148:151], a[120:123], v[44:47], v[148:151]
    v_mfma_f32_16x16x32_bf16 v[152:155], a[124:127], v[44:47], v[152:155]
    s_add_u32 s4, s4, 1
    v_mfma_f32_16x16x32_bf16 v[156:159], a[128:131], v[44:47], v[156:159]
    s_cmp_eq_u32 s4, 12
    v_mfma_f32_16x16x32_bf16 v[160:163], a[120:123], v[48:51], v[160:163]
    s_cselect_b32 s4, 0, s4
    v_mfma_f32_16x16x32_bf16 v[164:167], a[124:127], v[48:51], v[164:167]
    v_mfma_f32_16x16x32_bf16 v[168:171], a[128:131], v[48:51], v[168:171]
    s_mul_i32 s43, s4, 5120
    v_mfma_f32_16x16x32_bf16 v[172:175], a[120:123], v[52:55], v[172:175]
    s_add_u32 s43, s43, s5
    v_mfma_f32_16x16x32_bf16 v[176:179], a[124:127], v[52:55], v[176:179]
    buffer_load_dwordx4 a[100:103], v2, s[16:19], s43 offen offset:0 sc1
    v_mfma_f32_16x16x32_bf16 v[180:183], a[128:131], v[52:55], v[180:183]
    s_waitcnt lgkmcnt(0)
    s_waitcnt vmcnt(36)
    s_barrier
    v_mfma_f32_16x16x32_bf16 v[88:91], a[132:135], v[56:59], v[88:91]
    ds_read_b128 v[24:27], v5 offset:32768
    v_mfma_f32_16x16x32_bf16 v[92:95], a[136:139], v[56:59], v[92:95]
    ds_read_b128 v[28:31], v5 offset:33792
    v_mfma_f32_16x16x32_bf16 v[96:99], a[140:143], v[56:59], v[96:99]
    ds_read_b128 v[32:35], v5 offset:34816
    v_mfma_f32_16x16x32_bf16 v[100:103], a[132:135], v[60:63], v[100:103]
    ds_read_b128 v[36:39], v5 offset:35840
    v_mfma_f32_16x16x32_bf16 v[104:107], a[136:139], v[60:63], v[104:107]
    ds_read_b128 v[40:43], v5 offset:36864
    v_mfma_f32_16x16x32_bf16 v[108:111], a[140:143], v[60:63], v[108:111]
    ds_read_b128 v[44:47], v5 offset:37888
    v_mfma_f32_16x16x32_bf16 v[112:115], a[132:135], v[64:67], v[112:115]
    ds_read_b128 v[48:51], v5 offset:38912
    v_mfma_f32_16x16x32_bf16 v[116:119], a[136:139], v[64:67], v[116:119]
    ds_read_b128 v[52:55], v5 offset:39936
    v_mfma_f32_16x16x32_bf16 v[120:123], a[140:143], v[64:67], v[120:123]
    v_mfma_f32_16x16x32_bf16 v[124:127], a[132:135], v[68:71], v[124:127]
    v_mfma_f32_16x16x32_bf16 v[128:131], a[136:139], v[68:71], v[128:131]
    buffer_load_dwordx4 a[104:107], v2, s[16:19], s43 offen offset:1024 sc1
    v_mfma_f32_16x16x32_bf16 v[132:135], a[140:143], v[68:71], v[132:135]
    v_mfma_f32_16x16x32_bf16 v[136:139], a[132:135], v[72:75], v[136:139]
    buffer_load_dwordx4 a[108:111], v2, s[16:19], s43 offen offset:2048 sc1
    v_mfma_f32_16x16x32_bf16 v[140:143], a[136:139], v[72:75], v[140:143]
    buffer_load_dwordx4 a[112:115], v2, s[16:19], s43 offen offset:3072 sc1
    v_mfma_f32_16x16x32_bf16 v[144:147], a[140:143], v[72:75], v[144:147]
    buffer_load_dwordx4 a[116:119], v4, s[16:19], s43 offen offset:0 sc1
    v_mfma_f32_16x16x32_bf16 v[148:151], a[132:135], v[76:79], v[148:151]
    v_mfma_f32_16x16x32_bf16 v[152:155], a[136:139], v[76:79], v[152:155]
    s_add_u32 s4, s4, 1
    v_mfma_f32_16x16x32_bf16 v[156:159], a[140:143], v[76:79], v[156:159]
    s_cmp_eq_u32 s4, 12
    v_mfma_f32_16x16x32_bf16 v[160:163], a[132:135], v[80:83], v[160:163]
    s_cselect_b32 s4, 0, s4
    v_mfma_f32_16x16x32_bf16 v[164:167], a[136:139], v[80:83], v[164:167]
    v_mfma_f32_16x16x32_bf16 v[168:171], a[140:143], v[80:83], v[168:171]
    s_mul_i32 s43, s4, 5120
    v_mfma_f32_16x16x32_bf16 v[172:175], a[132:135], v[84:87], v[172:175]
    s_add_u32 s43, s43, s5
    v_mfma_f32_16x16x32_bf16 v[176:179], a[136:139], v[84:87], v[176:179]
    buffer_load_dwordx4 a[120:123], v2, s[16:19], s43 offen offset:0 sc1
    v_mfma_f32_16x16x32_bf16 v[180:183], a[140:143], v[84:87], v[180:183]
    s_waitcnt lgkmcnt(0)
    v_mfma_f32_16x16x32_bf16 v[88:91], a[144:147], v[24:27], v[88:91]
    ds_read_b128 v[56:59], v5 offset:40960
    v_mfma_f32_16x16x32_bf16 v[92:95], a[148:151], v[24:27], v[92:95]
    ds_read_b128 v[60:63], v5 offset:41984
    v_mfma_f32_16x16x32_bf16 v[96:99], a[152:155], v[24:27], v[96:99]
    ds_read_b128 v[64:67], v5 offset:43008
    v_mfma_f32_16x16x32_bf16 v[100:103], a[144:147], v[28:31], v[100:103]
    ds_read_b128 v[68:71], v5 offset:44032
    v_mfma_f32_16x16x32_bf16 v[104:107], a[148:151], v[28:31], v[104:107]
    ds_read_b128 v[72:75], v5 offset:45056
    v_mfma_f32_16x16x32_bf16 v[108:111], a[152:155], v[28:31], v[108:111]
    ds_read_b128 v[76:79], v5 offset:46080
    v_mfma_f32_16x16x32_bf16 v[112:115], a[144:147], v[32:35], v[112:115]
    ds_read_b128 v[80:83], v5 offset:47104
    v_mfma_f32_16x16x32_bf16 v[116:119], a[148:151], v[32:35], v[116:119]
    ds_read_b128 v[84:87], v5 offset:48128
    v_mfma_f32_16x16x32_bf16 v[120:123], a[152:155], v[32:35], v[120:123]
    v_mfma_f32_16x16x32_bf16 v[124:127], a[144:147], v[36:39], v[124:127]
    v_mfma_f32_16x16x32_bf16 v[128:131], a[148:151], v[36:39], v[128:131]
    buffer_load_dwordx4 a[124:127], v2, s[16:19], s43 offen offset:1024 sc1
    v_mfma_f32_16x16x32_bf16 v[132:135], a[152:155], v[36:39], v[132:135]
    v_mfma_f32_16x16x32_bf16 v[136:139], a[144:147], v[40:43], v[136:139]
    buffer_load_dwordx4 a[128:131], v2, s[16:19], s43 offen offset:2048 sc1
    v_mfma_f32_16x16x32_bf16 v[140:143], a[148:151], v[40:43], v[140:143]
    buffer_load_dwordx4 a[132:135], v2, s[16:19], s43 offen offset:3072 sc1
    v_mfma_f32_16x16x32_bf16 v[144:147], a[152:155], v[40:43], v[144:147]
    buffer_load_dwordx4 a[136:139], v4, s[16:19], s43 offen offset:0 sc1
    v_mfma_f32_16x16x32_bf16 v[148:151], a[144:147], v[44:47], v[148:151]
    v_mfma_f32_16x16x32_bf16 v[152:155], a[148:151], v[44:47], v[152:155]
    s_add_u32 s4, s4, 1
    v_mfma_f32_16x16x32_bf16 v[156:159], a[152:155], v[44:47], v[156:159]
    s_cmp_eq_u32 s4, 12
    v_mfma_f32_16x16x32_bf16 v[160:163], a[144:147], v[48:51], v[160:163]
    s_cselect_b32 s4, 0, s4
    v_mfma_f32_16x16x32_bf16 v[164:167], a[148:151], v[48:51], v[164:167]
    v_mfma_f32_16x16x32_bf16 v[168:171], a[152:155], v[48:51], v[168:171]
    s_mul_i32 s43, s4, 5120
    v_mfma_f32_16x16x32_bf16 v[172:175], a[144:147], v[52:55], v[172:175]
    s_add_u32 s43, s43, s5
    v_mfma_f32_16x16x32_bf16 v[176:179], a[148:151], v[52:55], v[176:179]
    buffer_load_dwordx4 a[140:143], v2, s[16:19], s43 offen offset:0 sc1
    v_mfma_f32_16x16x32_bf16 v[180:183], a[152:155], v[52:55], v[180:183]
    s_waitcnt lgkmcnt(0)
    s_waitcnt vmcnt(41)
    s_barrier
    v_mfma_f32_16x16x32_bf16 v[88:91], a[156:159], v[56:59], v[88:91]
    ds_read_b128 v[24:27], v5 offset:49152
    v_mfma_f32_16x16x32_bf16 v[92:95], a[160:163], v[56:59], v[92:95]
    ds_read_b128 v[28:31], v5 offset:50176
    v_mfma_f32_16x16x32_bf16 v[96:99], a[164:167], v[56:59], v[96:99]
    ds_read_b128 v[32:35], v5 offset:51200
    v_mfma_f32_16x16x32_bf16 v[100:103], a[156:159], v[60:63], v[100:103]
    ds_read_b128 v[36:39], v5 offset:52224
    v_mfma_f32_16x16x32_bf16 v[104:107], a[160:163], v[60:63], v[104:107]
    ds_read_b128 v[40:43], v5 offset:53248
    v_mfma_f32_16x16x32_bf16 v[108:111], a[164:167], v[60:63], v[108:111]
    ds_read_b128 v[44:47], v5 offset:54272
    v_mfma_f32_16x16x32_bf16 v[112:115], a[156:159], v[64:67], v[112:115]
    ds_read_b128 v[48:51], v5 offset:55296
    v_mfma_f32_16x16x32_bf16 v[116:119], a[160:163], v[64:67], v[116:119]
    ds_read_b128 v[52:55], v5 offset:56320
    v_mfma_f32_16x16x32_bf16 v[120:123], a[164:167], v[64:67], v[120:123]
    v_mfma_f32_16x16x32_bf16 v[124:127], a[156:159], v[68:71], v[124:127]
    v_mfma_f32_16x16x32_bf16 v[128:131], a[160:163], v[68:71], v[128:131]
    v_mfma_f32_16x16x32_bf16 v[132:135], a[164:167], v[68:71], v[132:135]
    v_mfma_f32_16x16x32_bf16 v[136:139], a[156:159], v[72:75], v[136:139]
    v_mfma_f32_16x16x32_bf16 v[140:143], a[160:163], v[72:75], v[140:143]
    v_mfma_f32_16x16x32_bf16 v[144:147], a[164:167], v[72:75], v[144:147]
    v_mfma_f32_16x16x32_bf16 v[148:151], a[156:159], v[76:79], v[148:151]
    v_mfma_f32_16x16x32_bf16 v[152:155], a[160:163], v[76:79], v[152:155]
    v_mfma_f32_16x16x32_bf16 v[156:159], a[164:167], v[76:79], v[156:159]
    buffer_load_dwordx4 a[144:147], v2, s[16:19], s43 offen offset:1024 sc1
    v_mfma_f32_16x16x32_bf16 v[160:163], a[156:159], v[80:83], v[160:163]
    v_mfma_f32_16x16x32_bf16 v[164:167], a[160:163], v[80:83], v[164:167]
    buffer_load_dwordx4 a[148:151], v2, s[16:19], s43 offen offset:2048 sc1
    v_mfma_f32_16x16x32_bf16 v[168:171], a[164:167], v[80:83], v[168:171]
    v_mfma_f32_16x16x32_bf16 v[172:175], a[156:159], v[84:87], v[172:175]
    buffer_load_dwordx4 a[152:155], v2, s[16:19], s43 offen offset:3072 sc1
    v_mfma_f32_16x16x32_bf16 v[176:179], a[160:163], v[84:87], v[176:179]
    v_mfma_f32_16x16x32_bf16 v[180:183], a[164:167], v[84:87], v[180:183]
    s_waitcnt lgkmcnt(0)
    v_mfma_f32_16x16x32_bf16 v[88:91], a[168:171], v[24:27], v[88:91]
    ds_read_b128 v[56:59], v5 offset:57344
    v_mfma_f32_16x16x32_bf16 v[92:95], a[172:175], v[24:27], v[92:95]
    ds_read_b128 v[60:63], v5 offset:58368
    v_mfma_f32_16x16x32_bf16 v[96:99], a[176:179], v[24:27], v[96:99]
    ds_read_b128 v[64:67], v5 offset:59392
    v_mfma_f32_16x16x32_bf16 v[100:103], a[168:171], v[28:31], v[100:103]
    ds_read_b128 v[68:71], v5 offset:60416
    v_mfma_f32_16x16x32_bf16 v[104:107], a[172:175], v[28:31], v[104:107]
    ds_read_b128 v[72:75], v5 offset:61440
    v_mfma_f32_16x16x32_bf16 v[108:111], a[176:179], v[28:31], v[108:111]
    ds_read_b128 v[76:79], v5 offset:62464
    v_mfma_f32_16x16x32_bf16 v[112:115], a[168:171], v[32:35], v[112:115]
    ds_read_b128 v[80:83], v5 offset:63488
    v_mfma_f32_16x16x32_bf16 v[116:119], a[172:175], v[32:35], v[116:119]
    ds_read_b128 v[84:87], v5 offset:64512
    v_mfma_f32_16x16x32_bf16 v[120:123], a[176:179], v[32:35], v[120:123]
    v_mfma_f32_16x16x32_bf16 v[124:127], a[168:171], v[36:39], v[124:127]
    v_mfma_f32_16x16x32_bf16 v[128:131], a[172:175], v[36:39], v[128:131]
    v_mfma_f32_16x16x32_bf16 v[132:135], a[176:179], v[36:39], v[132:135]
    v_mfma_f32_16x16x32_bf16 v[136:139], a[168:171], v[40:43], v[136:139]
    buffer_load_dwordx4 a[156:159], v4, s[16:19], s43 offen offset:0 sc1
    v_mfma_f32_16x16x32_bf16 v[140:143], a[172:175], v[40:43], v[140:143]
    s_add_u32 s4, s4, 1
    v_mfma_f32_16x16x32_bf16 v[144:147], a[176:179], v[40:43], v[144:147]
    v_mfma_f32_16x16x32_bf16 v[148:151], a[168:171], v[44:47], v[148:151]
    s_cmp_eq_u32 s4, 12
    v_mfma_f32_16x16x32_bf16 v[152:155], a[172:175], v[44:47], v[152:155]
    s_cselect_b32 s4, 0, s4
    v_mfma_f32_16x16x32_bf16 v[156:159], a[176:179], v[44:47], v[156:159]
    v_mfma_f32_16x16x32_bf16 v[160:163], a[168:171], v[48:51], v[160:163]
    s_mul_i32 s43, s4, 5120
    v_mfma_f32_16x16x32_bf16 v[164:167], a[172:175], v[48:51], v[164:167]
    s_add_u32 s43, s43, s5
    v_mfma_f32_16x16x32_bf16 v[168:171], a[176:179], v[48:51], v[168:171]
    v_mfma_f32_16x16x32_bf16 v[172:175], a[168:171], v[52:55], v[172:175]
    buffer_load_dwordx4 a[160:163], v2, s[16:19], s43 offen offset:0 sc1
    v_mfma_f32_16x16x32_bf16 v[176:179], a[172:175], v[52:55], v[176:179]
    buffer_load_dwordx4 a[164:167], v2, s[16:19], s43 offen offset:1024 sc1
    v_mfma_f32_16x16x32_bf16 v[180:183], a[176:179], v[52:55], v[180:183]
    s_waitcnt lgkmcnt(0)
    s_waitcnt vmcnt(42)
    s_barrier
    v_mfma_f32_16x16x32_bf16 v[88:91], a[180:183], v[56:59], v[88:91]
    ds_read_b128 v[24:27], v2 offset:0
    v_mfma_f32_16x16x32_bf16 v[92:95], a[184:187], v[56:59], v[92:95]
    ds_read_b128 v[28:31], v2 offset:1024
    v_mfma_f32_16x16x32_bf16 v[96:99], a[188:191], v[56:59], v[96:99]
    ds_read_b128 v[32:35], v2 offset:2048
    v_mfma_f32_16x16x32_bf16 v[100:103], a[180:183], v[60:63], v[100:103]
    ds_read_b128 v[36:39], v2 offset:3072
    v_mfma_f32_16x16x32_bf16 v[104:107], a[184:187], v[60:63], v[104:107]
    ds_read_b128 v[40:43], v2 offset:4096
    v_mfma_f32_16x16x32_bf16 v[108:111], a[188:191], v[60:63], v[108:111]
    ds_read_b128 v[44:47], v2 offset:5120
    v_mfma_f32_16x16x32_bf16 v[112:115], a[180:183], v[64:67], v[112:115]
    ds_read_b128 v[48:51], v2 offset:6144
    v_mfma_f32_16x16x32_bf16 v[116:119], a[184:187], v[64:67], v[116:119]
    ds_read_b128 v[52:55], v2 offset:7168
    v_mfma_f32_16x16x32_bf16 v[120:123], a[188:191], v[64:67], v[120:123]
    v_mfma_f32_16x16x32_bf16 v[124:127], a[180:183], v[68:71], v[124:127]
    v_mfma_f32_16x16x32_bf16 v[128:131], a[184:187], v[68:71], v[128:131]
    v_mfma_f32_16x16x32_bf16 v[132:135], a[188:191], v[68:71], v[132:135]
    v_mfma_f32_16x16x32_bf16 v[136:139], a[180:183], v[72:75], v[136:139]
    v_mfma_f32_16x16x32_bf16 v[140:143], a[184:187], v[72:75], v[140:143]
    buffer_load_dwordx4 a[168:171], v2, s[16:19], s43 offen offset:2048 sc1
    v_mfma_f32_16x16x32_bf16 v[144:147], a[188:191], v[72:75], v[144:147]
    v_mfma_f32_16x16x32_bf16 v[148:151], a[180:183], v[76:79], v[148:151]
    buffer_load_dwordx4 a[172:175], v2, s[16:19], s43 offen offset:3072 sc1
    v_mfma_f32_16x16x32_bf16 v[152:155], a[184:187], v[76:79], v[152:155]
    v_mfma_f32_16x16x32_bf16 v[156:159], a[188:191], v[76:79], v[156:159]
    buffer_load_dwordx4 a[176:179], v4, s[16:19], s43 offen offset:0 sc1
    v_mfma_f32_16x16x32_bf16 v[160:163], a[180:183], v[80:83], v[160:163]
    s_add_u32 s4, s4, 1
    v_mfma_f32_16x16x32_bf16 v[164:167], a[184:187], v[80:83], v[164:167]
    v_mfma_f32_16x16x32_bf16 v[168:171], a[188:191], v[80:83], v[168:171]
    s_cmp_eq_u32 s4, 12
    v_mfma_f32_16x16x32_bf16 v[172:175], a[180:183], v[84:87], v[172:175]
    v_mfma_f32_16x16x32_bf16 v[176:179], a[184:187], v[84:87], v[176:179]
    s_cselect_b32 s4, 0, s4
    v_mfma_f32_16x16x32_bf16 v[180:183], a[188:191], v[84:87], v[180:183]
    s_waitcnt lgkmcnt(0)
    v_mfma_f32_16x16x32_bf16 v[88:91], a[192:195], v[24:27], v[88:91]
    ds_read_b128 v[56:59], v2 offset:8192
    v_mfma_f32_16x16x32_bf16 v[92:95], a[196:199], v[24:27], v[92:95]
    ds_read_b128 v[60:63], v2 offset:9216
    v_mfma_f32_16x16x32_bf16 v[96:99], a[200:203], v[24:27], v[96:99]
    ds_read_b128 v[64:67], v2 offset:10240
    v_mfma_f32_16x16x32_bf16 v[100:103], a[192:195], v[28:31], v[100:103]
    ds_read_b128 v[68:71], v2 offset:11264
    v_mfma_f32_16x16x32_bf16 v[104:107], a[196:199], v[28:31], v[104:107]
    ds_read_b128 v[72:75], v2 offset:12288
    v_mfma_f32_16x16x32_bf16 v[108:111], a[200:203], v[28:31], v[108:111]
    ds_read_b128 v[76:79], v2 offset:13312
    v_mfma_f32_16x16x32_bf16 v[112:115], a[192:195], v[32:35], v[112:115]
    ds_read_b128 v[80:83], v2 offset:14336
    v_mfma_f32_16x16x32_bf16 v[116:119], a[196:199], v[32:35], v[116:119]
    ds_read_b128 v[84:87], v2 offset:15360
    v_mfma_f32_16x16x32_bf16 v[120:123], a[200:203], v[32:35], v[120:123]
    v_mfma_f32_16x16x32_bf16 v[124:127], a[192:195], v[36:39], v[124:127]
    v_mfma_f32_16x16x32_bf16 v[128:131], a[196:199], v[36:39], v[128:131]
    v_mfma_f32_16x16x32_bf16 v[132:135], a[200:203], v[36:39], v[132:135]
    v_mfma_f32_16x16x32_bf16 v[136:139], a[192:195], v[40:43], v[136:139]
    v_mfma_f32_16x16x32_bf16 v[140:143], a[196:199], v[40:43], v[140:143]
    v_mfma_f32_16x16x32_bf16 v[144:147], a[200:203], v[40:43], v[144:147]
    s_mul_i32 s43, s4, 5120
    v_mfma_f32_16x16x32_bf16 v[148:151], a[192:195], v[44:47], v[148:151]
    v_mfma_f32_16x16x32_bf16 v[152:155], a[196:199], v[44:47], v[152:155]
    s_add_u32 s43, s43, s5
    v_mfma_f32_16x16x32_bf16 v[156:159], a[200:203], v[44:47], v[156:159]
    v_mfma_f32_16x16x32_bf16 v[160:163], a[192:195], v[48:51], v[160:163]
    buffer_load_dwordx4 a[180:183], v2, s[16:19], s43 offen offset:0 sc1
    v_mfma_f32_16x16x32_bf16 v[164:167], a[196:199], v[48:51], v[164:167]
    v_mfma_f32_16x16x32_bf16 v[168:171], a[200:203], v[48:51], v[168:171]
    buffer_load_dwordx4 a[184:187], v2, s[16:19], s43 offen offset:1024 sc1
    v_mfma_f32_16x16x32_bf16 v[172:175], a[192:195], v[52:55], v[172:175]
    v_mfma_f32_16x16x32_bf16 v[176:179], a[196:199], v[52:55], v[176:179]
    buffer_load_dwordx4 a[188:191], v2, s[16:19], s43 offen offset:2048 sc1
    v_mfma_f32_16x16x32_bf16 v[180:183], a[200:203], v[52:55], v[180:183]
    s_waitcnt lgkmcnt(0)
    s_waitcnt vmcnt(43)
    s_barrier
    v_mfma_f32_16x16x32_bf16 v[88:91], a[204:207], v[56:59], v[88:91]
    ds_read_b128 v[24:27], v2 offset:16384
    v_mfma_f32_16x16x32_bf16 v[92:95], a[208:211], v[56:59], v[92:95]
    ds_read_b128 v[28:31], v2 offset:17408
    v_mfma_f32_16x16x32_bf16 v[96:99], a[212:215], v[56:59], v[96:99]
    ds_read_b128 v[32:35], v2 offset:18432
    v_mfma_f32_16x16x32_bf16 v[100:103], a[204:207], v[60:63], v[100:103]
    ds_read_b128 v[36:39], v2 offset:19456
    v_mfma_f32_16x16x32_bf16 v[104:107], a[208:211], v[60:63], v[104:107]
    ds_read_b128 v[40:43], v2 offset:20480
    v_mfma_f32_16x16x32_bf16 v[108:111], a[212:215], v[60:63], v[108:111]
    ds_read_b128 v[44:47], v2 offset:21504
    v_mfma_f32_16x16x32_bf16 v[112:115], a[204:207], v[64:67], v[112:115]
    ds_read_b128 v[48:51], v2 offset:22528
    v_mfma_f32_16x16x32_bf16 v[116:119], a[208:211], v[64:67], v[116:119]
    ds_read_b128 v[52:55], v2 offset:23552
    v_mfma_f32_16x16x32_bf16 v[120:123], a[212:215], v[64:67], v[120:123]
    v_mfma_f32_16x16x32_bf16 v[124:127], a[204:207], v[68:71], v[124:127]
    v_mfma_f32_16x16x32_bf16 v[128:131], a[208:211], v[68:71], v[128:131]
    v_mfma_f32_16x16x32_bf16 v[132:135], a[212:215], v[68:71], v[132:135]
    v_mfma_f32_16x16x32_bf16 v[136:139], a[204:207], v[72:75], v[136:139]
    buffer_load_dwordx4 a[192:195], v2, s[16:19], s43 offen offset:3072 sc1
    v_mfma_f32_16x16x32_bf16 v[140:143], a[208:211], v[72:75], v[140:143]
    buffer_load_dwordx4 a[196:199], v4, s[16:19], s43 offen offset:0 sc1
    v_mfma_f32_16x16x32_bf16 v[144:147], a[212:215], v[72:75], v[144:147]
    v_mfma_f32_16x16x32_bf16 v[148:151], a[204:207], v[76:79], v[148:151]
    s_add_u32 s4, s4, 1
    v_mfma_f32_16x16x32_bf16 v[152:155], a[208:211], v[76:79], v[152:155]
    s_cmp_eq_u32 s4, 12
    v_mfma_f32_16x16x32_bf16 v[156:159], a[212:215], v[76:79], v[156:159]
    v_mfma_f32_16x16x32_bf16 v[160:163], a[204:207], v[80:83], v[160:163]
    s_cselect_b32 s4, 0, s4
    v_mfma_f32_16x16x32_bf16 v[164:167], a[208:211], v[80:83], v[164:167]
    s_mul_i32 s43, s4, 5120
    v_mfma_f32_16x16x32_bf16 v[168:171], a[212:215], v[80:83], v[168:171]
    v_mfma_f32_16x16x32_bf16 v[172:175], a[204:207], v[84:87], v[172:175]
    s_add_u32 s43, s43, s5
    v_mfma_f32_16x16x32_bf16 v[176:179], a[208:211], v[84:87], v[176:179]
    buffer_load_dwordx4 a[200:203], v2, s[16:19], s43 offen offset:0 sc1
    v_mfma_f32_16x16x32_bf16 v[180:183], a[212:215], v[84:87], v[180:183]
    s_waitcnt lgkmcnt(0)
    v_mfma_f32_16x16x32_bf16 v[88:91], a[216:219], v[24:27], v[88:91]
    ds_read_b128 v[56:59], v2 offset:24576
    v_mfma_f32_16x16x32_bf16 v[92:95], a[220:223], v[24:27], v[92:95]
    ds_read_b128 v[60:63], v2 offset:25600
    v_mfma_f32_16x16x32_bf16 v[96:99], a[224:227], v[24:27], v[96:99]
    ds_read_b128 v[64:67], v2 offset:26624
    v_mfma_f32_16x16x32_bf16 v[100:103], a[216:219], v[28:31], v[100:103]
    ds_read_b128 v[68:71], v2 offset:27648
    v_mfma_f32_16x16x32_bf16 v[104:107], a[220:223], v[28:31], v[104:107]
    ds_read_b128 v[72:75], v2 offset:28672
    v_mfma_f32_16x16x32_bf16 v[108:111], a[224:227], v[28:31], v[108:111]
    ds_read_b128 v[76:79], v2 offset:29696
    v_mfma_f32_16x16x32_bf16 v[112:115], a[216:219], v[32:35], v[112:115]
    ds_read_b128 v[80:83], v2 offset:30720
    v_mfma_f32_16x16x32_bf16 v[116:119], a[220:223], v[32:35], v[116:119]
    ds_read_b128 v[84:87], v2 offset:31744
    v_mfma_f32_16x16x32_bf16 v[120:123], a[224:227], v[32:35], v[120:123]
    v_mfma_f32_16x16x32_bf16 v[124:127], a[216:219], v[36:39], v[124:127]
    v_mfma_f32_16x16x32_bf16 v[128:131], a[220:223], v[36:39], v[128:131]
    v_mfma_f32_16x16x32_bf16 v[132:135], a[224:227], v[36:39], v[132:135]
    v_mfma_f32_16x16x32_bf16 v[136:139], a[216:219], v[40:43], v[136:139]
    v_mfma_f32_16x16x32_bf16 v[140:143], a[220:223], v[40:43], v[140:143]
    v_mfma_f32_16x16x32_bf16 v[144:147], a[224:227], v[40:43], v[144:147]
    v_mfma_f32_16x16x32_bf16 v[148:151], a[216:219], v[44:47], v[148:151]
    v_mfma_f32_16x16x32_bf16 v[152:155], a[220:223], v[44:47], v[152:155]
    v_mfma_f32_16x16x32_bf16 v[156:159], a[224:227], v[44:47], v[156:159]
    buffer_load_dwordx4 a[204:207], v2, s[16:19], s43 offen offset:1024 sc1
    v_mfma_f32_16x16x32_bf16 v[160:163], a[216:219], v[48:51], v[160:163]
    v_mfma_f32_16x16x32_bf16 v[164:167], a[220:223], v[48:51], v[164:167]
    buffer_load_dwordx4 a[208:211], v2, s[16:19], s43 offen offset:2048 sc1
    v_mfma_f32_16x16x32_bf16 v[168:171], a[224:227], v[48:51], v[168:171]
    v_mfma_f32_16x16x32_bf16 v[172:175], a[216:219], v[52:55], v[172:175]
    buffer_load_dwordx4 a[212:215], v2, s[16:19], s43 offen offset:3072 sc1
    v_mfma_f32_16x16x32_bf16 v[176:179], a[220:223], v[52:55], v[176:179]
    v_mfma_f32_16x16x32_bf16 v[180:183], a[224:227], v[52:55], v[180:183]
    s_waitcnt lgkmcnt(0)
    v_mfma_f32_16x16x32_bf16 v[88:91], a[228:231], v[56:59], v[88:91]
    buffer_load_dwordx4 a[216:219], v4, s[16:19], s43 offen offset:0 sc1
    v_mfma_f32_16x16x32_bf16 v[92:95], a[232:235], v[56:59], v[92:95]
    v_mfma_f32_16x16x32_bf16 v[96:99], a[236:239], v[56:59], v[96:99]
    v_mfma_f32_16x16x32_bf16 v[100:103], a[228:231], v[60:63], v[100:103]
    s_add_u32 s4, s4, 1
    v_mfma_f32_16x16x32_bf16 v[104:107], a[232:235], v[60:63], v[104:107]
    v_mfma_f32_16x16x32_bf16 v[108:111], a[236:239], v[60:63], v[108:111]
    v_mfma_f32_16x16x32_bf16 v[112:115], a[228:231], v[64:67], v[112:115]
    s_cmp_eq_u32 s4, 12
    v_mfma_f32_16x16x32_bf16 v[116:119], a[232:235], v[64:67], v[116:119]
    v_mfma_f32_16x16x32_bf16 v[120:123], a[236:239], v[64:67], v[120:123]
    v_mfma_f32_16x16x32_bf16 v[124:127], a[228:231], v[68:71], v[124:127]
    s_cselect_b32 s4, 0, s4
    v_mfma_f32_16x16x32_bf16 v[128:131], a[232:235], v[68:71], v[128:131]
    v_mfma_f32_16x16x32_bf16 v[132:135], a[236:239], v[68:71], v[132:135]
    v_mfma_f32_16x16x32_bf16 v[136:139], a[228:231], v[72:75], v[136:139]
    s_mul_i32 s43, s4, 5120
    v_mfma_f32_16x16x32_bf16 v[140:143], a[232:235], v[72:75], v[140:143]
    v_mfma_f32_16x16x32_bf16 v[144:147], a[236:239], v[72:75], v[144:147]
    v_mfma_f32_16x16x32_bf16 v[148:151], a[228:231], v[76:79], v[148:151]
    s_add_u32 s43, s43, s5
    v_mfma_f32_16x16x32_bf16 v[152:155], a[232:235], v[76:79], v[152:155]
    v_mfma_f32_16x16x32_bf16 v[156:159], a[236:239], v[76:79], v[156:159]
    v_mfma_f32_16x16x32_bf16 v[160:163], a[228:231], v[80:83], v[160:163]
    buffer_load_dwordx4 a[220:223], v2, s[16:19], s43 offen offset:0 sc1
    v_mfma_f32_16x16x32_bf16 v[164:167], a[232:235], v[80:83], v[164:167]
    v_mfma_f32_16x16x32_bf16 v[168:171], a[236:239], v[80:83], v[168:171]
    v_mfma_f32_16x16x32_bf16 v[172:175], a[228:231], v[84:87], v[172:175]
    buffer_load_dwordx4 a[224:227], v2, s[16:19], s43 offen offset:1024 sc1
    v_mfma_f32_16x16x32_bf16 v[176:179], a[232:235], v[84:87], v[176:179]
    v_mfma_f32_16x16x32_bf16 v[180:183], a[236:239], v[84:87], v[180:183]
    v_and_b32 v6, 15, v0
    v_lshlrev_b32 v7, 3, v6
    v_add_u32 v7, 0x20000, v7
    ds_read_b64 v[184:185], v7 offset:0
    ds_read_b64 v[186:187], v7 offset:128
    ds_read_b64 v[188:189], v7 offset:256
    ds_read_b64 v[190:191], v7 offset:384
    ds_read_b64 v[192:193], v7 offset:512
    ds_read_b64 v[194:195], v7 offset:640
    ds_read_b64 v[196:197], v7 offset:768
    ds_read_b64 v[198:199], v7 offset:896
    v_lshrrev_b32 v7, 4, v0
    v_mul_u32_u24 v7, 49152, v7
    v_lshl_add_u32 v7, v6, 4, v7
    s_mul_i32 s40, s34, 393216
    s_mul_i32 s41, s35, 3072
    s_add_u32 s40, s40, s41
    s_lshl_b32 s41, s36, 8
    s_add_u32 s40, s40, s41
    s_add_u32 s40, s40, 13631488
    s_waitcnt lgkmcnt(0)
    v_pk_fma_f32 v[88:89], v[184:185], v[208:209], v[88:89] op_sel_hi:[0,1,1] neg_lo:[1,0,0] neg_hi:[1,0,0]
    v_pk_fma_f32 v[100:101], v[186:187], v[208:209], v[100:101] op_sel_hi:[0,1,1] neg_lo:[1,0,0] neg_hi:[1,0,0]
    v_pk_fma_f32 v[112:113], v[188:189], v[208:209], v[112:113] op_sel_hi:[0,1,1] neg_lo:[1,0,0] neg_hi:[1,0,0]
    v_pk_fma_f32 v[124:125], v[190:191], v[208:209], v[124:125] op_sel_hi:[0,1,1] neg_lo:[1,0,0] neg_hi:[1,0,0]
    v_pk_fma_f32 v[90:91], v[184:185], v[210:211], v[90:91] op_sel_hi:[0,1,1] neg_lo:[1,0,0] neg_hi:[1,0,0]
    v_pk_fma_f32 v[102:103], v[186:187], v[210:211], v[102:103] op_sel_hi:[0,1,1] neg_lo:[1,0,0] neg_hi:[1,0,0]
    v_pk_fma_f32 v[114:115], v[188:189], v[210:211], v[114:115] op_sel_hi:[0,1,1] neg_lo:[1,0,0] neg_hi:[1,0,0]
    v_pk_fma_f32 v[126:127], v[190:191], v[210:211], v[126:127] op_sel_hi:[0,1,1] neg_lo:[1,0,0] neg_hi:[1,0,0]
    v_max_f32 v88, 0, v88
    v_max_f32 v100, 0, v100
    v_max_f32 v112, 0, v112
    v_max_f32 v124, 0, v124
    v_max_f32 v89, 0, v89
    v_max_f32 v101, 0, v101
    v_max_f32 v113, 0, v113
    v_max_f32 v125, 0, v125
    v_pk_mul_f32 v[90:91], v[90:91], v[184:185] op_sel:[0,1] op_sel_hi:[1,1]
    v_pk_mul_f32 v[102:103], v[102:103], v[186:187] op_sel:[0,1] op_sel_hi:[1,1]
    v_pk_mul_f32 v[114:115], v[114:115], v[188:189] op_sel:[0,1] op_sel_hi:[1,1]
    v_pk_mul_f32 v[126:127], v[126:127], v[190:191] op_sel:[0,1] op_sel_hi:[1,1]
    v_pk_mul_f32 v[88:89], v[88:89], v[90:91]
    v_pk_mul_f32 v[100:101], v[100:101], v[102:103]
    v_pk_mul_f32 v[112:113], v[112:113], v[114:115]
    v_pk_mul_f32 v[124:125], v[124:125], v[126:127]
    v_cvt_pk_bf16_f32 v24, v88, v89
    v_cvt_pk_bf16_f32 v25, v100, v101
    v_cvt_pk_bf16_f32 v26, v112, v113
    v_cvt_pk_bf16_f32 v27, v124, v125
    s_nop 1
    v_permlane32_swap_b32 v24, v26
    v_permlane32_swap_b32 v25, v27
    s_nop 1
    v_permlane16_swap_b32 v24, v25
    v_permlane16_swap_b32 v26, v27
    s_nop 0
    buffer_store_dwordx4 v[24:27], v7, s[16:19], s40 offen offset:0 sc0 sc1
    v_pk_fma_f32 v[92:93], v[184:185], v[212:213], v[92:93] op_sel_hi:[0,1,1] neg_lo:[1,0,0] neg_hi:[1,0,0]
    v_pk_fma_f32 v[104:105], v[186:187], v[212:213], v[104:105] op_sel_hi:[0,1,1] neg_lo:[1,0,0] neg_hi:[1,0,0]
    v_pk_fma_f32 v[116:117], v[188:189], v[212:213], v[116:117] op_sel_hi:[0,1,1] neg_lo:[1,0,0] neg_hi:[1,0,0]
    v_pk_fma_f32 v[128:129], v[190:191], v[212:213], v[128:129] op_sel_hi:[0,1,1] neg_lo:[1,0,0] neg_hi:[1,0,0]
    v_pk_fma_f32 v[94:95], v[184:185], v[214:215], v[94:95] op_sel_hi:[0,1,1] neg_lo:[1,0,0] neg_hi:[1,0,0]
    v_pk_fma_f32 v[106:107], v[186:187], v[214:215], v[106:107] op_sel_hi:[0,1,1] neg_lo:[1,0,0] neg_hi:[1,0,0]
    v_pk_fma_f32 v[118:119], v[188:189], v[214:215], v[118:119] op_sel_hi:[0,1,1] neg_lo:[1,0,0] neg_hi:[1,0,0]
    v_pk_fma_f32 v[130:131], v[190:191], v[214:215], v[130:131] op_sel_hi:[0,1,1] neg_lo:[1,0,0] neg_hi:[1,0,0]
    v_max_f32 v92, 0, v92
    v_max_f32 v104, 0, v104
    v_max_f32 v116, 0, v116
    v_max_f32 v128, 0, v128
    v_max_f32 v93, 0, v93
    v_max_f32 v105, 0, v105
    v_max_f32 v117, 0, v117
    v_max_f32 v129, 0, v129
    v_pk_mul_f32 v[94:95], v[94:95], v[184:185] op_sel:[0,1] op_sel_hi:[1,1]
    v_pk_mul_f32 v[106:107], v[106:107], v[186:187] op_sel:[0,1] op_sel_hi:[1,1]
    v_pk_mul_f32 v[118:119], v[118:119], v[188:189] op_sel:[0,1] op_sel_hi:[1,1]
    v_pk_mul_f32 v[130:131], v[130:131], v[190:191] op_sel:[0,1] op_sel_hi:[1,1]
    v_pk_mul_f32 v[92:93], v[92:93], v[94:95]
    v_pk_mul_f32 v[104:105], v[104:105], v[106:107]
    v_pk_mul_f32 v[116:117], v[116:117], v[118:119]
    v_pk_mul_f32 v[128:129], v[128:129], v[130:131]
    v_cvt_pk_bf16_f32 v32, v92, v93
    v_cvt_pk_bf16_f32 v33, v104, v105
    v_cvt_pk_bf16_f32 v34, v116, v117
    v_cvt_pk_bf16_f32 v35, v128, v129
    s_nop 1
    v_permlane32_swap_b32 v32, v34
    v_permlane32_swap_b32 v33, v35
    s_nop 1
    v_permlane16_swap_b32 v32, v33
    v_permlane16_swap_b32 v34, v35
    s_nop 0
    buffer_store_dwordx4 v[32:35], v7, s[16:19], s40 offen offset:1024 sc0 sc1
    v_pk_fma_f32 v[96:97], v[184:185], v[216:217], v[96:97] op_sel_hi:[0,1,1] neg_lo:[1,0,0] neg_hi:[1,0,0]
    v_pk_fma_f32 v[108:109], v[186:187], v[216:217], v[108:109] op_sel_hi:[0,1,1] neg_lo:[1,0,0] neg_hi:[1,0,0]
    v_pk_fma_f32 v[120:121], v[188:189], v[216:217], v[120:121] op_sel_hi:[0,1,1] neg_lo:[1,0,0] neg_hi:[1,0,0]
    v_pk_fma_f32 v[132:133], v[190:191], v[216:217], v[132:133] op_sel_hi:[0,1,1] neg_lo:[1,0,0] neg_hi:[1,0,0]
    v_pk_fma_f32 v[98:99], v[184:185], v[218:219], v[98:99] op_sel_hi:[0,1,1] neg_lo:[1,0,0] neg_hi:[1,0,0]
    v_pk_fma_f32 v[110:111], v[186:187], v[218:219], v[110:111] op_sel_hi:[0,1,1] neg_lo:[1,0,0] neg_hi:[1,0,0]
    v_pk_fma_f32 v[122:123], v[188:189], v[218:219], v[122:123] op_sel_hi:[0,1,1] neg_lo:[1,0,0] neg_hi:[1,0,0]
    v_pk_fma_f32 v[134:135], v[190:191], v[218:219], v[134:135] op_sel_hi:[0,1,1] neg_lo:[1,0,0] neg_hi:[1,0,0]
    v_max_f32 v96, 0, v96
    v_max_f32 v108, 0, v108
    v_max_f32 v120, 0, v120
    v_max_f32 v132, 0, v132
    v_max_f32 v97, 0, v97
    v_max_f32 v109, 0, v109
    v_max_f32 v121, 0, v121
    v_max_f32 v133, 0, v133
    v_pk_mul_f32 v[98:99], v[98:99], v[184:185] op_sel:[0,1] op_sel_hi:[1,1]
    v_pk_mul_f32 v[110:111], v[110:111], v[186:187] op_sel:[0,1] op_sel_hi:[1,1]
    v_pk_mul_f32 v[122:123], v[122:123], v[188:189] op_sel:[0,1] op_sel_hi:[1,1]
    v_pk_mul_f32 v[134:135], v[134:135], v[190:191] op_sel:[0,1] op_sel_hi:[1,1]
    v_pk_mul_f32 v[96:97], v[96:97], v[98:99]
    v_pk_mul_f32 v[108:109], v[108:109], v[110:111]
    v_pk_mul_f32 v[120:121], v[120:121], v[122:123]
    v_pk_mul_f32 v[132:133], v[132:133], v[134:135]
    v_cvt_pk_bf16_f32 v40, v96, v97
    v_cvt_pk_bf16_f32 v41, v108, v109
    v_cvt_pk_bf16_f32 v42, v120, v121
    v_cvt_pk_bf16_f32 v43, v132, v133
    s_nop 1
    v_permlane32_swap_b32 v40, v42
    v_permlane32_swap_b32 v41, v43
    s_nop 1
    v_permlane16_swap_b32 v40, v41
    v_permlane16_swap_b32 v42, v43
    s_nop 0
    buffer_store_dwordx4 v[40:43], v7, s[16:19], s40 offen offset:2048 sc0 sc1
    s_add_u32 s40, s40, 196608
    v_pk_fma_f32 v[136:137], v[192:193], v[208:209], v[136:137] op_sel_hi:[0,1,1] neg_lo:[1,0,0] neg_hi:[1,0,0]
    v_pk_fma_f32 v[148:149], v[194:195], v[208:209], v[148:149] op_sel_hi:[0,1,1] neg_lo:[1,0,0] neg_hi:[1,0,0]
    v_pk_fma_f32 v[160:161], v[196:197], v[208:209], v[160:161] op_sel_hi:[0,1,1] neg_lo:[1,0,0] neg_hi:[1,0,0]
    v_pk_fma_f32 v[172:173], v[198:199], v[208:209], v[172:173] op_sel_hi:[0,1,1] neg_lo:[1,0,0] neg_hi:[1,0,0]
    v_pk_fma_f32 v[138:139], v[192:193], v[210:211], v[138:139] op_sel_hi:[0,1,1] neg_lo:[1,0,0] neg_hi:[1,0,0]
    v_pk_fma_f32 v[150:151], v[194:195], v[210:211], v[150:151] op_sel_hi:[0,1,1] neg_lo:[1,0,0] neg_hi:[1,0,0]
    v_pk_fma_f32 v[162:163], v[196:197], v[210:211], v[162:163] op_sel_hi:[0,1,1] neg_lo:[1,0,0] neg_hi:[1,0,0]
    v_pk_fma_f32 v[174:175], v[198:199], v[210:211], v[174:175] op_sel_hi:[0,1,1] neg_lo:[1,0,0] neg_hi:[1,0,0]
    v_max_f32 v136, 0, v136
    v_max_f32 v148, 0, v148
    v_max_f32 v160, 0, v160
    v_max_f32 v172, 0, v172
    v_max_f32 v137, 0, v137
    v_max_f32 v149, 0, v149
    v_max_f32 v161, 0, v161
    v_max_f32 v173, 0, v173
    v_pk_mul_f32 v[138:139], v[138:139], v[192:193] op_sel:[0,1] op_sel_hi:[1,1]
    v_pk_mul_f32 v[150:151], v[150:151], v[194:195] op_sel:[0,1] op_sel_hi:[1,1]
    v_pk_mul_f32 v[162:163], v[162:163], v[196:197] op_sel:[0,1] op_sel_hi:[1,1]
    v_pk_mul_f32 v[174:175], v[174:175], v[198:199] op_sel:[0,1] op_sel_hi:[1,1]
    v_pk_mul_f32 v[136:137], v[136:137], v[138:139]
    v_pk_mul_f32 v[148:149], v[148:149], v[150:151]
    v_pk_mul_f32 v[160:161], v[160:161], v[162:163]
    v_pk_mul_f32 v[172:173], v[172:173], v[174:175]
    v_cvt_pk_bf16_f32 v28, v136, v137
    v_cvt_pk_bf16_f32 v29, v148, v149
    v_cvt_pk_bf16_f32 v30, v160, v161
    v_cvt_pk_bf16_f32 v31, v172, v173
    s_nop 1
    v_permlane32_swap_b32 v28, v30
    v_permlane32_swap_b32 v29, v31
    s_nop 1
    v_permlane16_swap_b32 v28, v29
    v_permlane16_swap_b32 v30, v31
    s_nop 0
    buffer_store_dwordx4 v[28:31], v7, s[16:19], s40 offen offset:0 sc0 sc1
    v_pk_fma_f32 v[140:141], v[192:193], v[212:213], v[140:141] op_sel_hi:[0,1,1] neg_lo:[1,0,0] neg_hi:[1,0,0]
    v_pk_fma_f32 v[152:153], v[194:195], v[212:213], v[152:153] op_sel_hi:[0,1,1] neg_lo:[1,0,0] neg_hi:[1,0,0]
    v_pk_fma_f32 v[164:165], v[196:197], v[212:213], v[164:165] op_sel_hi:[0,1,1] neg_lo:[1,0,0] neg_hi:[1,0,0]
    v_pk_fma_f32 v[176:177], v[198:199], v[212:213], v[176:177] op_sel_hi:[0,1,1] neg_lo:[1,0,0] neg_hi:[1,0,0]
    v_pk_fma_f32 v[142:143], v[192:193], v[214:215], v[142:143] op_sel_hi:[0,1,1] neg_lo:[1,0,0] neg_hi:[1,0,0]
    v_pk_fma_f32 v[154:155], v[194:195], v[214:215], v[154:155] op_sel_hi:[0,1,1] neg_lo:[1,0,0] neg_hi:[1,0,0]
    v_pk_fma_f32 v[166:167], v[196:197], v[214:215], v[166:167] op_sel_hi:[0,1,1] neg_lo:[1,0,0] neg_hi:[1,0,0]
    v_pk_fma_f32 v[178:179], v[198:199], v[214:215], v[178:179] op_sel_hi:[0,1,1] neg_lo:[1,0,0] neg_hi:[1,0,0]
    v_max_f32 v140, 0, v140
    v_max_f32 v152, 0, v152
    v_max_f32 v164, 0, v164
    v_max_f32 v176, 0, v176
    v_max_f32 v141, 0, v141
    v_max_f32 v153, 0, v153
    v_max_f32 v165, 0, v165
    v_max_f32 v177, 0, v177
    v_pk_mul_f32 v[142:143], v[142:143], v[192:193] op_sel:[0,1] op_sel_hi:[1,1]
    v_pk_mul_f32 v[154:155], v[154:155], v[194:195] op_sel:[0,1] op_sel_hi:[1,1]
    v_pk_mul_f32 v[166:167], v[166:167], v[196:197] op_sel:[0,1] op_sel_hi:[1,1]
    v_pk_mul_f32 v[178:179], v[178:179], v[198:199] op_sel:[0,1] op_sel_hi:[1,1]
    v_pk_mul_f32 v[140:141], v[140:141], v[142:143]
    v_pk_mul_f32 v[152:153], v[152:153], v[154:155]
    v_pk_mul_f32 v[164:165], v[164:165], v[166:167]
    v_pk_mul_f32 v[176:177], v[176:177], v[178:179]
    v_cvt_pk_bf16_f32 v36, v140, v141
    v_cvt_pk_bf16_f32 v37, v152, v153
    v_cvt_pk_bf16_f32 v38, v164, v165
    v_cvt_pk_bf16_f32 v39, v176, v177
    s_nop 1
    v_permlane32_swap_b32 v36, v38
    v_permlane32_swap_b32 v37, v39
    s_nop 1
    v_permlane16_swap_b32 v36, v37
    v_permlane16_swap_b32 v38, v39
    s_nop 0
    buffer_store_dwordx4 v[36:39], v7, s[16:19], s40 offen offset:1024 sc0 sc1
    v_pk_fma_f32 v[144:145], v[192:193], v[216:217], v[144:145] op_sel_hi:[0,1,1] neg_lo:[1,0,0] neg_hi:[1,0,0]
    v_pk_fma_f32 v[156:157], v[194:195], v[216:217], v[156:157] op_sel_hi:[0,1,1] neg_lo:[1,0,0] neg_hi:[1,0,0]
    v_pk_fma_f32 v[168:169], v[196:197], v[216:217], v[168:169] op_sel_hi:[0,1,1] neg_lo:[1,0,0] neg_hi:[1,0,0]
    v_pk_fma_f32 v[180:181], v[198:199], v[216:217], v[180:181] op_sel_hi:[0,1,1] neg_lo:[1,0,0] neg_hi:[1,0,0]
    v_pk_fma_f32 v[146:147], v[192:193], v[218:219], v[146:147] op_sel_hi:[0,1,1] neg_lo:[1,0,0] neg_hi:[1,0,0]
    v_pk_fma_f32 v[158:159], v[194:195], v[218:219], v[158:159] op_sel_hi:[0,1,1] neg_lo:[1,0,0] neg_hi:[1,0,0]
    v_pk_fma_f32 v[170:171], v[196:197], v[218:219], v[170:171] op_sel_hi:[0,1,1] neg_lo:[1,0,0] neg_hi:[1,0,0]
    v_pk_fma_f32 v[182:183], v[198:199], v[218:219], v[182:183] op_sel_hi:[0,1,1] neg_lo:[1,0,0] neg_hi:[1,0,0]
    v_max_f32 v144, 0, v144
    v_max_f32 v156, 0, v156
    v_max_f32 v168, 0, v168
    v_max_f32 v180, 0, v180
    v_max_f32 v145, 0, v145
    v_max_f32 v157, 0, v157
    v_max_f32 v169, 0, v169
    v_max_f32 v181, 0, v181
    v_pk_mul_f32 v[146:147], v[146:147], v[192:193] op_sel:[0,1] op_sel_hi:[1,1]
    v_pk_mul_f32 v[158:159], v[158:159], v[194:195] op_sel:[0,1] op_sel_hi:[1,1]
    v_pk_mul_f32 v[170:171], v[170:171], v[196:197] op_sel:[0,1] op_sel_hi:[1,1]
    v_pk_mul_f32 v[182:183], v[182:183], v[198:199] op_sel:[0,1] op_sel_hi:[1,1]
    v_pk_mul_f32 v[144:145], v[144:145], v[146:147]
    v_pk_mul_f32 v[156:157], v[156:157], v[158:159]
    v_pk_mul_f32 v[168:169], v[168:169], v[170:171]
    v_pk_mul_f32 v[180:181], v[180:181], v[182:183]
    v_cvt_pk_bf16_f32 v44, v144, v145
    v_cvt_pk_bf16_f32 v45, v156, v157
    v_cvt_pk_bf16_f32 v46, v168, v169
    v_cvt_pk_bf16_f32 v47, v180, v181
    s_nop 1
    v_permlane32_swap_b32 v44, v46
    v_permlane32_swap_b32 v45, v47
    s_nop 1
    v_permlane16_swap_b32 v44, v45
    v_permlane16_swap_b32 v46, v47
    s_nop 0
    buffer_store_dwordx4 v[44:47], v7, s[16:19], s40 offen offset:2048 sc0 sc1
    s_add_u32 s41, s36, 0
    s_and_b32 s41, s41, 3
    s_mul_i32 s42, s41, 49152
    v_add_u32 v8, s42, v2
    s_mul_i32 s42, s41, 15360
    v_add_u32 v12, s42, v2
    s_add_u32 s41, s36, 1
    s_and_b32 s41, s41, 3
    s_mul_i32 s42, s41, 49152
    v_add_u32 v9, s42, v2
    s_mul_i32 s42, s41, 15360
    v_add_u32 v13, s42, v2
    s_add_u32 s41, s36, 2
    s_and_b32 s41, s41, 3
    s_mul_i32 s42, s41, 49152
    v_add_u32 v10, s42, v2
    s_mul_i32 s42, s41, 15360
    v_add_u32 v14, s42, v2
    s_add_u32 s41, s36, 3
    s_and_b32 s41, s41, 3
    s_mul_i32 s42, s41, 49152
    v_add_u32 v11, s42, v2
    s_mul_i32 s42, s41, 15360
    v_add_u32 v15, s42, v2
    s_lshr_b32 s65, s38, 2
    s_mul_i32 s65, s65, 196608
    s_mul_i32 s41, s36, 12288
    s_add_u32 s65, s65, s41
    s_add_u32 s65, s65, 13631488
    s_nop 0
    buffer_load_dwordx4 a[228:231], v2, s[16:19], s43 offen offset:2048 sc1
    buffer_load_dwordx4 a[232:235], v2, s[16:19], s43 offen offset:3072 sc1
    buffer_load_dwordx4 a[236:239], v4, s[16:19], s43 offen offset:0 sc1
    s_add_u32 s4, s4, 1
    s_cmp_eq_u32 s4, 12
    s_cselect_b32 s4, 0, s4
    s_waitcnt vmcnt(3)
    s_barrier
    s_cmp_lg_u32 s36, 0
    s_cbranch_scc1 W_53
    s_mov_b64 exec, 1
    v_mov_b32 v16, 0
    v_mov_b32 v17, 3
    buffer_store_dword v17, v16, s[16:19], s7 offen sc1
    s_mov_b64 exec, -1
W_53:
    s_nop 0
    s_and_b32 s40, s7, 0xffffff80
    v_and_b32 v18, 15, v0
    v_lshlrev_b32 v18, 2, v18
    s_mov_b32 s41, 100000
P_54:
    buffer_load_dword v19, v18, s[16:19], s40 offen sc1
    s_waitcnt vmcnt(0)
    v_cmp_gt_u32 vcc, 3, v19
    s_sub_u32 s41, s41, 1
    s_cbranch_vccz P_55
    s_cmp_lg_u32 s41, 0
    s_cbranch_scc1 P_54
P_55:
    s_lshl_b32 s41, s4, 10
    s_add_u32 s41, s41, s65
    buffer_load_dwordx4 v[112:115], v9, s[16:19], s41 offen offset:0 sc1
    buffer_load_dwordx4 v[116:119], v10, s[16:19], s41 offen offset:0 sc1
    buffer_load_dwordx4 v[120:123], v11, s[16:19], s41 offen offset:0 sc1
    buffer_load_dwordx4 v[108:111], v8, s[16:19], s41 offen offset:0 sc1
    s_add_u32 s4, s4, 1
    s_cmp_eq_u32 s4, 12
    s_cselect_b32 s4, 0, s4
    s_lshl_b32 s41, s4, 10
    s_add_u32 s41, s41, s65
    buffer_load_dwordx4 v[128:131], v9, s[16:19], s41 offen offset:0 sc1
    buffer_load_dwordx4 v[132:135], v10, s[16:19], s41 offen offset:0 sc1
    buffer_load_dwordx4 v[136:139], v11, s[16:19], s41 offen offset:0 sc1
    buffer_load_dwordx4 v[124:127], v8, s[16:19], s41 offen offset:0 sc1
    s_add_u32 s4, s4, 1
    s_cmp_eq_u32 s4, 12
    s_cselect_b32 s4, 0, s4
    s_lshl_b32 s41, s4, 10
    s_add_u32 s41, s41, s65
    buffer_load_dwordx4 v[144:147], v9, s[16:19], s41 offen offset:0 sc1
    buffer_load_dwordx4 v[148:151], v10, s[16:19], s41 offen offset:0 sc1
    buffer_load_dwordx4 v[152:155], v11, s[16:19], s41 offen offset:0 sc1
    buffer_load_dwordx4 v[140:143], v8, s[16:19], s41 offen offset:0 sc1
    s_add_u32 s4, s4, 1
    s_cmp_eq_u32 s4, 12
    s_cselect_b32 s4, 0, s4
    s_waitcnt vmcnt(8)
    v_mfma_f32_16x16x32_bf16 v[48:51], a[0:3], v[112:115], 0
    s_lshl_b32 s41, s4, 10
    v_mfma_f32_16x16x32_bf16 v[52:55], a[4:7], v[112:115], 0
    v_mfma_f32_16x16x32_bf16 v[56:59], a[8:11], v[112:115], 0
    s_add_u32 s41, s41, s65
    v_mfma_f32_16x16x32_bf16 v[60:63], a[12:15], v[112:115], 0
    v_mfma_f32_16x16x32_bf16 v[64:67], a[16:19], v[112:115], 0
    buffer_load_dwordx4 v[160:163], v9, s[16:19], s41 offen offset:0 sc1
    v_mfma_f32_16x16x32_bf16 v[68:71], a[0:3], v[116:119], 0
    v_mfma_f32_16x16x32_bf16 v[72:75], a[4:7], v[116:119], 0
    buffer_load_dwordx4 v[164:167], v10, s[16:19], s41 offen offset:0 sc1
    v_mfma_f32_16x16x32_bf16 v[76:79], a[8:11], v[116:119], 0
    v_mfma_f32_16x16x32_bf16 v[80:83], a[12:15], v[116:119], 0
    buffer_load_dwordx4 v[168:171], v11, s[16:19], s41 offen offset:0 sc1
    v_mfma_f32_16x16x32_bf16 v[84:87], a[16:19], v[116:119], 0
    v_mfma_f32_16x16x32_bf16 v[88:91], a[0:3], v[120:123], 0
    v_mfma_f32_16x16x32_bf16 v[92:95], a[4:7], v[120:123], 0
    buffer_load_dwordx4 v[156:159], v8, s[16:19], s41 offen offset:0 sc1
    v_mfma_f32_16x16x32_bf16 v[96:99], a[8:11], v[120:123], 0
    v_mfma_f32_16x16x32_bf16 v[100:103], a[12:15], v[120:123], 0
    s_add_u32 s4, s4, 1
    v_mfma_f32_16x16x32_bf16 v[104:107], a[16:19], v[120:123], 0
    v_mfma_f32_16x16x32_bf16 v[28:31], a[0:3], v[108:111], 0
    s_cmp_eq_u32 s4, 12
    v_mfma_f32_16x16x32_bf16 v[32:35], a[4:7], v[108:111], 0
    v_mfma_f32_16x16x32_bf16 v[36:39], a[8:11], v[108:111], 0
    s_cselect_b32 s4, 0, s4
    v_mfma_f32_16x16x32_bf16 v[40:43], a[12:15], v[108:111], 0
    v_mfma_f32_16x16x32_bf16 v[44:47], a[16:19], v[108:111], 0
    s_waitcnt vmcnt(8)
    v_mfma_f32_16x16x32_bf16 v[48:51], a[20:23], v[128:131], v[48:51]
    s_lshl_b32 s41, s4, 10
    v_mfma_f32_16x16x32_bf16 v[52:55], a[24:27], v[128:131], v[52:55]
    v_mfma_f32_16x16x32_bf16 v[56:59], a[28:31], v[128:131], v[56:59]
    s_add_u32 s41, s41, s65
    v_mfma_f32_16x16x32_bf16 v[60:63], a[32:35], v[128:131], v[60:63]
    v_mfma_f32_16x16x32_bf16 v[64:67], a[36:39], v[128:131], v[64:67]
    buffer_load_dwordx4 v[176:179], v9, s[16:19], s41 offen offset:0 sc1
    v_mfma_f32_16x16x32_bf16 v[68:71], a[20:23], v[132:135], v[68:71]
    v_mfma_f32_16x16x32_bf16 v[72:75], a[24:27], v[132:135], v[72:75]
    buffer_load_dwordx4 v[180:183], v10, s[16:19], s41 offen offset:0 sc1
    v_mfma_f32_16x16x32_bf16 v[76:79], a[28:31], v[132:135], v[76:79]
    v_mfma_f32_16x16x32_bf16 v[80:83], a[32:35], v[132:135], v[80:83]
    buffer_load_dwordx4 v[184:187], v11, s[16:19], s41 offen offset:0 sc1
    v_mfma_f32_16x16x32_bf16 v[84:87], a[36:39], v[132:135], v[84:87]
    v_mfma_f32_16x16x32_bf16 v[88:91], a[20:23], v[136:139], v[88:91]
    v_mfma_f32_16x16x32_bf16 v[92:95], a[24:27], v[136:139], v[92:95]
    buffer_load_dwordx4 v[172:175], v8, s[16:19], s41 offen offset:0 sc1
    v_mfma_f32_16x16x32_bf16 v[96:99], a[28:31], v[136:139], v[96:99]
    v_mfma_f32_16x16x32_bf16 v[100:103], a[32:35], v[136:139], v[100:103]
    s_add_u32 s4, s4, 1
    v_mfma_f32_16x16x32_bf16 v[104:107], a[36:39], v[136:139], v[104:107]
    v_mfma_f32_16x16x32_bf16 v[28:31], a[20:23], v[124:127], v[28:31]
    s_cmp_eq_u32 s4, 12
    v_mfma_f32_16x16x32_bf16 v[32:35], a[24:27], v[124:127], v[32:35]
    v_mfma_f32_16x16x32_bf16 v[36:39], a[28:31], v[124:127], v[36:39]
    s_cselect_b32 s4, 0, s4
    v_mfma_f32_16x16x32_bf16 v[40:43], a[32:35], v[124:127], v[40:43]
    v_mfma_f32_16x16x32_bf16 v[44:47], a[36:39], v[124:127], v[44:47]
    s_waitcnt vmcnt(8)
    v_mfma_f32_16x16x32_bf16 v[48:51], a[40:43], v[144:147], v[48:51]
    s_lshl_b32 s41, s4, 10
    v_mfma_f32_16x16x32_bf16 v[52:55], a[44:47], v[144:147], v[52:55]
    v_mfma_f32_16x16x32_bf16 v[56:59], a[48:51], v[144:147], v[56:59]
    s_add_u32 s41, s41, s65
    v_mfma_f32_16x16x32_bf16 v[60:63], a[52:55], v[144:147], v[60:63]
    v_mfma_f32_16x16x32_bf16 v[64:67], a[56:59], v[144:147], v[64:67]
    buffer_load_dwordx4 v[192:195], v9, s[16:19], s41 offen offset:0 sc1
    v_mfma_f32_16x16x32_bf16 v[68:71], a[40:43], v[148:151], v[68:71]
    v_mfma_f32_16x16x32_bf16 v[72:75], a[44:47], v[148:151], v[72:75]
    buffer_load_dwordx4 v[196:199], v10, s[16:19], s41 offen offset:0 sc1
    v_mfma_f32_16x16x32_bf16 v[76:79], a[48:51], v[148:151], v[76:79]
    v_mfma_f32_16x16x32_bf16 v[80:83], a[52:55], v[148:151], v[80:83]
    buffer_load_dwordx4 v[200:203], v11, s[16:19], s41 offen offset:0 sc1
    v_mfma_f32_16x16x32_bf16 v[84:87], a[56:59], v[148:151], v[84:87]
    v_mfma_f32_16x16x32_bf16 v[88:91], a[40:43], v[152:155], v[88:91]
    v_mfma_f32_16x16x32_bf16 v[92:95], a[44:47], v[152:155], v[92:95]
    buffer_load_dwordx4 v[188:191], v8, s[16:19], s41 offen offset:0 sc1
    v_mfma_f32_16x16x32_bf16 v[96:99], a[48:51], v[152:155], v[96:99]
    v_mfma_f32_16x16x32_bf16 v[100:103], a[52:55], v[152:155], v[100:103]
    s_add_u32 s4, s4, 1
    v_mfma_f32_16x16x32_bf16 v[104:107], a[56:59], v[152:155], v[104:107]
    v_mfma_f32_16x16x32_bf16 v[28:31], a[40:43], v[140:143], v[28:31]
    s_cmp_eq_u32 s4, 12
    v_mfma_f32_16x16x32_bf16 v[32:35], a[44:47], v[140:143], v[32:35]
    v_mfma_f32_16x16x32_bf16 v[36:39], a[48:51], v[140:143], v[36:39]
    s_cselect_b32 s4, 0, s4
    v_mfma_f32_16x16x32_bf16 v[40:43], a[52:55], v[140:143], v[40:43]
    v_mfma_f32_16x16x32_bf16 v[44:47], a[56:59], v[140:143], v[44:47]
    s_waitcnt vmcnt(8)
    v_mfma_f32_16x16x32_bf16 v[48:51], a[60:63], v[160:163], v[48:51]
    s_lshl_b32 s41, s4, 10
    v_mfma_f32_16x16x32_bf16 v[52:55], a[64:67], v[160:163], v[52:55]
    v_mfma_f32_16x16x32_bf16 v[56:59], a[68:71], v[160:163], v[56:59]
    s_add_u32 s41, s41, s65
    v_mfma_f32_16x16x32_bf16 v[60:63], a[72:75], v[160:163], v[60:63]
    v_mfma_f32_16x16x32_bf16 v[64:67], a[76:79], v[160:163], v[64:67]
    buffer_load_dwordx4 v[208:211], v9, s[16:19], s41 offen offset:0 sc1
    v_mfma_f32_16x16x32_bf16 v[68:71], a[60:63], v[164:167], v[68:71]
    v_mfma_f32_16x16x32_bf16 v[72:75], a[64:67], v[164:167], v[72:75]
    buffer_load_dwordx4 v[212:215], v10, s[16:19], s41 offen offset:0 sc1
    v_mfma_f32_16x16x32_bf16 v[76:79], a[68:71], v[164:167], v[76:79]
    v_mfma_f32_16x16x32_bf16 v[80:83], a[72:75], v[164:167], v[80:83]
    buffer_load_dwordx4 v[216:219], v11, s[16:19], s41 offen offset:0 sc1
    v_mfma_f32_16x16x32_bf16 v[84:87], a[76:79], v[164:167], v[84:87]
    v_mfma_f32_16x16x32_bf16 v[88:91], a[60:63], v[168:171], v[88:91]
    v_mfma_f32_16x16x32_bf16 v[92:95], a[64:67], v[168:171], v[92:95]
    buffer_load_dwordx4 v[204:207], v8, s[16:19], s41 offen offset:0 sc1
    v_mfma_f32_16x16x32_bf16 v[96:99], a[68:71], v[168:171], v[96:99]
    v_mfma_f32_16x16x32_bf16 v[100:103], a[72:75], v[168:171], v[100:103]
    s_add_u32 s4, s4, 1
    v_mfma_f32_16x16x32_bf16 v[104:107], a[76:79], v[168:171], v[104:107]
    v_mfma_f32_16x16x32_bf16 v[28:31], a[60:63], v[156:159], v[28:31]
    s_cmp_eq_u32 s4, 12
    v_mfma_f32_16x16x32_bf16 v[32:35], a[64:67], v[156:159], v[32:35]
    v_mfma_f32_16x16x32_bf16 v[36:39], a[68:71], v[156:159], v[36:39]
    s_cselect_b32 s4, 0, s4
    v_mfma_f32_16x16x32_bf16 v[40:43], a[72:75], v[156:159], v[40:43]
    v_mfma_f32_16x16x32_bf16 v[44:47], a[76:79], v[156:159], v[44:47]
    s_waitcnt vmcnt(8)
    v_mfma_f32_16x16x32_bf16 v[48:51], a[80:83], v[176:179], v[48:51]
    s_lshl_b32 s41, s4, 10
    v_mfma_f32_16x16x32_bf16 v[52:55], a[84:87], v[176:179], v[52:55]
    v_mfma_f32_16x16x32_bf16 v[56:59], a[88:91], v[176:179], v[56:59]
    s_add_u32 s41, s41, s65
    v_mfma_f32_16x16x32_bf16 v[60:63], a[92:95], v[176:179], v[60:63]
    v_mfma_f32_16x16x32_bf16 v[64:67], a[96:99], v[176:179], v[64:67]
    buffer_load_dwordx4 v[112:115], v9, s[16:19], s41 offen offset:0 sc1
    v_mfma_f32_16x16x32_bf16 v[68:71], a[80:83], v[180:183], v[68:71]
    v_mfma_f32_16x16x32_bf16 v[72:75], a[84:87], v[180:183], v[72:75]
    buffer_load_dwordx4 v[116:119], v10, s[16:19], s41 offen offset:0 sc1
    v_mfma_f32_16x16x32_bf16 v[76:79], a[88:91], v[180:183], v[76:79]
    v_mfma_f32_16x16x32_bf16 v[80:83], a[92:95], v[180:183], v[80:83]
    buffer_load_dwordx4 v[120:123], v11, s[16:19], s41 offen offset:0 sc1
    v_mfma_f32_16x16x32_bf16 v[84:87], a[96:99], v[180:183], v[84:87]
    v_mfma_f32_16x16x32_bf16 v[88:91], a[80:83], v[184:187], v[88:91]
    v_mfma_f32_16x16x32_bf16 v[92:95], a[84:87], v[184:187], v[92:95]
    buffer_load_dwordx4 v[108:111], v8, s[16:19], s41 offen offset:0 sc1
    v_mfma_f32_16x16x32_bf16 v[96:99], a[88:91], v[184:187], v[96:99]
    v_mfma_f32_16x16x32_bf16 v[100:103], a[92:95], v[184:187], v[100:103]
    s_add_u32 s4, s4, 1
    v_mfma_f32_16x16x32_bf16 v[104:107], a[96:99], v[184:187], v[104:107]
    v_mfma_f32_16x16x32_bf16 v[28:31], a[80:83], v[172:175], v[28:31]
    s_cmp_eq_u32 s4, 12
    v_mfma_f32_16x16x32_bf16 v[32:35], a[84:87], v[172:175], v[32:35]
    v_mfma_f32_16x16x32_bf16 v[36:39], a[88:91], v[172:175], v[36:39]
    s_cselect_b32 s4, 0, s4
    v_mfma_f32_16x16x32_bf16 v[40:43], a[92:95], v[172:175], v[40:43]
    v_mfma_f32_16x16x32_bf16 v[44:47], a[96:99], v[172:175], v[44:47]
    s_waitcnt vmcnt(8)
    v_mfma_f32_16x16x32_bf16 v[48:51], a[100:103], v[192:195], v[48:51]
    s_lshl_b32 s41, s4, 10
    v_mfma_f32_16x16x32_bf16 v[52:55], a[104:107], v[192:195], v[52:55]
    v_mfma_f32_16x16x32_bf16 v[56:59], a[108:111], v[192:195], v[56:59]
    s_add_u32 s41, s41, s65
    v_mfma_f32_16x16x32_bf16 v[60:63], a[112:115], v[192:195], v[60:63]
    v_mfma_f32_16x16x32_bf16 v[64:67], a[116:119], v[192:195], v[64:67]
    buffer_load_dwordx4 v[128:131], v9, s[16:19], s41 offen offset:0 sc1
    v_mfma_f32_16x16x32_bf16 v[68:71], a[100:103], v[196:199], v[68:71]
    v_mfma_f32_16x16x32_bf16 v[72:75], a[104:107], v[196:199], v[72:75]
    buffer_load_dwordx4 v[132:135], v10, s[16:19], s41 offen offset:0 sc1
    v_mfma_f32_16x16x32_bf16 v[76:79], a[108:111], v[196:199], v[76:79]
    v_mfma_f32_16x16x32_bf16 v[80:83], a[112:115], v[196:199], v[80:83]
    buffer_load_dwordx4 v[136:139], v11, s[16:19], s41 offen offset:0 sc1
    v_mfma_f32_16x16x32_bf16 v[84:87], a[116:119], v[196:199], v[84:87]
    v_mfma_f32_16x16x32_bf16 v[88:91], a[100:103], v[200:203], v[88:91]
    v_mfma_f32_16x16x32_bf16 v[92:95], a[104:107], v[200:203], v[92:95]
    buffer_load_dwordx4 v[124:127], v8, s[16:19], s41 offen offset:0 sc1
    v_mfma_f32_16x16x32_bf16 v[96:99], a[108:111], v[200:203], v[96:99]
    v_mfma_f32_16x16x32_bf16 v[100:103], a[112:115], v[200:203], v[100:103]
    s_add_u32 s4, s4, 1
    v_mfma_f32_16x16x32_bf16 v[104:107], a[116:119], v[200:203], v[104:107]
    v_mfma_f32_16x16x32_bf16 v[28:31], a[100:103], v[188:191], v[28:31]
    s_cmp_eq_u32 s4, 12
    v_mfma_f32_16x16x32_bf16 v[32:35], a[104:107], v[188:191], v[32:35]
    v_mfma_f32_16x16x32_bf16 v[36:39], a[108:111], v[188:191], v[36:39]
    s_cselect_b32 s4, 0, s4
    v_mfma_f32_16x16x32_bf16 v[40:43], a[112:115], v[188:191], v[40:43]
    v_mfma_f32_16x16x32_bf16 v[44:47], a[116:119], v[188:191], v[44:47]
    s_waitcnt vmcnt(8)
    v_mfma_f32_16x16x32_bf16 v[48:51], a[120:123], v[208:211], v[48:51]
    s_lshl_b32 s41, s4, 10
    v_mfma_f32_16x16x32_bf16 v[52:55], a[124:127], v[208:211], v[52:55]
    v_mfma_f32_16x16x32_bf16 v[56:59], a[128:131], v[208:211], v[56:59]
    s_add_u32 s41, s41, s65
    v_mfma_f32_16x16x32_bf16 v[60:63], a[132:135], v[208:211], v[60:63]
    v_mfma_f32_16x16x32_bf16 v[64:67], a[136:139], v[208:211], v[64:67]
    buffer_load_dwordx4 v[144:147], v9, s[16:19], s41 offen offset:0 sc1
    v_mfma_f32_16x16x32_bf16 v[68:71], a[120:123], v[212:215], v[68:71]
    v_mfma_f32_16x16x32_bf16 v[72:75], a[124:127], v[212:215], v[72:75]
    buffer_load_dwordx4 v[148:151], v10, s[16:19], s41 offen offset:0 sc1
    v_mfma_f32_16x16x32_bf16 v[76:79], a[128:131], v[212:215], v[76:79]
    v_mfma_f32_16x16x32_bf16 v[80:83], a[132:135], v[212:215], v[80:83]
    buffer_load_dwordx4 v[152:155], v11, s[16:19], s41 offen offset:0 sc1
    v_mfma_f32_16x16x32_bf16 v[84:87], a[136:139], v[212:215], v[84:87]
    v_mfma_f32_16x16x32_bf16 v[88:91], a[120:123], v[216:219], v[88:91]
    v_mfma_f32_16x16x32_bf16 v[92:95], a[124:127], v[216:219], v[92:95]
    buffer_load_dwordx4 v[140:143], v8, s[16:19], s41 offen offset:0 sc1
    v_mfma_f32_16x16x32_bf16 v[96:99], a[128:131], v[216:219], v[96:99]
    v_mfma_f32_16x16x32_bf16 v[100:103], a[132:135], v[216:219], v[100:103]
    s_add_u32 s4, s4, 1
    v_mfma_f32_16x16x32_bf16 v[104:107], a[136:139], v[216:219], v[104:107]
    v_mfma_f32_16x16x32_bf16 v[28:31], a[120:123], v[204:207], v[28:31]
    s_cmp_eq_u32 s4, 12
    v_mfma_f32_16x16x32_bf16 v[32:35], a[124:127], v[204:207], v[32:35]
    v_mfma_f32_16x16x32_bf16 v[36:39], a[128:131], v[204:207], v[36:39]
    s_cselect_b32 s4, 0, s4
    v_mfma_f32_16x16x32_bf16 v[40:43], a[132:135], v[204:207], v[40:43]
    v_mfma_f32_16x16x32_bf16 v[44:47], a[136:139], v[204:207], v[44:47]
    s_waitcnt vmcnt(8)
    v_mfma_f32_16x16x32_bf16 v[48:51], a[140:143], v[112:115], v[48:51]
    s_lshl_b32 s41, s4, 10
    v_mfma_f32_16x16x32_bf16 v[52:55], a[144:147], v[112:115], v[52:55]
    v_mfma_f32_16x16x32_bf16 v[56:59], a[148:151], v[112:115], v[56:59]
    s_add_u32 s41, s41, s65
    v_mfma_f32_16x16x32_bf16 v[60:63], a[152:155], v[112:115], v[60:63]
    v_mfma_f32_16x16x32_bf16 v[64:67], a[156:159], v[112:115], v[64:67]
    buffer_load_dwordx4 v[160:163], v9, s[16:19], s41 offen offset:0 sc1
    v_mfma_f32_16x16x32_bf16 v[68:71], a[140:143], v[116:119], v[68:71]
    v_mfma_f32_16x16x32_bf16 v[72:75], a[144:147], v[116:119], v[72:75]
    buffer_load_dwordx4 v[164:167], v10, s[16:19], s41 offen offset:0 sc1
    v_mfma_f32_16x16x32_bf16 v[76:79], a[148:151], v[116:119], v[76:79]
    v_mfma_f32_16x16x32_bf16 v[80:83], a[152:155], v[116:119], v[80:83]
    buffer_load_dwordx4 v[168:171], v11, s[16:19], s41 offen offset:0 sc1
    v_mfma_f32_16x16x32_bf16 v[84:87], a[156:159], v[116:119], v[84:87]
    v_mfma_f32_16x16x32_bf16 v[88:91], a[140:143], v[120:123], v[88:91]
    v_mfma_f32_16x16x32_bf16 v[92:95], a[144:147], v[120:123], v[92:95]
    buffer_load_dwordx4 v[156:159], v8, s[16:19], s41 offen offset:0 sc1
    v_mfma_f32_16x16x32_bf16 v[96:99], a[148:151], v[120:123], v[96:99]
    v_mfma_f32_16x16x32_bf16 v[100:103], a[152:155], v[120:123], v[100:103]
    s_add_u32 s4, s4, 1
    v_mfma_f32_16x16x32_bf16 v[104:107], a[156:159], v[120:123], v[104:107]
    v_mfma_f32_16x16x32_bf16 v[28:31], a[140:143], v[108:111], v[28:31]
    s_cmp_eq_u32 s4, 12
    v_mfma_f32_16x16x32_bf16 v[32:35], a[144:147], v[108:111], v[32:35]
    v_mfma_f32_16x16x32_bf16 v[36:39], a[148:151], v[108:111], v[36:39]
    s_cselect_b32 s4, 0, s4
    v_mfma_f32_16x16x32_bf16 v[40:43], a[152:155], v[108:111], v[40:43]
    v_mfma_f32_16x16x32_bf16 v[44:47], a[156:159], v[108:111], v[44:47]
    s_waitcnt vmcnt(8)
    v_mfma_f32_16x16x32_bf16 v[48:51], a[160:163], v[128:131], v[48:51]
    s_lshl_b32 s41, s4, 10
    v_mfma_f32_16x16x32_bf16 v[52:55], a[164:167], v[128:131], v[52:55]
    v_mfma_f32_16x16x32_bf16 v[56:59], a[168:171], v[128:131], v[56:59]
    s_add_u32 s41, s41, s65
    v_mfma_f32_16x16x32_bf16 v[60:63], a[172:175], v[128:131], v[60:63]
    v_mfma_f32_16x16x32_bf16 v[64:67], a[176:179], v[128:131], v[64:67]
    buffer_load_dwordx4 v[176:179], v9, s[16:19], s41 offen offset:0 sc1
    v_mfma_f32_16x16x32_bf16 v[68:71], a[160:163], v[132:135], v[68:71]
    v_mfma_f32_16x16x32_bf16 v[72:75], a[164:167], v[132:135], v[72:75]
    buffer_load_dwordx4 v[180:183], v10, s[16:19], s41 offen offset:0 sc1
    v_mfma_f32_16x16x32_bf16 v[76:79], a[168:171], v[132:135], v[76:79]
    v_mfma_f32_16x16x32_bf16 v[80:83], a[172:175], v[132:135], v[80:83]
    buffer_load_dwordx4 v[184:187], v11, s[16:19], s41 offen offset:0 sc1
    v_mfma_f32_16x16x32_bf16 v[84:87], a[176:179], v[132:135], v[84:87]
    v_mfma_f32_16x16x32_bf16 v[88:91], a[160:163], v[136:139], v[88:91]
    v_mfma_f32_16x16x32_bf16 v[92:95], a[164:167], v[136:139], v[92:95]
    buffer_load_dwordx4 v[172:175], v8, s[16:19], s41 offen offset:0 sc1
    v_mfma_f32_16x16x32_bf16 v[96:99], a[168:171], v[136:139], v[96:99]
    v_mfma_f32_16x16x32_bf16 v[100:103], a[172:175], v[136:139], v[100:103]
    s_add_u32 s4, s4, 1
    v_mfma_f32_16x16x32_bf16 v[104:107], a[176:179], v[136:139], v[104:107]
    v_mfma_f32_16x16x32_bf16 v[28:31], a[160:163], v[124:127], v[28:31]
    s_cmp_eq_u32 s4, 12
    v_mfma_f32_16x16x32_bf16 v[32:35], a[164:167], v[124:127], v[32:35]
    v_mfma_f32_16x16x32_bf16 v[36:39], a[168:171], v[124:127], v[36:39]
    s_cselect_b32 s4, 0, s4
    v_mfma_f32_16x16x32_bf16 v[40:43], a[172:175], v[124:127], v[40:43]
    v_mfma_f32_16x16x32_bf16 v[44:47], a[176:179], v[124:127], v[44:47]
    s_waitcnt vmcnt(8)
    v_mfma_f32_16x16x32_bf16 v[48:51], a[180:183], v[144:147], v[48:51]
    v_mfma_f32_16x16x32_bf16 v[52:55], a[184:187], v[144:147], v[52:55]
    v_mfma_f32_16x16x32_bf16 v[56:59], a[188:191], v[144:147], v[56:59]
    v_mfma_f32_16x16x32_bf16 v[60:63], a[192:195], v[144:147], v[60:63]
    v_mfma_f32_16x16x32_bf16 v[64:67], a[196:199], v[144:147], v[64:67]
    v_mfma_f32_16x16x32_bf16 v[68:71], a[180:183], v[148:151], v[68:71]
    v_mfma_f32_16x16x32_bf16 v[72:75], a[184:187], v[148:151], v[72:75]
    v_mfma_f32_16x16x32_bf16 v[76:79], a[188:191], v[148:151], v[76:79]
    v_mfma_f32_16x16x32_bf16 v[80:83], a[192:195], v[148:151], v[80:83]
    v_mfma_f32_16x16x32_bf16 v[84:87], a[196:199], v[148:151], v[84:87]
    v_mfma_f32_16x16x32_bf16 v[88:91], a[180:183], v[152:155], v[88:91]
    v_mfma_f32_16x16x32_bf16 v[92:95], a[184:187], v[152:155], v[92:95]
    v_mfma_f32_16x16x32_bf16 v[96:99], a[188:191], v[152:155], v[96:99]
    v_mfma_f32_16x16x32_bf16 v[100:103], a[192:195], v[152:155], v[100:103]
    v_mfma_f32_16x16x32_bf16 v[104:107], a[196:199], v[152:155], v[104:107]
    v_mfma_f32_16x16x32_bf16 v[28:31], a[180:183], v[140:143], v[28:31]
    v_mfma_f32_16x16x32_bf16 v[32:35], a[184:187], v[140:143], v[32:35]
    v_mfma_f32_16x16x32_bf16 v[36:39], a[188:191], v[140:143], v[36:39]
    v_mfma_f32_16x16x32_bf16 v[40:43], a[192:195], v[140:143], v[40:43]
    v_mfma_f32_16x16x32_bf16 v[44:47], a[196:199], v[140:143], v[44:47]
    s_waitcnt vmcnt(3)
    v_mfma_f32_16x16x32_bf16 v[48:51], a[200:203], v[160:163], v[48:51]
    v_mfma_f32_16x16x32_bf16 v[52:55], a[204:207], v[160:163], v[52:55]
    v_mfma_f32_16x16x32_bf16 v[56:59], a[208:211], v[160:163], v[56:59]
    v_mfma_f32_16x16x32_bf16 v[60:63], a[212:215], v[160:163], v[60:63]
    v_mfma_f32_16x16x32_bf16 v[64:67], a[216:219], v[160:163], v[64:67]
    v_mfma_f32_16x16x32_bf16 v[48:51], a[220:223], v[176:179], v[48:51]
    v_mfma_f32_16x16x32_bf16 v[52:55], a[224:227], v[176:179], v[52:55]
    v_mfma_f32_16x16x32_bf16 v[56:59], a[228:231], v[176:179], v[56:59]
    v_mfma_f32_16x16x32_bf16 v[60:63], a[232:235], v[176:179], v[60:63]
    v_mfma_f32_16x16x32_bf16 v[64:67], a[236:239], v[176:179], v[64:67]
    s_waitcnt vmcnt(2)
    v_mfma_f32_16x16x32_bf16 v[68:71], a[200:203], v[164:167], v[68:71]
    v_mfma_f32_16x16x32_bf16 v[72:75], a[204:207], v[164:167], v[72:75]
    v_mfma_f32_16x16x32_bf16 v[76:79], a[208:211], v[164:167], v[76:79]
    ds_write_b128 v13, v[48:51] offset:0
    v_mfma_f32_16x16x32_bf16 v[80:83], a[212:215], v[164:167], v[80:83]
    ds_write_b128 v13, v[52:55] offset:1024
    v_mfma_f32_16x16x32_bf16 v[84:87], a[216:219], v[164:167], v[84:87]
    v_mfma_f32_16x16x32_bf16 v[68:71], a[220:223], v[180:183], v[68:71]
    ds_write_b128 v13, v[56:59] offset:2048
    v_mfma_f32_16x16x32_bf16 v[72:75], a[224:227], v[180:183], v[72:75]
    ds_write_b128 v13, v[60:63] offset:3072
    v_mfma_f32_16x16x32_bf16 v[76:79], a[228:231], v[180:183], v[76:79]
    v_mfma_f32_16x16x32_bf16 v[80:83], a[232:235], v[180:183], v[80:83]
    ds_write_b128 v13, v[64:67] offset:4096
    v_mfma_f32_16x16x32_bf16 v[84:87], a[236:239], v[180:183], v[84:87]
    s_waitcnt vmcnt(1)
    v_mfma_f32_16x16x32_bf16 v[88:91], a[200:203], v[168:171], v[88:91]
    v_mfma_f32_16x16x32_bf16 v[92:95], a[204:207], v[168:171], v[92:95]
    v_mfma_f32_16x16x32_bf16 v[96:99], a[208:211], v[168:171], v[96:99]
    ds_write_b128 v14, v[68:71] offset:5120
    v_mfma_f32_16x16x32_bf16 v[100:103], a[212:215], v[168:171], v[100:103]
    ds_write_b128 v14, v[72:75] offset:6144
    v_mfma_f32_16x16x32_bf16 v[104:107], a[216:219], v[168:171], v[104:107]
    v_mfma_f32_16x16x32_bf16 v[88:91], a[220:223], v[184:187], v[88:91]
    ds_write_b128 v14, v[76:79] offset:7168
    v_mfma_f32_16x16x32_bf16 v[92:95], a[224:227], v[184:187], v[92:95]
    ds_write_b128 v14, v[80:83] offset:8192
    v_mfma_f32_16x16x32_bf16 v[96:99], a[228:231], v[184:187], v[96:99]
    v_mfma_f32_16x16x32_bf16 v[100:103], a[232:235], v[184:187], v[100:103]
    ds_write_b128 v14, v[84:87] offset:9216
    v_mfma_f32_16x16x32_bf16 v[104:107], a[236:239], v[184:187], v[104:107]
    s_waitcnt vmcnt(0)
    v_mfma_f32_16x16x32_bf16 v[28:31], a[200:203], v[156:159], v[28:31]
    v_mfma_f32_16x16x32_bf16 v[32:35], a[204:207], v[156:159], v[32:35]
    v_mfma_f32_16x16x32_bf16 v[36:39], a[208:211], v[156:159], v[36:39]
    ds_write_b128 v15, v[88:91] offset:10240
    v_mfma_f32_16x16x32_bf16 v[40:43], a[212:215], v[156:159], v[40:43]
    ds_write_b128 v15, v[92:95] offset:11264
    v_mfma_f32_16x16x32_bf16 v[44:47], a[216:219], v[156:159], v[44:47]
    v_mfma_f32_16x16x32_bf16 v[28:31], a[220:223], v[172:175], v[28:31]
    ds_write_b128 v15, v[96:99] offset:12288
    v_mfma_f32_16x16x32_bf16 v[32:35], a[224:227], v[172:175], v[32:35]
    ds_write_b128 v15, v[100:103] offset:13312
    v_mfma_f32_16x16x32_bf16 v[36:39], a[228:231], v[172:175], v[36:39]
    v_mfma_f32_16x16x32_bf16 v[40:43], a[232:235], v[172:175], v[40:43]
    ds_write_b128 v15, v[104:107] offset:14336
    v_mfma_f32_16x16x32_bf16 v[44:47], a[236:239], v[172:175], v[44:47]
    v_and_b32 v5, 15, v0
    v_mul_u32_u24 v5, 1280, v5
    v_bfe_u32 v6, v0, 4, 1
    v_lshl_add_u32 v5, v6, 5, v5
    v_lshrrev_b32 v6, 5, v0
    v_lshl_add_u32 v5, v6, 4, v5
    s_waitcnt lgkmcnt(0)
    s_barrier
    ds_read_b128 v[108:111], v12 offset:0
    ds_read_b128 v[112:115], v12 offset:1024
    ds_read_b128 v[116:119], v12 offset:2048
    ds_read_b128 v[120:123], v12 offset:3072
    ds_read_b128 v[124:127], v12 offset:4096
    ds_read_b128 v[128:131], v12 offset:5120
    ds_read_b128 v[132:135], v12 offset:6144
    ds_read_b128 v[136:139], v12 offset:7168
    ds_read_b128 v[140:143], v12 offset:8192
    ds_read_b128 v[144:147], v12 offset:9216
    ds_read_b128 v[148:151], v12 offset:10240
    ds_read_b128 v[152:155], v12 offset:11264
    ds_read_b128 v[156:159], v12 offset:12288
    ds_read_b128 v[160:163], v12 offset:13312
    ds_read_b128 v[164:167], v12 offset:14336
    s_waitcnt lgkmcnt(10)
    v_pk_add_f32 v[28:29], v[28:29], v[108:109]
    v_pk_add_f32 v[30:31], v[30:31], v[110:111]
    v_pk_add_f32 v[32:33], v[32:33], v[112:113]
    v_pk_add_f32 v[34:35], v[34:35], v[114:115]
    v_pk_add_f32 v[36:37], v[36:37], v[116:117]
    v_pk_add_f32 v[38:39], v[38:39], v[118:119]
    v_pk_add_f32 v[40:41], v[40:41], v[120:121]
    v_pk_add_f32 v[42:43], v[42:43], v[122:123]
    v_pk_add_f32 v[44:45], v[44:45], v[124:125]
    v_pk_add_f32 v[46:47], v[46:47], v[126:127]
    s_waitcnt lgkmcnt(5)
    v_pk_add_f32 v[28:29], v[28:29], v[128:129]
    v_pk_add_f32 v[30:31], v[30:31], v[130:131]
    v_pk_add_f32 v[32:33], v[32:33], v[132:133]
    v_pk_add_f32 v[34:35], v[34:35], v[134:135]
    v_pk_add_f32 v[36:37], v[36:37], v[136:137]
    v_pk_add_f32 v[38:39], v[38:39], v[138:139]
    v_pk_add_f32 v[40:41], v[40:41], v[140:141]
    v_pk_add_f32 v[42:43], v[42:43], v[142:143]
    v_pk_add_f32 v[44:45], v[44:45], v[144:145]
    v_pk_add_f32 v[46:47], v[46:47], v[146:147]
    s_waitcnt lgkmcnt(0)
    v_pk_add_f32 v[28:29], v[28:29], v[148:149]
    v_pk_add_f32 v[30:31], v[30:31], v[150:151]
    v_pk_add_f32 v[32:33], v[32:33], v[152:153]
    v_pk_add_f32 v[34:35], v[34:35], v[154:155]
    v_pk_add_f32 v[36:37], v[36:37], v[156:157]
    v_pk_add_f32 v[38:39], v[38:39], v[158:159]
    v_pk_add_f32 v[40:41], v[40:41], v[160:161]
    v_pk_add_f32 v[42:43], v[42:43], v[162:163]
    v_pk_add_f32 v[44:45], v[44:45], v[164:165]
    v_pk_add_f32 v[46:47], v[46:47], v[166:167]
    v_lshlrev_b32 v26, 16, v220
    v_and_b32 v27, 0xffff0000, v220
    v_pk_add_f32 v[28:29], v[28:29], v[26:27]
    v_cvt_pk_bf16_f32 v220, v28, v29
    v_lshlrev_b32 v26, 16, v221
    v_and_b32 v27, 0xffff0000, v221
    v_pk_add_f32 v[30:31], v[30:31], v[26:27]
    v_cvt_pk_bf16_f32 v221, v30, v31
    v_lshlrev_b32 v26, 16, v222
    v_and_b32 v27, 0xffff0000, v222
    v_pk_add_f32 v[32:33], v[32:33], v[26:27]
    v_cvt_pk_bf16_f32 v222, v32, v33
    v_lshlrev_b32 v26, 16, v223
    v_and_b32 v27, 0xffff0000, v223
    v_pk_add_f32 v[34:35], v[34:35], v[26:27]
    v_cvt_pk_bf16_f32 v223, v34, v35
    v_lshlrev_b32 v26, 16, v224
    v_and_b32 v27, 0xffff0000, v224
    v_pk_add_f32 v[36:37], v[36:37], v[26:27]
    v_cvt_pk_bf16_f32 v224, v36, v37
    v_lshlrev_b32 v26, 16, v225
    v_and_b32 v27, 0xffff0000, v225
    v_pk_add_f32 v[38:39], v[38:39], v[26:27]
    v_cvt_pk_bf16_f32 v225, v38, v39
    v_lshlrev_b32 v26, 16, v226
    v_and_b32 v27, 0xffff0000, v226
    v_pk_add_f32 v[40:41], v[40:41], v[26:27]
    v_cvt_pk_bf16_f32 v226, v40, v41
    v_lshlrev_b32 v26, 16, v227
    v_and_b32 v27, 0xffff0000, v227
    v_pk_add_f32 v[42:43], v[42:43], v[26:27]
    v_cvt_pk_bf16_f32 v227, v42, v43
    v_lshlrev_b32 v26, 16, v228
    v_and_b32 v27, 0xffff0000, v228
    v_pk_add_f32 v[44:45], v[44:45], v[26:27]
    v_cvt_pk_bf16_f32 v228, v44, v45
    v_lshlrev_b32 v26, 16, v229
    v_and_b32 v27, 0xffff0000, v229
    v_pk_add_f32 v[46:47], v[46:47], v[26:27]
    v_cvt_pk_bf16_f32 v229, v46, v47
    v_permlane16_swap_b32 v220, v222
    v_permlane16_swap_b32 v221, v223
    v_permlane16_swap_b32 v224, v226
    v_permlane16_swap_b32 v225, v227
    buffer_store_dwordx2 v[228:229], v3, s[12:15], s39 offen offset:128
    buffer_store_dwordx4 v[220:223], v5, s[12:15], s39 offen offset:0
    buffer_store_dwordx4 v[224:227], v5, s[12:15], s39 offen offset:64
    s_endpgm
KEND:
.section .rodata,"a"
.p2align 6
.amdhsa_kernel sequential_preLN__linear_attn_block__glu_gated_reglu__prompt_kernel
  .amdhsa_next_free_vgpr 512
  .amdhsa_next_free_sgpr 102
  .amdhsa_accum_offset 256
  .amdhsa_group_segment_fixed_size 0
  .amdhsa_kernarg_size 80
  .amdhsa_user_sgpr_count 2
  .amdhsa_user_sgpr_kernarg_segment_ptr 1
  .amdhsa_system_sgpr_workgroup_id_x 1
.end_amdhsa_kernel
```
